```python
import torch

def _softmax(x, axis=-1):
    return torch.softmax(x, dim=axis)

def _gelu(x):
    return torch.nn.functional.gelu(x, approximate='tanh')

def _silu(x):
    return torch.nn.functional.silu(x)

def _sigmoid(x):
    return torch.sigmoid(x)

def _layernorm(x, axis=-1, eps=1e-05):
    m = x.mean(dim=axis, keepdim=True)
    v = x.var(dim=axis, keepdim=True, unbiased=False)
    return (x - m) / torch.sqrt(v + eps)

def _scatter_add(tgt, idx, src, axis=0):
    return tgt.clone().index_add_(axis, idx, src)

def _segment_sum(src, seg, n):
    out = torch.zeros((n,) + src.shape[1:], dtype=src.dtype)
    return out.index_add_(0, seg, src)

def _pad(x, pw):
    flat = tuple((v for pair in reversed(pw) for v in pair))
    return torch.nn.functional.pad(x, flat)
kernel_name = 'interleave_layers__memory_aug_recurrent_mem_tr__glu_gated_glu__prompt'

def setup_inputs():

    _w = lambda a: (lambda t: t.to(torch.bfloat16) if t.is_floating_point() else t)(torch.as_tensor(a))

    def _A_setup():
        B, S, Dm = (1, 2048, 512)
        H, Dh = (32, 128)
        M, seg = (8, 32)
        seg = min(seg, S)
        S = S // seg * seg
        return {'x': _w((lambda *s: torch.randn(*s, dtype=torch.bfloat16) * 0.05)(B, S, Dm)), 'mem0': _w((lambda *s: torch.randn(*s, dtype=torch.bfloat16) * 0.8)(B, M, Dm)), 'Wq': _w((lambda *s: torch.randn(*s, dtype=torch.bfloat16) * 0.8)(Dm, H, Dh) * Dm ** (-0.5)), 'Wk': _w((lambda *s: torch.randn(*s, dtype=torch.bfloat16) * 0.8)(Dm, H, Dh) * Dm ** (-0.5)), 'Wv': _w((lambda *s: torch.randn(*s, dtype=torch.bfloat16) * 0.8)(Dm, H, Dh) * Dm ** (-0.5)), 'Wo': _w((lambda *s: torch.randn(*s, dtype=torch.bfloat16) * 0.8)(H, Dh, Dm) * (H * Dh) ** (-0.5)), 'seg_len': seg}
    _A_in = _A_setup()

    def _B_setup():
        B, S, D, F = (1, 2048, 512, 1792)
        return {'x': _w((lambda *s: torch.randn(*s, dtype=torch.bfloat16) * 0.05)(B, S, D)), 'w_gate': _w((lambda *s: torch.randn(*s, dtype=torch.bfloat16) * 0.05)(D, F)), 'w_up': _w((lambda *s: torch.randn(*s, dtype=torch.bfloat16) * 0.05)(D, F)), 'w_down': _w((lambda *s: torch.randn(*s, dtype=torch.bfloat16) * 0.05)(F, D))}
    _B_in = _B_setup()
    return {'A_x': _A_in['x'], 'A_mem0': _A_in['mem0'], 'A_Wq': _A_in['Wq'], 'A_Wk': _A_in['Wk'], 'A_Wv': _A_in['Wv'], 'A_Wo': _A_in['Wo'], 'A_seg_len': _A_in['seg_len'], 'B_x': _B_in['x'], 'B_w_gate': _B_in['w_gate'], 'B_w_up': _B_in['w_up'], 'B_w_down': _B_in['w_down']}

def reference(A_x, A_mem0, A_Wq, A_Wk, A_Wv, A_Wo, A_seg_len, B_x, B_w_gate, B_w_up, B_w_down):

    def _A_ref(x, mem0, Wq, Wk, Wv, Wo, seg_len):
        B, S, Dm = x.shape
        H, Dh = (Wq.shape[1], Wq.shape[2])
        M = mem0.shape[1]
        scale = Dh ** (-0.5)
        n_seg = S // seg_len
        L = M + seg_len
        idx = torch.arange(L)
        mask = (idx[:, None] < M) | (idx[:, None] >= idx[None, :])
        mem = mem0
        outs = []
        for s in range(n_seg):
            xs = x[:, s * seg_len:(s + 1) * seg_len, :].clone()
            h = torch.concatenate([mem, xs], axis=1)
            q = torch.einsum('btd,dhe->bhte', h, Wq)
            k = torch.einsum('btd,dhe->bhte', h, Wk)
            v = torch.einsum('btd,dhe->bhte', h, Wv)
            scores = torch.einsum('bhqe,bhke->bhqk', q, k) * scale
            scores = torch.where(mask[None, None], scores, -1000000000.0)
            p = _softmax(scores, axis=-1)
            o = torch.einsum('bhqk,bhke->bhqe', p, v)
            o = torch.einsum('bhte,hed->btd', o, Wo)
            mem = o[:, :M, :].clone()
            outs.append(o[:, M:, :])
        return torch.concatenate(outs, axis=1)

    def _B_ref(x, w_gate, w_up, w_down):
        g = torch.einsum('bsd,df->bsf', x, w_gate)
        u = torch.einsum('bsd,df->bsf', x, w_up)
        h = _sigmoid(g) * u
        return torch.einsum('bsf,fd->bsd', h, w_down)
    x = A_x
    x = x + _A_ref(_layernorm(x, axis=-1), A_mem0, A_Wq, A_Wk, A_Wv, A_Wo, A_seg_len)
    x = x + _B_ref(_layernorm(x, axis=-1), B_w_gate, B_w_up, B_w_down)
    x = x + _A_ref(_layernorm(x, axis=-1), A_mem0, A_Wq, A_Wk, A_Wv, A_Wo, A_seg_len)
    x = x + _B_ref(_layernorm(x, axis=-1), B_w_gate, B_w_up, B_w_down)
    return x
```

```asm
; @launch grid=(256,1,1) block=(256,1,1) lds=163840
.amdgcn_target "amdgcn-amd-amdhsa--gfx950"
.text
.globl interleave_layers__memory_aug_recurrent_mem_tr__glu_gated_glu__prompt_kernel
.p2align 8
.type interleave_layers__memory_aug_recurrent_mem_tr__glu_gated_glu__prompt_kernel,@function
interleave_layers__memory_aug_recurrent_mem_tr__glu_gated_glu__prompt_kernel:
  s_cmp_ge_u32 s2, 256
  s_cbranch_scc1 L_end
  s_load_dwordx2 s[4:5], s[0:1], 104
  s_load_dwordx2 s[62:63], s[0:1], 96
  s_getpc_b64 s[70:71]
L_pc:
  s_lshr_b32 s67, s2, 3
  s_and_b32 s67, s67, 3
  s_lshl_b32 s67, s67, 15
  v_lshlrev_b32 v100, 7, v0
  v_add_u32 v100, s67, v100
  v_min_u32 v100, L_last-L_pc, v100
  global_load_dword v101, v100, s[70:71]
  s_getreg_b32 s3, hwreg(HW_REG_XCC_ID, 0, 3)
  s_mov_b32 s6, 268435456
  s_mov_b32 s7, 0x20000
  s_mov_b32 s66, 262144
  v_lshrrev_b32 v1, 6, v0
  v_and_b32 v0, 63, v0
  v_readfirstlane_b32 s14, v1
  s_and_b32 s64, s2, 7
  s_lshr_b32 s65, s2, 3
  s_mov_b32 s2, 0
  s_waitcnt lgkmcnt(0)
L_dispatch:
  s_mov_b32 s13, s65
  s_lshr_b32 s12, s3, 2
  s_cmp_eq_u32 s3, 0
  s_cbranch_scc1 L_rec
  s_lshr_b32 s67, 0x62, s3
  s_and_b32 s67, s67, 1
  s_cbranch_scc1 L_x156
  s_min_u32 s67, s3, 5
  s_sub_u32 s67, s67, 2
  s_lshl_b32 s67, s67, 5
  s_add_u32 s67, s67, s65
  s_lshl_b32 s67, s67, 2
  s_add_u32 s67, s67, s14
  s_lshl_b32 s67, s67, 11
  v_lshlrev_b32 v100, 4, v0
  v_mov_b64 v[104:105], 0
  v_mov_b64 v[106:107], 0
  buffer_store_dwordx4 v[104:107], v100, s[4:7], s67 offen offset:0 sc1
  buffer_store_dwordx4 v[104:107], v100, s[4:7], s67 offen offset:1024 sc1
  s_cmp_eq_u32 s3, 4
  s_cbranch_scc1 L_rec
  s_waitcnt vmcnt(0)
  s_barrier
  s_cmp_lg_u32 s14, 0
  s_cbranch_scc1 L_arr_1
  s_and_b32 s67, s3, 1
  s_lshl_b32 s67, s67, 7
  s_lshr_b32 s68, s3, 1
  s_lshl_b32 s68, s68, 2
  s_add_u32 s67, s67, s68
  s_add_u32 s67, s67, s2
  s_mul_i32 s68, s64, s64
  s_lshl_b32 s68, s68, 8
  s_add_u32 s68, s68, s64
  s_lshl_b32 s68, s68, 8
  s_add_u32 s68, s68, 1
  s_mov_b64 exec, 1
  v_mov_b32 v98, s67
  v_mov_b32 v99, s68
  global_atomic_add v98, v99, s[62:63] sc1
  s_mov_b64 exec, -1
L_arr_1:
  s_mov_b32 s12, 2
  s_cmp_eq_u32 s3, 7
  s_cbranch_scc1 L_s1
L_helped:
  s_barrier
  s_lshr_b32 s12, s3, 2
  s_cmp_eq_u32 s3, 3
  s_cbranch_scc1 L_x3
  s_cmp_lt_u32 s65, 14
  s_cbranch_scc1 L_s4
  s_cmp_lt_u32 s65, 16
  s_cbranch_scc1 L_idle2
  s_and_b32 s13, s65, 7
  s_cmp_lt_u32 s65, 24
  s_cbranch_scc1 L_s5
  s_cmp_eq_u32 0, 0
  s_cbranch_scc1 L_red
L_x156:
  s_sub_u32 s67, s3, 4
  s_cmp_eq_u32 s3, 1
  s_cselect_b32 s67, 0, s67
  s_lshl_b32 s67, s67, 5
  s_add_u32 s67, s67, s65
  s_mul_i32 s13, s67, 171
  s_lshr_b32 s13, s13, 9
  s_mul_i32 s68, s13, 3
  s_sub_u32 s12, s67, s68
  s_cmp_eq_u32 s12, 2
  s_cbranch_scc1 L_s2
  s_cmp_lg_u32 s14, 0
  s_cbranch_scc1 L_arr_2
  s_and_b32 s67, s3, 1
  s_lshl_b32 s67, s67, 7
  s_lshr_b32 s68, s3, 1
  s_lshl_b32 s68, s68, 2
  s_add_u32 s67, s67, s68
  s_add_u32 s67, s67, s2
  s_mul_i32 s68, s64, s64
  s_lshl_b32 s68, s68, 8
  s_add_u32 s68, s68, s64
  s_lshl_b32 s68, s68, 8
  s_add_u32 s68, s68, 1
  s_mov_b64 exec, 1
  v_mov_b32 v98, s67
  v_mov_b32 v99, s68
  global_atomic_add v98, v99, s[62:63] sc1
  s_mov_b64 exec, -1
L_arr_2:
  s_cmp_eq_u32 0, 0
  s_cbranch_scc1 L_s1
L_x3:
  s_lshr_b32 s12, s65, 4
  s_and_b32 s13, s65, 15
  s_cmp_eq_u32 0, 0
  s_cbranch_scc1 L_s3
L_idle:
  s_waitcnt vmcnt(0)
  s_barrier
  s_cmp_lg_u32 s14, 0
  s_cbranch_scc1 L_arr_3
  s_and_b32 s67, s3, 1
  s_lshl_b32 s67, s67, 7
  s_lshr_b32 s68, s3, 1
  s_lshl_b32 s68, s68, 2
  s_add_u32 s67, s67, s68
  s_add_u32 s67, s67, s2
  s_mul_i32 s68, s64, s64
  s_lshl_b32 s68, s68, 8
  s_add_u32 s68, s68, s64
  s_lshl_b32 s68, s68, 8
  s_add_u32 s68, s68, 1
  s_mov_b64 exec, 1
  v_mov_b32 v98, s67
  v_mov_b32 v99, s68
  global_atomic_add v98, v99, s[62:63] sc1
  s_mov_b64 exec, -1
L_arr_3:
L_idle2:
  v_mbcnt_lo_u32_b32 v102, -1, 0
  v_and_b32 v100, 1, v102
  v_lshlrev_b32 v100, 7, v100
  v_bfe_u32 v102, v102, 1, 2
  v_lshl_add_u32 v100, v102, 2, v100
  v_add_u32 v100, s2, v100
L_go_4:
  s_sub_u32 s66, s66, 1
  s_cbranch_scc1 L_abort
  global_load_dword v101, v100, s[62:63] sc1
  s_waitcnt vmcnt(0)
  v_and_b32 v102, 0xff, v101
  v_cmp_eq_u32 vcc, 32, v102
  v_bfe_u32 v102, v101, 8, 8
  v_lshrrev_b32 v103, 16, v101
  s_and_b32 s67, vcc_lo, 0xff
  s_cmp_eq_u32 s67, 0xff
  s_cbranch_scc1 L_go_4_ok
  v_and_b32 v102, 0xff, v101
  v_cmp_lt_u32 vcc, 32, v102
  s_cbranch_vccnz L_abort
  s_sleep 8
  s_branch L_go_4
L_go_4_ok:
  v_mul_u32_u24 v102, v102, v102
  v_lshlrev_b32 v103, 5, v103
  v_cmp_eq_u32 vcc, v102, v103
  s_nop 3
  s_and_b32 s67, vcc_lo, 0xff
  s_cmp_lg_u32 s67, 0xff
  s_cbranch_scc1 L_regroup
  s_branch L_end
L_regroup:
  s_cmp_lg_u32 s2, 0
  s_cbranch_scc1 L_abort
  s_waitcnt vmcnt(0) lgkmcnt(0)
  s_barrier
  v_mov_b32 v3, 0
  s_cmp_lg_u32 s14, 0
  s_cbranch_scc1 L_norank
  s_mov_b64 exec, 1
  s_lshl_b32 s67, s3, 2
  s_add_u32 s67, s67, 32
  v_mov_b32 v4, s67
  v_mov_b32 v5, 1
  global_atomic_add v5, v4, v5, s[62:63] sc0 sc1
  s_waitcnt vmcnt(0)
  ds_write_b32 v3, v5
  s_mov_b64 exec, -1
L_norank:
  s_waitcnt lgkmcnt(0)
  s_barrier
  ds_read_b32 v5, v3
  v_mbcnt_lo_u32_b32 v0, -1, 0
  v_mbcnt_hi_u32_b32 v0, -1, v0
  s_waitcnt lgkmcnt(0)
  v_readfirstlane_b32 s65, v5
  s_mov_b32 s64, 0
  s_mov_b32 s2, 16
  s_nop 3
  s_barrier
  s_cmp_lt_u32 s65, 32
  s_cbranch_scc1 L_dispatch
L_abort:
  s_mov_b64 exec, 1
  v_mov_b32 v100, 64
  v_mov_b32 v101, 1
  global_atomic_add v100, v101, s[62:63] sc1
L_end:
  s_endpgm
L_rec:
  v_and_b32 v20, 15, v0
  v_lshrrev_b32 v21, 4, v0
  v_lshlrev_b32 v15, 2, v0
  v_lshlrev_b32 v18, 3, v0
  v_lshlrev_b32 v0, 4, v0
  s_lshl_b32 s68, s14, 15
  s_add_u32 s68, s68, 32768
  v_add_u32 v2, s68, v0
  s_lshl_b32 s69, s14, 6
  v_lshrrev_b32 v22, 2, v20
  v_and_b32 v23, 3, v20
  v_and_b32 v24, 1, v20
  v_lshl_add_u32 v24, v22, 1, v24
  v_lshrrev_b32 v25, 1, v23
  v_and_b32 v26, 7, v20
  v_mul_u32_u24 v27, 576, v21
  v_lshl_add_u32 v27, v20, 2, v27
  v_add_u32 v27, s69, v27
  v_add_u32 v3, 24576, v27
  v_mul_u32_u24 v27, 288, v24
  v_lshl_add_u32 v28, v21, 4, v27
  v_add_u32 v5, 24576, v28
  v_mul_u32_u24 v27, 96, v24
  v_lshl_add_u32 v28, v21, 4, v27
  s_lshl_b32 s67, s14, 10
  s_add_u32 s67, s67, 24576
  v_add_u32 v6, s67, v28
  s_lshl_b32 s67, s14, 10
  v_add_u32 v1, s67, v18
  v_lshlrev_b32 v27, 7, v21
  v_lshl_add_u32 v27, v20, 2, v27
  v_add_u32 v7, s67, v27
  v_lshlrev_b32 v17, 9, v21
  v_lshl_add_u32 v17, v20, 5, v17
  v_add_u32 v17, 8192, v17
  s_lshl_b32 s67, s14, 11
  v_add_u32 v8, s67, v17
  v_add_u32 v13, s67, v0
  s_add_u32 s33, s67, 0
  s_add_u32 s34, s67, 8192
  v_lshlrev_b32 v27, 13, v22
  v_lshl_add_u32 v27, v21, 11, v27
  v_lshl_add_u32 v27, v23, 4, v27
  s_lshl_b32 s70, s14, 16
  s_lshl_b32 s71, s13, 6
  s_add_u32 s70, s70, s71
  v_add_u32 v9, s70, v27
  v_mov_b32 v27, 0x4444
  v_mov_b32 v28, 0xeeee
  v_cmp_eq_u32 vcc, 1, v25
  s_nop 1
  v_cndmask_b32 v12, v27, v28, vcc
  s_mov_b32 s60, 2139193217
  s_mov_b32 s61, 2139193217
  s_mov_b32 s36, 0x3e0293ee
  s_mov_b32 s37, 0x3e0293ee
  s_lshl_b32 s35, s13, 8
  s_lshl_b32 s67, s12, 19
  s_add_u32 s16, s67, 1048576
  s_add_u32 s17, s16, 32768
  s_lshl_b32 s67, s13, 13
  s_add_u32 s18, s16, s67
  s_lshl_b32 s67, s12, 15
  s_add_u32 s72, s67, 31457280
  s_lshl_b32 s67, s12, 11
  s_add_u32 s67, s67, s13
  s_mul_i32 s23, s67, 24576
  s_add_u32 s23, s23, 67108864
  s_lshl_b32 s70, s67, 5
  s_add_u32 s70, s70, 843776
  s_lshl_b32 s67, s12, 5
  s_add_u32 s67, s67, s13
  s_lshl_b32 s27, s67, 15
  s_add_u32 s27, s27, 50331648
  s_lshl_b32 s67, s67, 10
  v_and_b32 v27, 12, v15
  v_add_u32 v27, s67, v27
  v_mov_b32 v28, s70
  v_cmp_eq_u32 vcc, 16, v15
  s_nop 1
  v_cndmask_b32 v15, v27, v28, vcc
  v_mov_b32 v27, 16
  v_mov_b32 v28, 1024
  v_cndmask_b32 v4, v27, v28, vcc
  s_mov_b32 s15, 0
  s_mov_b32 s31, 0
  v_lshl_add_u32 v27, v25, 1, v21
  v_lshlrev_b32 v27, 4, v27
  v_and_b32 v28, 1, v23
  v_lshl_add_u32 v27, v28, 3, v27
  v_add_u32 v27, s69, v27
  v_lshl_add_u32 v28, v22, 1, v21
  v_mov_b32 v29, 536870912
  v_cmp_gt_u32 vcc, 2, v28
  s_nop 1
  v_cndmask_b32 v10, v29, v27, vcc
  v_and_b32 v27, 1, v20
  v_lshlrev_b32 v27, 4, v27
  v_mov_b32 v28, 0x3f80
  v_lshlrev_b32 v11, v27, v28
  v_lshrrev_b32 v27, 1, v26
  v_cmp_eq_u32 s[52:53], 0, v27
  v_cmp_eq_u32 s[54:55], 1, v27
  v_cmp_eq_u32 s[56:57], 2, v27
  v_cmp_eq_u32 s[58:59], 3, v27
  s_mov_b32 s67, 536870912
  s_cmp_eq_u32 s14, 1
  s_cselect_b32 s74, 786432, s67
  v_mov_b64 v[32:33], s[60:61]
  v_mov_b64 v[34:35], s[60:61]
  s_xor_b32 s68, s18, 0x40000
  buffer_store_dwordx4 v[32:35], v13, s[4:7], s18 offen offset:0
  buffer_store_dwordx4 v[32:35], v13, s[4:7], s18 offen offset:1024
  buffer_store_dwordx4 v[32:35], v13, s[4:7], s68 offen offset:0
  buffer_store_dwordx4 v[32:35], v13, s[4:7], s68 offen offset:1024
  s_add_u32 s67, s72, s35
  buffer_store_dwordx2 v[32:33], v10, s[4:7], s67 offen
  s_add_u32 s67, s67, 8192
  buffer_store_dwordx2 v[32:33], v10, s[4:7], s67 offen
  s_add_u32 s67, s67, 8192
  buffer_store_dwordx2 v[32:33], v10, s[4:7], s67 offen
  s_add_u32 s67, s67, 8192
  buffer_store_dwordx2 v[32:33], v10, s[4:7], s67 offen
  s_add_u32 s67, s67, 8192
  s_waitcnt vmcnt(0)
  s_barrier
  s_cmp_lg_u32 s14, 0
  s_cbranch_scc1 L_arr_5
  s_and_b32 s67, s3, 1
  s_lshl_b32 s67, s67, 7
  s_lshr_b32 s68, s3, 1
  s_lshl_b32 s68, s68, 2
  s_add_u32 s67, s67, s68
  s_add_u32 s67, s67, s2
  s_mul_i32 s68, s64, s64
  s_lshl_b32 s68, s68, 8
  s_add_u32 s68, s68, s64
  s_lshl_b32 s68, s68, 8
  s_add_u32 s68, s68, 1
  s_mov_b64 exec, 1
  v_mov_b32 v98, s67
  v_mov_b32 v99, s68
  global_atomic_add v98, v99, s[62:63] sc1
  s_mov_b64 exec, -1
L_arr_5:
  s_mov_b32 s78, 0x05040100
  s_mov_b32 s79, 0x07060302
  v_lshrrev_b32 v27, 1, v21
  v_and_b32 v28, 1, v21
  v_lshlrev_b32 v29, 18, v27
  v_lshl_add_u32 v29, v28, 16, v29
  v_lshl_add_u32 v29, v20, 2, v29
  s_add_u32 s67, s35, s69
  v_add_u32 v30, s67, v29
  v_lshlrev_b32 v29, 13, v27
  v_lshl_add_u32 v29, v28, 12, v29
  v_lshl_add_u32 v29, v20, 4, v29
  s_lshl_b32 s67, s13, 17
  s_lshl_b32 s68, s14, 8
  s_add_u32 s67, s67, s68
  v_add_u32 v31, s67, v29
  v_lshlrev_b32 v29, 10, v24
  v_lshl_add_u32 v29, v21, 6, v29
  v_lshl_add_u32 v29, v25, 5, v29
  v_add_u32 v19, s68, v29
  s_lshl_b32 s67, s14, 11
  v_add_u32 v18, s67, v0
  s_load_dwordx2 s[80:81], s[0:1], 16
  s_mov_b32 s82, 4194304
  s_mov_b32 s83, 0x20000
  s_load_dwordx2 s[84:85], s[0:1], 24
  s_mov_b32 s86, 4194304
  s_mov_b32 s87, 0x20000
  s_load_dwordx2 s[88:89], s[0:1], 32
  s_mov_b32 s90, 4194304
  s_mov_b32 s91, 0x20000
  s_load_dwordx2 s[92:93], s[0:1], 40
  s_mov_b32 s94, 4194304
  s_mov_b32 s95, 0x20000
  s_load_dwordx2 s[8:9], s[0:1], 8
  s_mov_b32 s10, 8192
  s_mov_b32 s11, 0x20000
  s_waitcnt lgkmcnt(0)
  s_xor_b32 s67, s14, 0
  s_lshl_b32 s40, s67, 20
  s_lshl_b32 s44, s67, 15
  s_xor_b32 s67, s14, 1
  s_lshl_b32 s41, s67, 20
  s_lshl_b32 s45, s67, 15
  s_xor_b32 s67, s14, 2
  s_lshl_b32 s42, s67, 20
  s_lshl_b32 s46, s67, 15
  s_xor_b32 s67, s14, 3
  s_lshl_b32 s43, s67, 20
  s_lshl_b32 s47, s67, 15
  s_add_u32 s67, s40, 0
  buffer_load_dword v32, v30, s[80:83], s67 offen
  s_add_u32 s67, s40, 8192
  buffer_load_dword v33, v30, s[80:83], s67 offen
  s_add_u32 s67, s40, 131072
  buffer_load_dword v34, v30, s[80:83], s67 offen
  s_add_u32 s67, s40, 139264
  buffer_load_dword v35, v30, s[80:83], s67 offen
  s_add_u32 s67, s40, 16384
  buffer_load_dword v36, v30, s[80:83], s67 offen
  s_add_u32 s67, s40, 24576
  buffer_load_dword v37, v30, s[80:83], s67 offen
  s_add_u32 s67, s40, 147456
  buffer_load_dword v38, v30, s[80:83], s67 offen
  s_add_u32 s67, s40, 155648
  buffer_load_dword v39, v30, s[80:83], s67 offen
  s_add_u32 s67, s40, 524288
  buffer_load_dword v40, v30, s[80:83], s67 offen
  s_add_u32 s67, s40, 532480
  buffer_load_dword v41, v30, s[80:83], s67 offen
  s_add_u32 s67, s40, 655360
  buffer_load_dword v42, v30, s[80:83], s67 offen
  s_add_u32 s67, s40, 663552
  buffer_load_dword v43, v30, s[80:83], s67 offen
  s_add_u32 s67, s40, 540672
  buffer_load_dword v44, v30, s[80:83], s67 offen
  s_add_u32 s67, s40, 548864
  buffer_load_dword v45, v30, s[80:83], s67 offen
  s_add_u32 s67, s40, 671744
  buffer_load_dword v46, v30, s[80:83], s67 offen
  s_add_u32 s67, s40, 679936
  buffer_load_dword v47, v30, s[80:83], s67 offen
  s_add_u32 s67, s40, 32768
  buffer_load_dword v48, v30, s[80:83], s67 offen
  s_add_u32 s67, s40, 40960
  buffer_load_dword v49, v30, s[80:83], s67 offen
  s_add_u32 s67, s40, 163840
  buffer_load_dword v50, v30, s[80:83], s67 offen
  s_add_u32 s67, s40, 172032
  buffer_load_dword v51, v30, s[80:83], s67 offen
  s_add_u32 s67, s40, 49152
  buffer_load_dword v52, v30, s[80:83], s67 offen
  s_add_u32 s67, s40, 57344
  buffer_load_dword v53, v30, s[80:83], s67 offen
  s_add_u32 s67, s40, 180224
  buffer_load_dword v54, v30, s[80:83], s67 offen
  s_add_u32 s67, s40, 188416
  buffer_load_dword v55, v30, s[80:83], s67 offen
  s_add_u32 s67, s40, 557056
  buffer_load_dword v56, v30, s[80:83], s67 offen
  s_add_u32 s67, s40, 565248
  buffer_load_dword v57, v30, s[80:83], s67 offen
  s_add_u32 s67, s40, 688128
  buffer_load_dword v58, v30, s[80:83], s67 offen
  s_add_u32 s67, s40, 696320
  buffer_load_dword v59, v30, s[80:83], s67 offen
  s_add_u32 s67, s40, 573440
  buffer_load_dword v60, v30, s[80:83], s67 offen
  s_add_u32 s67, s40, 581632
  buffer_load_dword v61, v30, s[80:83], s67 offen
  s_add_u32 s67, s40, 704512
  buffer_load_dword v62, v30, s[80:83], s67 offen
  s_add_u32 s67, s40, 712704
  buffer_load_dword v63, v30, s[80:83], s67 offen
  s_add_u32 s67, s41, 0
  buffer_load_dword v64, v30, s[80:83], s67 offen
  s_add_u32 s67, s41, 8192
  buffer_load_dword v65, v30, s[80:83], s67 offen
  s_add_u32 s67, s41, 131072
  buffer_load_dword v66, v30, s[80:83], s67 offen
  s_add_u32 s67, s41, 139264
  buffer_load_dword v67, v30, s[80:83], s67 offen
  s_add_u32 s67, s41, 16384
  buffer_load_dword v68, v30, s[80:83], s67 offen
  s_add_u32 s67, s41, 24576
  buffer_load_dword v69, v30, s[80:83], s67 offen
  s_add_u32 s67, s41, 147456
  buffer_load_dword v70, v30, s[80:83], s67 offen
  s_add_u32 s67, s41, 155648
  buffer_load_dword v71, v30, s[80:83], s67 offen
  s_add_u32 s67, s41, 524288
  buffer_load_dword v72, v30, s[80:83], s67 offen
  s_add_u32 s67, s41, 532480
  buffer_load_dword v73, v30, s[80:83], s67 offen
  s_add_u32 s67, s41, 655360
  buffer_load_dword v74, v30, s[80:83], s67 offen
  s_add_u32 s67, s41, 663552
  buffer_load_dword v75, v30, s[80:83], s67 offen
  s_add_u32 s67, s41, 540672
  buffer_load_dword v76, v30, s[80:83], s67 offen
  s_add_u32 s67, s41, 548864
  buffer_load_dword v77, v30, s[80:83], s67 offen
  s_add_u32 s67, s41, 671744
  buffer_load_dword v78, v30, s[80:83], s67 offen
  s_add_u32 s67, s41, 679936
  buffer_load_dword v79, v30, s[80:83], s67 offen
  s_add_u32 s67, s41, 32768
  buffer_load_dword v80, v30, s[80:83], s67 offen
  s_add_u32 s67, s41, 40960
  buffer_load_dword v81, v30, s[80:83], s67 offen
  s_add_u32 s67, s41, 163840
  buffer_load_dword v82, v30, s[80:83], s67 offen
  s_add_u32 s67, s41, 172032
  buffer_load_dword v83, v30, s[80:83], s67 offen
  s_add_u32 s67, s41, 49152
  buffer_load_dword v84, v30, s[80:83], s67 offen
  s_add_u32 s67, s41, 57344
  buffer_load_dword v85, v30, s[80:83], s67 offen
  s_add_u32 s67, s41, 180224
  buffer_load_dword v86, v30, s[80:83], s67 offen
  s_add_u32 s67, s41, 188416
  buffer_load_dword v87, v30, s[80:83], s67 offen
  s_waitcnt vmcnt(54)
  v_perm_b32 v104, v33, v32, s78
  s_waitcnt vmcnt(52)
  v_perm_b32 v105, v35, v34, s78
  s_waitcnt vmcnt(50)
  v_perm_b32 v106, v37, v36, s78
  s_waitcnt vmcnt(48)
  v_perm_b32 v107, v39, v38, s78
  v_perm_b32 v108, v33, v32, s79
  v_perm_b32 v109, v35, v34, s79
  v_perm_b32 v110, v37, v36, s79
  v_perm_b32 v111, v39, v38, s79
  v_accvgpr_write_b32 a0, v104
  v_accvgpr_write_b32 a1, v105
  v_accvgpr_write_b32 a2, v106
  v_accvgpr_write_b32 a3, v107
  v_accvgpr_write_b32 a64, v108
  v_accvgpr_write_b32 a65, v109
  v_accvgpr_write_b32 a66, v110
  v_accvgpr_write_b32 a67, v111
  s_add_u32 s67, s41, 557056
  buffer_load_dword v88, v30, s[80:83], s67 offen
  s_add_u32 s67, s41, 565248
  buffer_load_dword v89, v30, s[80:83], s67 offen
  s_add_u32 s67, s41, 688128
  buffer_load_dword v90, v30, s[80:83], s67 offen
  s_add_u32 s67, s41, 696320
  buffer_load_dword v91, v30, s[80:83], s67 offen
  s_add_u32 s67, s41, 573440
  buffer_load_dword v92, v30, s[80:83], s67 offen
  s_add_u32 s67, s41, 581632
  buffer_load_dword v93, v30, s[80:83], s67 offen
  s_add_u32 s67, s41, 704512
  buffer_load_dword v94, v30, s[80:83], s67 offen
  s_add_u32 s67, s41, 712704
  buffer_load_dword v95, v30, s[80:83], s67 offen
  s_waitcnt vmcnt(54)
  v_perm_b32 v104, v41, v40, s78
  s_waitcnt vmcnt(52)
  v_perm_b32 v105, v43, v42, s78
  s_waitcnt vmcnt(50)
  v_perm_b32 v106, v45, v44, s78
  s_waitcnt vmcnt(48)
  v_perm_b32 v107, v47, v46, s78
  v_perm_b32 v108, v41, v40, s79
  v_perm_b32 v109, v43, v42, s79
  v_perm_b32 v110, v45, v44, s79
  v_perm_b32 v111, v47, v46, s79
  v_accvgpr_write_b32 a4, v104
  v_accvgpr_write_b32 a5, v105
  v_accvgpr_write_b32 a6, v106
  v_accvgpr_write_b32 a7, v107
  v_accvgpr_write_b32 a68, v108
  v_accvgpr_write_b32 a69, v109
  v_accvgpr_write_b32 a70, v110
  v_accvgpr_write_b32 a71, v111
  s_add_u32 s67, s42, 0
  buffer_load_dword v32, v30, s[80:83], s67 offen
  s_add_u32 s67, s42, 8192
  buffer_load_dword v33, v30, s[80:83], s67 offen
  s_add_u32 s67, s42, 131072
  buffer_load_dword v34, v30, s[80:83], s67 offen
  s_add_u32 s67, s42, 139264
  buffer_load_dword v35, v30, s[80:83], s67 offen
  s_add_u32 s67, s42, 16384
  buffer_load_dword v36, v30, s[80:83], s67 offen
  s_add_u32 s67, s42, 24576
  buffer_load_dword v37, v30, s[80:83], s67 offen
  s_add_u32 s67, s42, 147456
  buffer_load_dword v38, v30, s[80:83], s67 offen
  s_add_u32 s67, s42, 155648
  buffer_load_dword v39, v30, s[80:83], s67 offen
  s_waitcnt vmcnt(54)
  v_perm_b32 v104, v49, v48, s78
  s_waitcnt vmcnt(52)
  v_perm_b32 v105, v51, v50, s78
  s_waitcnt vmcnt(50)
  v_perm_b32 v106, v53, v52, s78
  s_waitcnt vmcnt(48)
  v_perm_b32 v107, v55, v54, s78
  v_perm_b32 v108, v49, v48, s79
  v_perm_b32 v109, v51, v50, s79
  v_perm_b32 v110, v53, v52, s79
  v_perm_b32 v111, v55, v54, s79
  v_accvgpr_write_b32 a8, v104
  v_accvgpr_write_b32 a9, v105
  v_accvgpr_write_b32 a10, v106
  v_accvgpr_write_b32 a11, v107
  v_accvgpr_write_b32 a72, v108
  v_accvgpr_write_b32 a73, v109
  v_accvgpr_write_b32 a74, v110
  v_accvgpr_write_b32 a75, v111
  s_add_u32 s67, s42, 524288
  buffer_load_dword v40, v30, s[80:83], s67 offen
  s_add_u32 s67, s42, 532480
  buffer_load_dword v41, v30, s[80:83], s67 offen
  s_add_u32 s67, s42, 655360
  buffer_load_dword v42, v30, s[80:83], s67 offen
  s_add_u32 s67, s42, 663552
  buffer_load_dword v43, v30, s[80:83], s67 offen
  s_add_u32 s67, s42, 540672
  buffer_load_dword v44, v30, s[80:83], s67 offen
  s_add_u32 s67, s42, 548864
  buffer_load_dword v45, v30, s[80:83], s67 offen
  s_add_u32 s67, s42, 671744
  buffer_load_dword v46, v30, s[80:83], s67 offen
  s_add_u32 s67, s42, 679936
  buffer_load_dword v47, v30, s[80:83], s67 offen
  s_waitcnt vmcnt(54)
  v_perm_b32 v104, v57, v56, s78
  s_waitcnt vmcnt(52)
  v_perm_b32 v105, v59, v58, s78
  s_waitcnt vmcnt(50)
  v_perm_b32 v106, v61, v60, s78
  s_waitcnt vmcnt(48)
  v_perm_b32 v107, v63, v62, s78
  v_perm_b32 v108, v57, v56, s79
  v_perm_b32 v109, v59, v58, s79
  v_perm_b32 v110, v61, v60, s79
  v_perm_b32 v111, v63, v62, s79
  v_accvgpr_write_b32 a12, v104
  v_accvgpr_write_b32 a13, v105
  v_accvgpr_write_b32 a14, v106
  v_accvgpr_write_b32 a15, v107
  v_accvgpr_write_b32 a76, v108
  v_accvgpr_write_b32 a77, v109
  v_accvgpr_write_b32 a78, v110
  v_accvgpr_write_b32 a79, v111
  s_add_u32 s67, s42, 32768
  buffer_load_dword v48, v30, s[80:83], s67 offen
  s_add_u32 s67, s42, 40960
  buffer_load_dword v49, v30, s[80:83], s67 offen
  s_add_u32 s67, s42, 163840
  buffer_load_dword v50, v30, s[80:83], s67 offen
  s_add_u32 s67, s42, 172032
  buffer_load_dword v51, v30, s[80:83], s67 offen
  s_add_u32 s67, s42, 49152
  buffer_load_dword v52, v30, s[80:83], s67 offen
  s_add_u32 s67, s42, 57344
  buffer_load_dword v53, v30, s[80:83], s67 offen
  s_add_u32 s67, s42, 180224
  buffer_load_dword v54, v30, s[80:83], s67 offen
  s_add_u32 s67, s42, 188416
  buffer_load_dword v55, v30, s[80:83], s67 offen
  s_waitcnt vmcnt(54)
  v_perm_b32 v104, v65, v64, s78
  s_waitcnt vmcnt(52)
  v_perm_b32 v105, v67, v66, s78
  s_waitcnt vmcnt(50)
  v_perm_b32 v106, v69, v68, s78
  s_waitcnt vmcnt(48)
  v_perm_b32 v107, v71, v70, s78
  v_perm_b32 v108, v65, v64, s79
  v_perm_b32 v109, v67, v66, s79
  v_perm_b32 v110, v69, v68, s79
  v_perm_b32 v111, v71, v70, s79
  v_accvgpr_write_b32 a16, v104
  v_accvgpr_write_b32 a17, v105
  v_accvgpr_write_b32 a18, v106
  v_accvgpr_write_b32 a19, v107
  v_accvgpr_write_b32 a80, v108
  v_accvgpr_write_b32 a81, v109
  v_accvgpr_write_b32 a82, v110
  v_accvgpr_write_b32 a83, v111
  s_add_u32 s67, s42, 557056
  buffer_load_dword v56, v30, s[80:83], s67 offen
  s_add_u32 s67, s42, 565248
  buffer_load_dword v57, v30, s[80:83], s67 offen
  s_add_u32 s67, s42, 688128
  buffer_load_dword v58, v30, s[80:83], s67 offen
  s_add_u32 s67, s42, 696320
  buffer_load_dword v59, v30, s[80:83], s67 offen
  s_add_u32 s67, s42, 573440
  buffer_load_dword v60, v30, s[80:83], s67 offen
  s_add_u32 s67, s42, 581632
  buffer_load_dword v61, v30, s[80:83], s67 offen
  s_add_u32 s67, s42, 704512
  buffer_load_dword v62, v30, s[80:83], s67 offen
  s_add_u32 s67, s42, 712704
  buffer_load_dword v63, v30, s[80:83], s67 offen
  s_waitcnt vmcnt(54)
  v_perm_b32 v104, v73, v72, s78
  s_waitcnt vmcnt(52)
  v_perm_b32 v105, v75, v74, s78
  s_waitcnt vmcnt(50)
  v_perm_b32 v106, v77, v76, s78
  s_waitcnt vmcnt(48)
  v_perm_b32 v107, v79, v78, s78
  v_perm_b32 v108, v73, v72, s79
  v_perm_b32 v109, v75, v74, s79
  v_perm_b32 v110, v77, v76, s79
  v_perm_b32 v111, v79, v78, s79
  v_accvgpr_write_b32 a20, v104
  v_accvgpr_write_b32 a21, v105
  v_accvgpr_write_b32 a22, v106
  v_accvgpr_write_b32 a23, v107
  v_accvgpr_write_b32 a84, v108
  v_accvgpr_write_b32 a85, v109
  v_accvgpr_write_b32 a86, v110
  v_accvgpr_write_b32 a87, v111
  s_add_u32 s67, s43, 0
  buffer_load_dword v64, v30, s[80:83], s67 offen
  s_add_u32 s67, s43, 8192
  buffer_load_dword v65, v30, s[80:83], s67 offen
  s_add_u32 s67, s43, 131072
  buffer_load_dword v66, v30, s[80:83], s67 offen
  s_add_u32 s67, s43, 139264
  buffer_load_dword v67, v30, s[80:83], s67 offen
  s_add_u32 s67, s43, 16384
  buffer_load_dword v68, v30, s[80:83], s67 offen
  s_add_u32 s67, s43, 24576
  buffer_load_dword v69, v30, s[80:83], s67 offen
  s_add_u32 s67, s43, 147456
  buffer_load_dword v70, v30, s[80:83], s67 offen
  s_add_u32 s67, s43, 155648
  buffer_load_dword v71, v30, s[80:83], s67 offen
  s_waitcnt vmcnt(54)
  v_perm_b32 v104, v81, v80, s78
  s_waitcnt vmcnt(52)
  v_perm_b32 v105, v83, v82, s78
  s_waitcnt vmcnt(50)
  v_perm_b32 v106, v85, v84, s78
  s_waitcnt vmcnt(48)
  v_perm_b32 v107, v87, v86, s78
  v_perm_b32 v108, v81, v80, s79
  v_perm_b32 v109, v83, v82, s79
  v_perm_b32 v110, v85, v84, s79
  v_perm_b32 v111, v87, v86, s79
  v_accvgpr_write_b32 a24, v104
  v_accvgpr_write_b32 a25, v105
  v_accvgpr_write_b32 a26, v106
  v_accvgpr_write_b32 a27, v107
  v_accvgpr_write_b32 a88, v108
  v_accvgpr_write_b32 a89, v109
  v_accvgpr_write_b32 a90, v110
  v_accvgpr_write_b32 a91, v111
  s_add_u32 s67, s43, 524288
  buffer_load_dword v72, v30, s[80:83], s67 offen
  s_add_u32 s67, s43, 532480
  buffer_load_dword v73, v30, s[80:83], s67 offen
  s_add_u32 s67, s43, 655360
  buffer_load_dword v74, v30, s[80:83], s67 offen
  s_add_u32 s67, s43, 663552
  buffer_load_dword v75, v30, s[80:83], s67 offen
  s_add_u32 s67, s43, 540672
  buffer_load_dword v76, v30, s[80:83], s67 offen
  s_add_u32 s67, s43, 548864
  buffer_load_dword v77, v30, s[80:83], s67 offen
  s_add_u32 s67, s43, 671744
  buffer_load_dword v78, v30, s[80:83], s67 offen
  s_add_u32 s67, s43, 679936
  buffer_load_dword v79, v30, s[80:83], s67 offen
  s_waitcnt vmcnt(54)
  v_perm_b32 v104, v89, v88, s78
  s_waitcnt vmcnt(52)
  v_perm_b32 v105, v91, v90, s78
  s_waitcnt vmcnt(50)
  v_perm_b32 v106, v93, v92, s78
  s_waitcnt vmcnt(48)
  v_perm_b32 v107, v95, v94, s78
  v_perm_b32 v108, v89, v88, s79
  v_perm_b32 v109, v91, v90, s79
  v_perm_b32 v110, v93, v92, s79
  v_perm_b32 v111, v95, v94, s79
  v_accvgpr_write_b32 a28, v104
  v_accvgpr_write_b32 a29, v105
  v_accvgpr_write_b32 a30, v106
  v_accvgpr_write_b32 a31, v107
  v_accvgpr_write_b32 a92, v108
  v_accvgpr_write_b32 a93, v109
  v_accvgpr_write_b32 a94, v110
  v_accvgpr_write_b32 a95, v111
  s_add_u32 s67, s43, 32768
  buffer_load_dword v80, v30, s[80:83], s67 offen
  s_add_u32 s67, s43, 40960
  buffer_load_dword v81, v30, s[80:83], s67 offen
  s_add_u32 s67, s43, 163840
  buffer_load_dword v82, v30, s[80:83], s67 offen
  s_add_u32 s67, s43, 172032
  buffer_load_dword v83, v30, s[80:83], s67 offen
  s_add_u32 s67, s43, 49152
  buffer_load_dword v84, v30, s[80:83], s67 offen
  s_add_u32 s67, s43, 57344
  buffer_load_dword v85, v30, s[80:83], s67 offen
  s_add_u32 s67, s43, 180224
  buffer_load_dword v86, v30, s[80:83], s67 offen
  s_add_u32 s67, s43, 188416
  buffer_load_dword v87, v30, s[80:83], s67 offen
  s_waitcnt vmcnt(54)
  v_perm_b32 v104, v33, v32, s78
  s_waitcnt vmcnt(52)
  v_perm_b32 v105, v35, v34, s78
  s_waitcnt vmcnt(50)
  v_perm_b32 v106, v37, v36, s78
  s_waitcnt vmcnt(48)
  v_perm_b32 v107, v39, v38, s78
  v_perm_b32 v108, v33, v32, s79
  v_perm_b32 v109, v35, v34, s79
  v_perm_b32 v110, v37, v36, s79
  v_perm_b32 v111, v39, v38, s79
  v_accvgpr_write_b32 a32, v104
  v_accvgpr_write_b32 a33, v105
  v_accvgpr_write_b32 a34, v106
  v_accvgpr_write_b32 a35, v107
  v_accvgpr_write_b32 a96, v108
  v_accvgpr_write_b32 a97, v109
  v_accvgpr_write_b32 a98, v110
  v_accvgpr_write_b32 a99, v111
  s_add_u32 s67, s43, 557056
  buffer_load_dword v88, v30, s[80:83], s67 offen
  s_add_u32 s67, s43, 565248
  buffer_load_dword v89, v30, s[80:83], s67 offen
  s_add_u32 s67, s43, 688128
  buffer_load_dword v90, v30, s[80:83], s67 offen
  s_add_u32 s67, s43, 696320
  buffer_load_dword v91, v30, s[80:83], s67 offen
  s_add_u32 s67, s43, 573440
  buffer_load_dword v92, v30, s[80:83], s67 offen
  s_add_u32 s67, s43, 581632
  buffer_load_dword v93, v30, s[80:83], s67 offen
  s_add_u32 s67, s43, 704512
  buffer_load_dword v94, v30, s[80:83], s67 offen
  s_add_u32 s67, s43, 712704
  buffer_load_dword v95, v30, s[80:83], s67 offen
  s_waitcnt vmcnt(54)
  v_perm_b32 v104, v41, v40, s78
  s_waitcnt vmcnt(52)
  v_perm_b32 v105, v43, v42, s78
  s_waitcnt vmcnt(50)
  v_perm_b32 v106, v45, v44, s78
  s_waitcnt vmcnt(48)
  v_perm_b32 v107, v47, v46, s78
  v_perm_b32 v108, v41, v40, s79
  v_perm_b32 v109, v43, v42, s79
  v_perm_b32 v110, v45, v44, s79
  v_perm_b32 v111, v47, v46, s79
  v_accvgpr_write_b32 a36, v104
  v_accvgpr_write_b32 a37, v105
  v_accvgpr_write_b32 a38, v106
  v_accvgpr_write_b32 a39, v107
  v_accvgpr_write_b32 a100, v108
  v_accvgpr_write_b32 a101, v109
  v_accvgpr_write_b32 a102, v110
  v_accvgpr_write_b32 a103, v111
  s_add_u32 s67, s44, 0
  buffer_load_dwordx4 v[32:35], v31, s[92:95], s67 offen
  s_add_u32 s67, s44, 1024
  buffer_load_dwordx4 v[36:39], v31, s[92:95], s67 offen
  s_waitcnt vmcnt(48)
  v_perm_b32 v104, v49, v48, s78
  s_waitcnt vmcnt(46)
  v_perm_b32 v105, v51, v50, s78
  s_waitcnt vmcnt(44)
  v_perm_b32 v106, v53, v52, s78
  s_waitcnt vmcnt(42)
  v_perm_b32 v107, v55, v54, s78
  v_perm_b32 v108, v49, v48, s79
  v_perm_b32 v109, v51, v50, s79
  v_perm_b32 v110, v53, v52, s79
  v_perm_b32 v111, v55, v54, s79
  v_accvgpr_write_b32 a40, v104
  v_accvgpr_write_b32 a41, v105
  v_accvgpr_write_b32 a42, v106
  v_accvgpr_write_b32 a43, v107
  v_accvgpr_write_b32 a104, v108
  v_accvgpr_write_b32 a105, v109
  v_accvgpr_write_b32 a106, v110
  v_accvgpr_write_b32 a107, v111
  s_add_u32 s67, s44, 2048
  buffer_load_dwordx4 v[40:43], v31, s[92:95], s67 offen
  s_add_u32 s67, s44, 3072
  buffer_load_dwordx4 v[44:47], v31, s[92:95], s67 offen
  s_waitcnt vmcnt(42)
  v_perm_b32 v104, v57, v56, s78
  s_waitcnt vmcnt(40)
  v_perm_b32 v105, v59, v58, s78
  s_waitcnt vmcnt(38)
  v_perm_b32 v106, v61, v60, s78
  s_waitcnt vmcnt(36)
  v_perm_b32 v107, v63, v62, s78
  v_perm_b32 v108, v57, v56, s79
  v_perm_b32 v109, v59, v58, s79
  v_perm_b32 v110, v61, v60, s79
  v_perm_b32 v111, v63, v62, s79
  v_accvgpr_write_b32 a44, v104
  v_accvgpr_write_b32 a45, v105
  v_accvgpr_write_b32 a46, v106
  v_accvgpr_write_b32 a47, v107
  v_accvgpr_write_b32 a108, v108
  v_accvgpr_write_b32 a109, v109
  v_accvgpr_write_b32 a110, v110
  v_accvgpr_write_b32 a111, v111
  s_add_u32 s67, s44, 16384
  buffer_load_dwordx4 v[48:51], v31, s[92:95], s67 offen
  s_add_u32 s67, s44, 17408
  buffer_load_dwordx4 v[52:55], v31, s[92:95], s67 offen
  s_waitcnt vmcnt(36)
  v_perm_b32 v104, v65, v64, s78
  s_waitcnt vmcnt(34)
  v_perm_b32 v105, v67, v66, s78
  s_waitcnt vmcnt(32)
  v_perm_b32 v106, v69, v68, s78
  s_waitcnt vmcnt(30)
  v_perm_b32 v107, v71, v70, s78
  v_perm_b32 v108, v65, v64, s79
  v_perm_b32 v109, v67, v66, s79
  v_perm_b32 v110, v69, v68, s79
  v_perm_b32 v111, v71, v70, s79
  v_accvgpr_write_b32 a48, v104
  v_accvgpr_write_b32 a49, v105
  v_accvgpr_write_b32 a50, v106
  v_accvgpr_write_b32 a51, v107
  v_accvgpr_write_b32 a112, v108
  v_accvgpr_write_b32 a113, v109
  v_accvgpr_write_b32 a114, v110
  v_accvgpr_write_b32 a115, v111
  s_add_u32 s67, s44, 18432
  buffer_load_dwordx4 v[56:59], v31, s[92:95], s67 offen
  s_add_u32 s67, s44, 19456
  buffer_load_dwordx4 v[60:63], v31, s[92:95], s67 offen
  s_waitcnt vmcnt(30)
  v_perm_b32 v104, v73, v72, s78
  s_waitcnt vmcnt(28)
  v_perm_b32 v105, v75, v74, s78
  s_waitcnt vmcnt(26)
  v_perm_b32 v106, v77, v76, s78
  s_waitcnt vmcnt(24)
  v_perm_b32 v107, v79, v78, s78
  v_perm_b32 v108, v73, v72, s79
  v_perm_b32 v109, v75, v74, s79
  v_perm_b32 v110, v77, v76, s79
  v_perm_b32 v111, v79, v78, s79
  v_accvgpr_write_b32 a52, v104
  v_accvgpr_write_b32 a53, v105
  v_accvgpr_write_b32 a54, v106
  v_accvgpr_write_b32 a55, v107
  v_accvgpr_write_b32 a116, v108
  v_accvgpr_write_b32 a117, v109
  v_accvgpr_write_b32 a118, v110
  v_accvgpr_write_b32 a119, v111
  s_add_u32 s67, s45, 0
  buffer_load_dwordx4 v[64:67], v31, s[92:95], s67 offen
  s_add_u32 s67, s45, 1024
  buffer_load_dwordx4 v[68:71], v31, s[92:95], s67 offen
  s_waitcnt vmcnt(24)
  v_perm_b32 v104, v81, v80, s78
  s_waitcnt vmcnt(22)
  v_perm_b32 v105, v83, v82, s78
  s_waitcnt vmcnt(20)
  v_perm_b32 v106, v85, v84, s78
  s_waitcnt vmcnt(18)
  v_perm_b32 v107, v87, v86, s78
  v_perm_b32 v108, v81, v80, s79
  v_perm_b32 v109, v83, v82, s79
  v_perm_b32 v110, v85, v84, s79
  v_perm_b32 v111, v87, v86, s79
  v_accvgpr_write_b32 a56, v104
  v_accvgpr_write_b32 a57, v105
  v_accvgpr_write_b32 a58, v106
  v_accvgpr_write_b32 a59, v107
  v_accvgpr_write_b32 a120, v108
  v_accvgpr_write_b32 a121, v109
  v_accvgpr_write_b32 a122, v110
  v_accvgpr_write_b32 a123, v111
  s_add_u32 s67, s45, 2048
  buffer_load_dwordx4 v[72:75], v31, s[92:95], s67 offen
  s_add_u32 s67, s45, 3072
  buffer_load_dwordx4 v[76:79], v31, s[92:95], s67 offen
  s_waitcnt vmcnt(18)
  v_perm_b32 v104, v89, v88, s78
  s_waitcnt vmcnt(16)
  v_perm_b32 v105, v91, v90, s78
  s_waitcnt vmcnt(14)
  v_perm_b32 v106, v93, v92, s78
  s_waitcnt vmcnt(12)
  v_perm_b32 v107, v95, v94, s78
  v_perm_b32 v108, v89, v88, s79
  v_perm_b32 v109, v91, v90, s79
  v_perm_b32 v110, v93, v92, s79
  v_perm_b32 v111, v95, v94, s79
  v_accvgpr_write_b32 a60, v104
  v_accvgpr_write_b32 a61, v105
  v_accvgpr_write_b32 a62, v106
  v_accvgpr_write_b32 a63, v107
  v_accvgpr_write_b32 a124, v108
  v_accvgpr_write_b32 a125, v109
  v_accvgpr_write_b32 a126, v110
  v_accvgpr_write_b32 a127, v111
  s_add_u32 s67, s45, 16384
  buffer_load_dwordx4 v[80:83], v31, s[92:95], s67 offen
  s_add_u32 s67, s45, 17408
  buffer_load_dwordx4 v[84:87], v31, s[92:95], s67 offen
  s_waitcnt vmcnt(12)
  v_perm_b32 v128, v36, v32, s78
  v_perm_b32 v160, v37, v33, s78
  v_perm_b32 v192, v38, v34, s78
  v_perm_b32 v224, v39, v35, s78
  v_perm_b32 v129, v36, v32, s79
  v_perm_b32 v161, v37, v33, s79
  v_perm_b32 v193, v38, v34, s79
  v_perm_b32 v225, v39, v35, s79
  s_add_u32 s67, s45, 18432
  buffer_load_dwordx4 v[88:91], v31, s[92:95], s67 offen
  s_add_u32 s67, s45, 19456
  buffer_load_dwordx4 v[92:95], v31, s[92:95], s67 offen
  s_waitcnt vmcnt(12)
  v_perm_b32 v130, v44, v40, s78
  v_perm_b32 v162, v45, v41, s78
  v_perm_b32 v194, v46, v42, s78
  v_perm_b32 v226, v47, v43, s78
  v_perm_b32 v131, v44, v40, s79
  v_perm_b32 v163, v45, v41, s79
  v_perm_b32 v195, v46, v42, s79
  v_perm_b32 v227, v47, v43, s79
  s_add_u32 s67, s46, 0
  buffer_load_dwordx4 v[32:35], v31, s[92:95], s67 offen
  s_add_u32 s67, s46, 1024
  buffer_load_dwordx4 v[36:39], v31, s[92:95], s67 offen
  s_waitcnt vmcnt(12)
  v_perm_b32 v132, v52, v48, s78
  v_perm_b32 v164, v53, v49, s78
  v_perm_b32 v196, v54, v50, s78
  v_perm_b32 v228, v55, v51, s78
  v_perm_b32 v133, v52, v48, s79
  v_perm_b32 v165, v53, v49, s79
  v_perm_b32 v197, v54, v50, s79
  v_perm_b32 v229, v55, v51, s79
  s_add_u32 s67, s46, 2048
  buffer_load_dwordx4 v[40:43], v31, s[92:95], s67 offen
  s_add_u32 s67, s46, 3072
  buffer_load_dwordx4 v[44:47], v31, s[92:95], s67 offen
  s_waitcnt vmcnt(12)
  v_perm_b32 v134, v60, v56, s78
  v_perm_b32 v166, v61, v57, s78
  v_perm_b32 v198, v62, v58, s78
  v_perm_b32 v230, v63, v59, s78
  v_perm_b32 v135, v60, v56, s79
  v_perm_b32 v167, v61, v57, s79
  v_perm_b32 v199, v62, v58, s79
  v_perm_b32 v231, v63, v59, s79
  s_add_u32 s67, s46, 16384
  buffer_load_dwordx4 v[48:51], v31, s[92:95], s67 offen
  s_add_u32 s67, s46, 17408
  buffer_load_dwordx4 v[52:55], v31, s[92:95], s67 offen
  s_waitcnt vmcnt(12)
  v_perm_b32 v136, v68, v64, s78
  v_perm_b32 v168, v69, v65, s78
  v_perm_b32 v200, v70, v66, s78
  v_perm_b32 v232, v71, v67, s78
  v_perm_b32 v137, v68, v64, s79
  v_perm_b32 v169, v69, v65, s79
  v_perm_b32 v201, v70, v66, s79
  v_perm_b32 v233, v71, v67, s79
  s_add_u32 s67, s46, 18432
  buffer_load_dwordx4 v[56:59], v31, s[92:95], s67 offen
  s_add_u32 s67, s46, 19456
  buffer_load_dwordx4 v[60:63], v31, s[92:95], s67 offen
  s_waitcnt vmcnt(12)
  v_perm_b32 v138, v76, v72, s78
  v_perm_b32 v170, v77, v73, s78
  v_perm_b32 v202, v78, v74, s78
  v_perm_b32 v234, v79, v75, s78
  v_perm_b32 v139, v76, v72, s79
  v_perm_b32 v171, v77, v73, s79
  v_perm_b32 v203, v78, v74, s79
  v_perm_b32 v235, v79, v75, s79
  s_add_u32 s67, s47, 0
  buffer_load_dwordx4 v[64:67], v31, s[92:95], s67 offen
  s_add_u32 s67, s47, 1024
  buffer_load_dwordx4 v[68:71], v31, s[92:95], s67 offen
  s_waitcnt vmcnt(12)
  v_perm_b32 v140, v84, v80, s78
  v_perm_b32 v172, v85, v81, s78
  v_perm_b32 v204, v86, v82, s78
  v_perm_b32 v236, v87, v83, s78
  v_perm_b32 v141, v84, v80, s79
  v_perm_b32 v173, v85, v81, s79
  v_perm_b32 v205, v86, v82, s79
  v_perm_b32 v237, v87, v83, s79
  s_add_u32 s67, s47, 2048
  buffer_load_dwordx4 v[72:75], v31, s[92:95], s67 offen
  s_add_u32 s67, s47, 3072
  buffer_load_dwordx4 v[76:79], v31, s[92:95], s67 offen
  s_waitcnt vmcnt(12)
  v_perm_b32 v142, v92, v88, s78
  v_perm_b32 v174, v93, v89, s78
  v_perm_b32 v206, v94, v90, s78
  v_perm_b32 v238, v95, v91, s78
  v_perm_b32 v143, v92, v88, s79
  v_perm_b32 v175, v93, v89, s79
  v_perm_b32 v207, v94, v90, s79
  v_perm_b32 v239, v95, v91, s79
  s_add_u32 s67, s47, 16384
  buffer_load_dwordx4 v[80:83], v31, s[92:95], s67 offen
  s_add_u32 s67, s47, 17408
  buffer_load_dwordx4 v[84:87], v31, s[92:95], s67 offen
  s_waitcnt vmcnt(12)
  v_perm_b32 v144, v36, v32, s78
  v_perm_b32 v176, v37, v33, s78
  v_perm_b32 v208, v38, v34, s78
  v_perm_b32 v240, v39, v35, s78
  v_perm_b32 v145, v36, v32, s79
  v_perm_b32 v177, v37, v33, s79
  v_perm_b32 v209, v38, v34, s79
  v_perm_b32 v241, v39, v35, s79
  s_add_u32 s67, s47, 18432
  buffer_load_dwordx4 v[88:91], v31, s[92:95], s67 offen
  s_add_u32 s67, s47, 19456
  buffer_load_dwordx4 v[92:95], v31, s[92:95], s67 offen
  s_waitcnt vmcnt(12)
  v_perm_b32 v146, v44, v40, s78
  v_perm_b32 v178, v45, v41, s78
  v_perm_b32 v210, v46, v42, s78
  v_perm_b32 v242, v47, v43, s78
  v_perm_b32 v147, v44, v40, s79
  v_perm_b32 v179, v45, v41, s79
  v_perm_b32 v211, v46, v42, s79
  v_perm_b32 v243, v47, v43, s79
  s_add_u32 s67, s40, 0
  buffer_load_dword v32, v30, s[84:87], s67 offen
  s_add_u32 s67, s40, 8192
  buffer_load_dword v33, v30, s[84:87], s67 offen
  s_add_u32 s67, s40, 131072
  buffer_load_dword v34, v30, s[84:87], s67 offen
  s_add_u32 s67, s40, 139264
  buffer_load_dword v35, v30, s[84:87], s67 offen
  s_add_u32 s67, s40, 16384
  buffer_load_dword v36, v30, s[84:87], s67 offen
  s_add_u32 s67, s40, 24576
  buffer_load_dword v37, v30, s[84:87], s67 offen
  s_add_u32 s67, s40, 147456
  buffer_load_dword v38, v30, s[84:87], s67 offen
  s_add_u32 s67, s40, 155648
  buffer_load_dword v39, v30, s[84:87], s67 offen
  s_waitcnt vmcnt(18)
  v_perm_b32 v148, v52, v48, s78
  v_perm_b32 v180, v53, v49, s78
  v_perm_b32 v212, v54, v50, s78
  v_perm_b32 v244, v55, v51, s78
  v_perm_b32 v149, v52, v48, s79
  v_perm_b32 v181, v53, v49, s79
  v_perm_b32 v213, v54, v50, s79
  v_perm_b32 v245, v55, v51, s79
  s_add_u32 s67, s40, 524288
  buffer_load_dword v40, v30, s[84:87], s67 offen
  s_add_u32 s67, s40, 532480
  buffer_load_dword v41, v30, s[84:87], s67 offen
  s_add_u32 s67, s40, 655360
  buffer_load_dword v42, v30, s[84:87], s67 offen
  s_add_u32 s67, s40, 663552
  buffer_load_dword v43, v30, s[84:87], s67 offen
  s_add_u32 s67, s40, 540672
  buffer_load_dword v44, v30, s[84:87], s67 offen
  s_add_u32 s67, s40, 548864
  buffer_load_dword v45, v30, s[84:87], s67 offen
  s_add_u32 s67, s40, 671744
  buffer_load_dword v46, v30, s[84:87], s67 offen
  s_add_u32 s67, s40, 679936
  buffer_load_dword v47, v30, s[84:87], s67 offen
  s_waitcnt vmcnt(24)
  v_perm_b32 v150, v60, v56, s78
  v_perm_b32 v182, v61, v57, s78
  v_perm_b32 v214, v62, v58, s78
  v_perm_b32 v246, v63, v59, s78
  v_perm_b32 v151, v60, v56, s79
  v_perm_b32 v183, v61, v57, s79
  v_perm_b32 v215, v62, v58, s79
  v_perm_b32 v247, v63, v59, s79
  s_add_u32 s67, s40, 32768
  buffer_load_dword v48, v30, s[84:87], s67 offen
  s_add_u32 s67, s40, 40960
  buffer_load_dword v49, v30, s[84:87], s67 offen
  s_add_u32 s67, s40, 163840
  buffer_load_dword v50, v30, s[84:87], s67 offen
  s_add_u32 s67, s40, 172032
  buffer_load_dword v51, v30, s[84:87], s67 offen
  s_add_u32 s67, s40, 49152
  buffer_load_dword v52, v30, s[84:87], s67 offen
  s_add_u32 s67, s40, 57344
  buffer_load_dword v53, v30, s[84:87], s67 offen
  s_add_u32 s67, s40, 180224
  buffer_load_dword v54, v30, s[84:87], s67 offen
  s_add_u32 s67, s40, 188416
  buffer_load_dword v55, v30, s[84:87], s67 offen
  s_waitcnt vmcnt(30)
  v_perm_b32 v152, v68, v64, s78
  v_perm_b32 v184, v69, v65, s78
  v_perm_b32 v216, v70, v66, s78
  v_perm_b32 v248, v71, v67, s78
  v_perm_b32 v153, v68, v64, s79
  v_perm_b32 v185, v69, v65, s79
  v_perm_b32 v217, v70, v66, s79
  v_perm_b32 v249, v71, v67, s79
  s_add_u32 s67, s40, 557056
  buffer_load_dword v56, v30, s[84:87], s67 offen
  s_add_u32 s67, s40, 565248
  buffer_load_dword v57, v30, s[84:87], s67 offen
  s_add_u32 s67, s40, 688128
  buffer_load_dword v58, v30, s[84:87], s67 offen
  s_add_u32 s67, s40, 696320
  buffer_load_dword v59, v30, s[84:87], s67 offen
  s_add_u32 s67, s40, 573440
  buffer_load_dword v60, v30, s[84:87], s67 offen
  s_add_u32 s67, s40, 581632
  buffer_load_dword v61, v30, s[84:87], s67 offen
  s_add_u32 s67, s40, 704512
  buffer_load_dword v62, v30, s[84:87], s67 offen
  s_add_u32 s67, s40, 712704
  buffer_load_dword v63, v30, s[84:87], s67 offen
  s_waitcnt vmcnt(36)
  v_perm_b32 v154, v76, v72, s78
  v_perm_b32 v186, v77, v73, s78
  v_perm_b32 v218, v78, v74, s78
  v_perm_b32 v250, v79, v75, s78
  v_perm_b32 v155, v76, v72, s79
  v_perm_b32 v187, v77, v73, s79
  v_perm_b32 v219, v78, v74, s79
  v_perm_b32 v251, v79, v75, s79
  s_add_u32 s67, s41, 0
  buffer_load_dword v64, v30, s[84:87], s67 offen
  s_add_u32 s67, s41, 8192
  buffer_load_dword v65, v30, s[84:87], s67 offen
  s_add_u32 s67, s41, 131072
  buffer_load_dword v66, v30, s[84:87], s67 offen
  s_add_u32 s67, s41, 139264
  buffer_load_dword v67, v30, s[84:87], s67 offen
  s_add_u32 s67, s41, 16384
  buffer_load_dword v68, v30, s[84:87], s67 offen
  s_add_u32 s67, s41, 24576
  buffer_load_dword v69, v30, s[84:87], s67 offen
  s_add_u32 s67, s41, 147456
  buffer_load_dword v70, v30, s[84:87], s67 offen
  s_add_u32 s67, s41, 155648
  buffer_load_dword v71, v30, s[84:87], s67 offen
  s_waitcnt vmcnt(42)
  v_perm_b32 v156, v84, v80, s78
  v_perm_b32 v188, v85, v81, s78
  v_perm_b32 v220, v86, v82, s78
  v_perm_b32 v252, v87, v83, s78
  v_perm_b32 v157, v84, v80, s79
  v_perm_b32 v189, v85, v81, s79
  v_perm_b32 v221, v86, v82, s79
  v_perm_b32 v253, v87, v83, s79
  s_add_u32 s67, s41, 524288
  buffer_load_dword v72, v30, s[84:87], s67 offen
  s_add_u32 s67, s41, 532480
  buffer_load_dword v73, v30, s[84:87], s67 offen
  s_add_u32 s67, s41, 655360
  buffer_load_dword v74, v30, s[84:87], s67 offen
  s_add_u32 s67, s41, 663552
  buffer_load_dword v75, v30, s[84:87], s67 offen
  s_add_u32 s67, s41, 540672
  buffer_load_dword v76, v30, s[84:87], s67 offen
  s_add_u32 s67, s41, 548864
  buffer_load_dword v77, v30, s[84:87], s67 offen
  s_add_u32 s67, s41, 671744
  buffer_load_dword v78, v30, s[84:87], s67 offen
  s_add_u32 s67, s41, 679936
  buffer_load_dword v79, v30, s[84:87], s67 offen
  s_waitcnt vmcnt(48)
  v_perm_b32 v158, v92, v88, s78
  v_perm_b32 v190, v93, v89, s78
  v_perm_b32 v222, v94, v90, s78
  v_perm_b32 v254, v95, v91, s78
  v_perm_b32 v159, v92, v88, s79
  v_perm_b32 v191, v93, v89, s79
  v_perm_b32 v223, v94, v90, s79
  v_perm_b32 v255, v95, v91, s79
  s_add_u32 s67, s41, 32768
  buffer_load_dword v80, v30, s[84:87], s67 offen
  s_add_u32 s67, s41, 40960
  buffer_load_dword v81, v30, s[84:87], s67 offen
  s_add_u32 s67, s41, 163840
  buffer_load_dword v82, v30, s[84:87], s67 offen
  s_add_u32 s67, s41, 172032
  buffer_load_dword v83, v30, s[84:87], s67 offen
  s_add_u32 s67, s41, 49152
  buffer_load_dword v84, v30, s[84:87], s67 offen
  s_add_u32 s67, s41, 57344
  buffer_load_dword v85, v30, s[84:87], s67 offen
  s_add_u32 s67, s41, 180224
  buffer_load_dword v86, v30, s[84:87], s67 offen
  s_add_u32 s67, s41, 188416
  buffer_load_dword v87, v30, s[84:87], s67 offen
  s_waitcnt vmcnt(54)
  v_perm_b32 v104, v33, v32, s78
  s_waitcnt vmcnt(52)
  v_perm_b32 v105, v35, v34, s78
  s_waitcnt vmcnt(50)
  v_perm_b32 v106, v37, v36, s78
  s_waitcnt vmcnt(48)
  v_perm_b32 v107, v39, v38, s78
  v_perm_b32 v108, v33, v32, s79
  v_perm_b32 v109, v35, v34, s79
  v_perm_b32 v110, v37, v36, s79
  v_perm_b32 v111, v39, v38, s79
  v_accvgpr_write_b32 a128, v104
  v_accvgpr_write_b32 a129, v105
  v_accvgpr_write_b32 a130, v106
  v_accvgpr_write_b32 a131, v107
  v_accvgpr_write_b32 a192, v108
  v_accvgpr_write_b32 a193, v109
  v_accvgpr_write_b32 a194, v110
  v_accvgpr_write_b32 a195, v111
  s_add_u32 s67, s41, 557056
  buffer_load_dword v88, v30, s[84:87], s67 offen
  s_add_u32 s67, s41, 565248
  buffer_load_dword v89, v30, s[84:87], s67 offen
  s_add_u32 s67, s41, 688128
  buffer_load_dword v90, v30, s[84:87], s67 offen
  s_add_u32 s67, s41, 696320
  buffer_load_dword v91, v30, s[84:87], s67 offen
  s_add_u32 s67, s41, 573440
  buffer_load_dword v92, v30, s[84:87], s67 offen
  s_add_u32 s67, s41, 581632
  buffer_load_dword v93, v30, s[84:87], s67 offen
  s_add_u32 s67, s41, 704512
  buffer_load_dword v94, v30, s[84:87], s67 offen
  s_add_u32 s67, s41, 712704
  buffer_load_dword v95, v30, s[84:87], s67 offen
  s_waitcnt vmcnt(54)
  v_perm_b32 v104, v41, v40, s78
  s_waitcnt vmcnt(52)
  v_perm_b32 v105, v43, v42, s78
  s_waitcnt vmcnt(50)
  v_perm_b32 v106, v45, v44, s78
  s_waitcnt vmcnt(48)
  v_perm_b32 v107, v47, v46, s78
  v_perm_b32 v108, v41, v40, s79
  v_perm_b32 v109, v43, v42, s79
  v_perm_b32 v110, v45, v44, s79
  v_perm_b32 v111, v47, v46, s79
  v_accvgpr_write_b32 a132, v104
  v_accvgpr_write_b32 a133, v105
  v_accvgpr_write_b32 a134, v106
  v_accvgpr_write_b32 a135, v107
  v_accvgpr_write_b32 a196, v108
  v_accvgpr_write_b32 a197, v109
  v_accvgpr_write_b32 a198, v110
  v_accvgpr_write_b32 a199, v111
  s_add_u32 s67, s42, 0
  buffer_load_dword v32, v30, s[84:87], s67 offen
  s_add_u32 s67, s42, 8192
  buffer_load_dword v33, v30, s[84:87], s67 offen
  s_add_u32 s67, s42, 131072
  buffer_load_dword v34, v30, s[84:87], s67 offen
  s_add_u32 s67, s42, 139264
  buffer_load_dword v35, v30, s[84:87], s67 offen
  s_add_u32 s67, s42, 16384
  buffer_load_dword v36, v30, s[84:87], s67 offen
  s_add_u32 s67, s42, 24576
  buffer_load_dword v37, v30, s[84:87], s67 offen
  s_add_u32 s67, s42, 147456
  buffer_load_dword v38, v30, s[84:87], s67 offen
  s_add_u32 s67, s42, 155648
  buffer_load_dword v39, v30, s[84:87], s67 offen
  s_waitcnt vmcnt(54)
  v_perm_b32 v104, v49, v48, s78
  s_waitcnt vmcnt(52)
  v_perm_b32 v105, v51, v50, s78
  s_waitcnt vmcnt(50)
  v_perm_b32 v106, v53, v52, s78
  s_waitcnt vmcnt(48)
  v_perm_b32 v107, v55, v54, s78
  v_perm_b32 v108, v49, v48, s79
  v_perm_b32 v109, v51, v50, s79
  v_perm_b32 v110, v53, v52, s79
  v_perm_b32 v111, v55, v54, s79
  v_accvgpr_write_b32 a136, v104
  v_accvgpr_write_b32 a137, v105
  v_accvgpr_write_b32 a138, v106
  v_accvgpr_write_b32 a139, v107
  v_accvgpr_write_b32 a200, v108
  v_accvgpr_write_b32 a201, v109
  v_accvgpr_write_b32 a202, v110
  v_accvgpr_write_b32 a203, v111
  s_add_u32 s67, s42, 524288
  buffer_load_dword v40, v30, s[84:87], s67 offen
  s_add_u32 s67, s42, 532480
  buffer_load_dword v41, v30, s[84:87], s67 offen
  s_add_u32 s67, s42, 655360
  buffer_load_dword v42, v30, s[84:87], s67 offen
  s_add_u32 s67, s42, 663552
  buffer_load_dword v43, v30, s[84:87], s67 offen
  s_add_u32 s67, s42, 540672
  buffer_load_dword v44, v30, s[84:87], s67 offen
  s_add_u32 s67, s42, 548864
  buffer_load_dword v45, v30, s[84:87], s67 offen
  s_add_u32 s67, s42, 671744
  buffer_load_dword v46, v30, s[84:87], s67 offen
  s_add_u32 s67, s42, 679936
  buffer_load_dword v47, v30, s[84:87], s67 offen
  s_waitcnt vmcnt(54)
  v_perm_b32 v104, v57, v56, s78
  s_waitcnt vmcnt(52)
  v_perm_b32 v105, v59, v58, s78
  s_waitcnt vmcnt(50)
  v_perm_b32 v106, v61, v60, s78
  s_waitcnt vmcnt(48)
  v_perm_b32 v107, v63, v62, s78
  v_perm_b32 v108, v57, v56, s79
  v_perm_b32 v109, v59, v58, s79
  v_perm_b32 v110, v61, v60, s79
  v_perm_b32 v111, v63, v62, s79
  v_accvgpr_write_b32 a140, v104
  v_accvgpr_write_b32 a141, v105
  v_accvgpr_write_b32 a142, v106
  v_accvgpr_write_b32 a143, v107
  v_accvgpr_write_b32 a204, v108
  v_accvgpr_write_b32 a205, v109
  v_accvgpr_write_b32 a206, v110
  v_accvgpr_write_b32 a207, v111
  s_add_u32 s67, s42, 32768
  buffer_load_dword v48, v30, s[84:87], s67 offen
  s_add_u32 s67, s42, 40960
  buffer_load_dword v49, v30, s[84:87], s67 offen
  s_add_u32 s67, s42, 163840
  buffer_load_dword v50, v30, s[84:87], s67 offen
  s_add_u32 s67, s42, 172032
  buffer_load_dword v51, v30, s[84:87], s67 offen
  s_add_u32 s67, s42, 49152
  buffer_load_dword v52, v30, s[84:87], s67 offen
  s_add_u32 s67, s42, 57344
  buffer_load_dword v53, v30, s[84:87], s67 offen
  s_add_u32 s67, s42, 180224
  buffer_load_dword v54, v30, s[84:87], s67 offen
  s_add_u32 s67, s42, 188416
  buffer_load_dword v55, v30, s[84:87], s67 offen
  s_waitcnt vmcnt(54)
  v_perm_b32 v104, v65, v64, s78
  s_waitcnt vmcnt(52)
  v_perm_b32 v105, v67, v66, s78
  s_waitcnt vmcnt(50)
  v_perm_b32 v106, v69, v68, s78
  s_waitcnt vmcnt(48)
  v_perm_b32 v107, v71, v70, s78
  v_perm_b32 v108, v65, v64, s79
  v_perm_b32 v109, v67, v66, s79
  v_perm_b32 v110, v69, v68, s79
  v_perm_b32 v111, v71, v70, s79
  v_accvgpr_write_b32 a144, v104
  v_accvgpr_write_b32 a145, v105
  v_accvgpr_write_b32 a146, v106
  v_accvgpr_write_b32 a147, v107
  v_accvgpr_write_b32 a208, v108
  v_accvgpr_write_b32 a209, v109
  v_accvgpr_write_b32 a210, v110
  v_accvgpr_write_b32 a211, v111
  s_add_u32 s67, s42, 557056
  buffer_load_dword v56, v30, s[84:87], s67 offen
  s_add_u32 s67, s42, 565248
  buffer_load_dword v57, v30, s[84:87], s67 offen
  s_add_u32 s67, s42, 688128
  buffer_load_dword v58, v30, s[84:87], s67 offen
  s_add_u32 s67, s42, 696320
  buffer_load_dword v59, v30, s[84:87], s67 offen
  s_add_u32 s67, s42, 573440
  buffer_load_dword v60, v30, s[84:87], s67 offen
  s_add_u32 s67, s42, 581632
  buffer_load_dword v61, v30, s[84:87], s67 offen
  s_add_u32 s67, s42, 704512
  buffer_load_dword v62, v30, s[84:87], s67 offen
  s_add_u32 s67, s42, 712704
  buffer_load_dword v63, v30, s[84:87], s67 offen
  s_waitcnt vmcnt(54)
  v_perm_b32 v104, v73, v72, s78
  s_waitcnt vmcnt(52)
  v_perm_b32 v105, v75, v74, s78
  s_waitcnt vmcnt(50)
  v_perm_b32 v106, v77, v76, s78
  s_waitcnt vmcnt(48)
  v_perm_b32 v107, v79, v78, s78
  v_perm_b32 v108, v73, v72, s79
  v_perm_b32 v109, v75, v74, s79
  v_perm_b32 v110, v77, v76, s79
  v_perm_b32 v111, v79, v78, s79
  v_accvgpr_write_b32 a148, v104
  v_accvgpr_write_b32 a149, v105
  v_accvgpr_write_b32 a150, v106
  v_accvgpr_write_b32 a151, v107
  v_accvgpr_write_b32 a212, v108
  v_accvgpr_write_b32 a213, v109
  v_accvgpr_write_b32 a214, v110
  v_accvgpr_write_b32 a215, v111
  s_add_u32 s67, s43, 0
  buffer_load_dword v64, v30, s[84:87], s67 offen
  s_add_u32 s67, s43, 8192
  buffer_load_dword v65, v30, s[84:87], s67 offen
  s_add_u32 s67, s43, 131072
  buffer_load_dword v66, v30, s[84:87], s67 offen
  s_add_u32 s67, s43, 139264
  buffer_load_dword v67, v30, s[84:87], s67 offen
  s_add_u32 s67, s43, 16384
  buffer_load_dword v68, v30, s[84:87], s67 offen
  s_add_u32 s67, s43, 24576
  buffer_load_dword v69, v30, s[84:87], s67 offen
  s_add_u32 s67, s43, 147456
  buffer_load_dword v70, v30, s[84:87], s67 offen
  s_add_u32 s67, s43, 155648
  buffer_load_dword v71, v30, s[84:87], s67 offen
  s_waitcnt vmcnt(54)
  v_perm_b32 v104, v81, v80, s78
  s_waitcnt vmcnt(52)
  v_perm_b32 v105, v83, v82, s78
  s_waitcnt vmcnt(50)
  v_perm_b32 v106, v85, v84, s78
  s_waitcnt vmcnt(48)
  v_perm_b32 v107, v87, v86, s78
  v_perm_b32 v108, v81, v80, s79
  v_perm_b32 v109, v83, v82, s79
  v_perm_b32 v110, v85, v84, s79
  v_perm_b32 v111, v87, v86, s79
  v_accvgpr_write_b32 a152, v104
  v_accvgpr_write_b32 a153, v105
  v_accvgpr_write_b32 a154, v106
  v_accvgpr_write_b32 a155, v107
  v_accvgpr_write_b32 a216, v108
  v_accvgpr_write_b32 a217, v109
  v_accvgpr_write_b32 a218, v110
  v_accvgpr_write_b32 a219, v111
  s_add_u32 s67, s43, 524288
  buffer_load_dword v72, v30, s[84:87], s67 offen
  s_add_u32 s67, s43, 532480
  buffer_load_dword v73, v30, s[84:87], s67 offen
  s_add_u32 s67, s43, 655360
  buffer_load_dword v74, v30, s[84:87], s67 offen
  s_add_u32 s67, s43, 663552
  buffer_load_dword v75, v30, s[84:87], s67 offen
  s_add_u32 s67, s43, 540672
  buffer_load_dword v76, v30, s[84:87], s67 offen
  s_add_u32 s67, s43, 548864
  buffer_load_dword v77, v30, s[84:87], s67 offen
  s_add_u32 s67, s43, 671744
  buffer_load_dword v78, v30, s[84:87], s67 offen
  s_add_u32 s67, s43, 679936
  buffer_load_dword v79, v30, s[84:87], s67 offen
  s_waitcnt vmcnt(54)
  v_perm_b32 v104, v89, v88, s78
  s_waitcnt vmcnt(52)
  v_perm_b32 v105, v91, v90, s78
  s_waitcnt vmcnt(50)
  v_perm_b32 v106, v93, v92, s78
  s_waitcnt vmcnt(48)
  v_perm_b32 v107, v95, v94, s78
  v_perm_b32 v108, v89, v88, s79
  v_perm_b32 v109, v91, v90, s79
  v_perm_b32 v110, v93, v92, s79
  v_perm_b32 v111, v95, v94, s79
  v_accvgpr_write_b32 a156, v104
  v_accvgpr_write_b32 a157, v105
  v_accvgpr_write_b32 a158, v106
  v_accvgpr_write_b32 a159, v107
  v_accvgpr_write_b32 a220, v108
  v_accvgpr_write_b32 a221, v109
  v_accvgpr_write_b32 a222, v110
  v_accvgpr_write_b32 a223, v111
  s_add_u32 s67, s43, 32768
  buffer_load_dword v80, v30, s[84:87], s67 offen
  s_add_u32 s67, s43, 40960
  buffer_load_dword v81, v30, s[84:87], s67 offen
  s_add_u32 s67, s43, 163840
  buffer_load_dword v82, v30, s[84:87], s67 offen
  s_add_u32 s67, s43, 172032
  buffer_load_dword v83, v30, s[84:87], s67 offen
  s_add_u32 s67, s43, 49152
  buffer_load_dword v84, v30, s[84:87], s67 offen
  s_add_u32 s67, s43, 57344
  buffer_load_dword v85, v30, s[84:87], s67 offen
  s_add_u32 s67, s43, 180224
  buffer_load_dword v86, v30, s[84:87], s67 offen
  s_add_u32 s67, s43, 188416
  buffer_load_dword v87, v30, s[84:87], s67 offen
  s_waitcnt vmcnt(54)
  v_perm_b32 v104, v33, v32, s78
  s_waitcnt vmcnt(52)
  v_perm_b32 v105, v35, v34, s78
  s_waitcnt vmcnt(50)
  v_perm_b32 v106, v37, v36, s78
  s_waitcnt vmcnt(48)
  v_perm_b32 v107, v39, v38, s78
  v_perm_b32 v108, v33, v32, s79
  v_perm_b32 v109, v35, v34, s79
  v_perm_b32 v110, v37, v36, s79
  v_perm_b32 v111, v39, v38, s79
  v_accvgpr_write_b32 a160, v104
  v_accvgpr_write_b32 a161, v105
  v_accvgpr_write_b32 a162, v106
  v_accvgpr_write_b32 a163, v107
  v_accvgpr_write_b32 a224, v108
  v_accvgpr_write_b32 a225, v109
  v_accvgpr_write_b32 a226, v110
  v_accvgpr_write_b32 a227, v111
  s_add_u32 s67, s43, 557056
  buffer_load_dword v88, v30, s[84:87], s67 offen
  s_add_u32 s67, s43, 565248
  buffer_load_dword v89, v30, s[84:87], s67 offen
  s_add_u32 s67, s43, 688128
  buffer_load_dword v90, v30, s[84:87], s67 offen
  s_add_u32 s67, s43, 696320
  buffer_load_dword v91, v30, s[84:87], s67 offen
  s_add_u32 s67, s43, 573440
  buffer_load_dword v92, v30, s[84:87], s67 offen
  s_add_u32 s67, s43, 581632
  buffer_load_dword v93, v30, s[84:87], s67 offen
  s_add_u32 s67, s43, 704512
  buffer_load_dword v94, v30, s[84:87], s67 offen
  s_add_u32 s67, s43, 712704
  buffer_load_dword v95, v30, s[84:87], s67 offen
  s_waitcnt vmcnt(54)
  v_perm_b32 v104, v41, v40, s78
  s_waitcnt vmcnt(52)
  v_perm_b32 v105, v43, v42, s78
  s_waitcnt vmcnt(50)
  v_perm_b32 v106, v45, v44, s78
  s_waitcnt vmcnt(48)
  v_perm_b32 v107, v47, v46, s78
  v_perm_b32 v108, v41, v40, s79
  v_perm_b32 v109, v43, v42, s79
  v_perm_b32 v110, v45, v44, s79
  v_perm_b32 v111, v47, v46, s79
  v_accvgpr_write_b32 a164, v104
  v_accvgpr_write_b32 a165, v105
  v_accvgpr_write_b32 a166, v106
  v_accvgpr_write_b32 a167, v107
  v_accvgpr_write_b32 a228, v108
  v_accvgpr_write_b32 a229, v109
  v_accvgpr_write_b32 a230, v110
  v_accvgpr_write_b32 a231, v111
  s_add_u32 s67, s40, 0
  buffer_load_dword v32, v30, s[88:91], s67 offen
  s_add_u32 s67, s40, 8192
  buffer_load_dword v33, v30, s[88:91], s67 offen
  s_add_u32 s67, s40, 131072
  buffer_load_dword v34, v30, s[88:91], s67 offen
  s_add_u32 s67, s40, 139264
  buffer_load_dword v35, v30, s[88:91], s67 offen
  s_add_u32 s67, s40, 16384
  buffer_load_dword v36, v30, s[88:91], s67 offen
  s_add_u32 s67, s40, 24576
  buffer_load_dword v37, v30, s[88:91], s67 offen
  s_add_u32 s67, s40, 147456
  buffer_load_dword v38, v30, s[88:91], s67 offen
  s_add_u32 s67, s40, 155648
  buffer_load_dword v39, v30, s[88:91], s67 offen
  s_waitcnt vmcnt(54)
  v_perm_b32 v104, v49, v48, s78
  s_waitcnt vmcnt(52)
  v_perm_b32 v105, v51, v50, s78
  s_waitcnt vmcnt(50)
  v_perm_b32 v106, v53, v52, s78
  s_waitcnt vmcnt(48)
  v_perm_b32 v107, v55, v54, s78
  v_perm_b32 v108, v49, v48, s79
  v_perm_b32 v109, v51, v50, s79
  v_perm_b32 v110, v53, v52, s79
  v_perm_b32 v111, v55, v54, s79
  v_accvgpr_write_b32 a168, v104
  v_accvgpr_write_b32 a169, v105
  v_accvgpr_write_b32 a170, v106
  v_accvgpr_write_b32 a171, v107
  v_accvgpr_write_b32 a232, v108
  v_accvgpr_write_b32 a233, v109
  v_accvgpr_write_b32 a234, v110
  v_accvgpr_write_b32 a235, v111
  s_add_u32 s67, s40, 524288
  buffer_load_dword v40, v30, s[88:91], s67 offen
  s_add_u32 s67, s40, 532480
  buffer_load_dword v41, v30, s[88:91], s67 offen
  s_add_u32 s67, s40, 655360
  buffer_load_dword v42, v30, s[88:91], s67 offen
  s_add_u32 s67, s40, 663552
  buffer_load_dword v43, v30, s[88:91], s67 offen
  s_add_u32 s67, s40, 540672
  buffer_load_dword v44, v30, s[88:91], s67 offen
  s_add_u32 s67, s40, 548864
  buffer_load_dword v45, v30, s[88:91], s67 offen
  s_add_u32 s67, s40, 671744
  buffer_load_dword v46, v30, s[88:91], s67 offen
  s_add_u32 s67, s40, 679936
  buffer_load_dword v47, v30, s[88:91], s67 offen
  s_waitcnt vmcnt(54)
  v_perm_b32 v104, v57, v56, s78
  s_waitcnt vmcnt(52)
  v_perm_b32 v105, v59, v58, s78
  s_waitcnt vmcnt(50)
  v_perm_b32 v106, v61, v60, s78
  s_waitcnt vmcnt(48)
  v_perm_b32 v107, v63, v62, s78
  v_perm_b32 v108, v57, v56, s79
  v_perm_b32 v109, v59, v58, s79
  v_perm_b32 v110, v61, v60, s79
  v_perm_b32 v111, v63, v62, s79
  v_accvgpr_write_b32 a172, v104
  v_accvgpr_write_b32 a173, v105
  v_accvgpr_write_b32 a174, v106
  v_accvgpr_write_b32 a175, v107
  v_accvgpr_write_b32 a236, v108
  v_accvgpr_write_b32 a237, v109
  v_accvgpr_write_b32 a238, v110
  v_accvgpr_write_b32 a239, v111
  s_add_u32 s67, s40, 32768
  buffer_load_dword v48, v30, s[88:91], s67 offen
  s_add_u32 s67, s40, 40960
  buffer_load_dword v49, v30, s[88:91], s67 offen
  s_add_u32 s67, s40, 163840
  buffer_load_dword v50, v30, s[88:91], s67 offen
  s_add_u32 s67, s40, 172032
  buffer_load_dword v51, v30, s[88:91], s67 offen
  s_add_u32 s67, s40, 49152
  buffer_load_dword v52, v30, s[88:91], s67 offen
  s_add_u32 s67, s40, 57344
  buffer_load_dword v53, v30, s[88:91], s67 offen
  s_add_u32 s67, s40, 180224
  buffer_load_dword v54, v30, s[88:91], s67 offen
  s_add_u32 s67, s40, 188416
  buffer_load_dword v55, v30, s[88:91], s67 offen
  s_waitcnt vmcnt(54)
  v_perm_b32 v104, v65, v64, s78
  s_waitcnt vmcnt(52)
  v_perm_b32 v105, v67, v66, s78
  s_waitcnt vmcnt(50)
  v_perm_b32 v106, v69, v68, s78
  s_waitcnt vmcnt(48)
  v_perm_b32 v107, v71, v70, s78
  v_perm_b32 v108, v65, v64, s79
  v_perm_b32 v109, v67, v66, s79
  v_perm_b32 v110, v69, v68, s79
  v_perm_b32 v111, v71, v70, s79
  v_accvgpr_write_b32 a176, v104
  v_accvgpr_write_b32 a177, v105
  v_accvgpr_write_b32 a178, v106
  v_accvgpr_write_b32 a179, v107
  v_accvgpr_write_b32 a240, v108
  v_accvgpr_write_b32 a241, v109
  v_accvgpr_write_b32 a242, v110
  v_accvgpr_write_b32 a243, v111
  s_add_u32 s67, s40, 557056
  buffer_load_dword v56, v30, s[88:91], s67 offen
  s_add_u32 s67, s40, 565248
  buffer_load_dword v57, v30, s[88:91], s67 offen
  s_add_u32 s67, s40, 688128
  buffer_load_dword v58, v30, s[88:91], s67 offen
  s_add_u32 s67, s40, 696320
  buffer_load_dword v59, v30, s[88:91], s67 offen
  s_add_u32 s67, s40, 573440
  buffer_load_dword v60, v30, s[88:91], s67 offen
  s_add_u32 s67, s40, 581632
  buffer_load_dword v61, v30, s[88:91], s67 offen
  s_add_u32 s67, s40, 704512
  buffer_load_dword v62, v30, s[88:91], s67 offen
  s_add_u32 s67, s40, 712704
  buffer_load_dword v63, v30, s[88:91], s67 offen
  s_waitcnt vmcnt(54)
  v_perm_b32 v104, v73, v72, s78
  s_waitcnt vmcnt(52)
  v_perm_b32 v105, v75, v74, s78
  s_waitcnt vmcnt(50)
  v_perm_b32 v106, v77, v76, s78
  s_waitcnt vmcnt(48)
  v_perm_b32 v107, v79, v78, s78
  v_perm_b32 v108, v73, v72, s79
  v_perm_b32 v109, v75, v74, s79
  v_perm_b32 v110, v77, v76, s79
  v_perm_b32 v111, v79, v78, s79
  v_accvgpr_write_b32 a180, v104
  v_accvgpr_write_b32 a181, v105
  v_accvgpr_write_b32 a182, v106
  v_accvgpr_write_b32 a183, v107
  v_accvgpr_write_b32 a244, v108
  v_accvgpr_write_b32 a245, v109
  v_accvgpr_write_b32 a246, v110
  v_accvgpr_write_b32 a247, v111
  s_add_u32 s67, s41, 0
  buffer_load_dword v64, v30, s[88:91], s67 offen
  s_add_u32 s67, s41, 8192
  buffer_load_dword v65, v30, s[88:91], s67 offen
  s_add_u32 s67, s41, 131072
  buffer_load_dword v66, v30, s[88:91], s67 offen
  s_add_u32 s67, s41, 139264
  buffer_load_dword v67, v30, s[88:91], s67 offen
  s_add_u32 s67, s41, 16384
  buffer_load_dword v68, v30, s[88:91], s67 offen
  s_add_u32 s67, s41, 24576
  buffer_load_dword v69, v30, s[88:91], s67 offen
  s_add_u32 s67, s41, 147456
  buffer_load_dword v70, v30, s[88:91], s67 offen
  s_add_u32 s67, s41, 155648
  buffer_load_dword v71, v30, s[88:91], s67 offen
  s_waitcnt vmcnt(54)
  v_perm_b32 v104, v81, v80, s78
  s_waitcnt vmcnt(52)
  v_perm_b32 v105, v83, v82, s78
  s_waitcnt vmcnt(50)
  v_perm_b32 v106, v85, v84, s78
  s_waitcnt vmcnt(48)
  v_perm_b32 v107, v87, v86, s78
  v_perm_b32 v108, v81, v80, s79
  v_perm_b32 v109, v83, v82, s79
  v_perm_b32 v110, v85, v84, s79
  v_perm_b32 v111, v87, v86, s79
  v_accvgpr_write_b32 a184, v104
  v_accvgpr_write_b32 a185, v105
  v_accvgpr_write_b32 a186, v106
  v_accvgpr_write_b32 a187, v107
  v_accvgpr_write_b32 a248, v108
  v_accvgpr_write_b32 a249, v109
  v_accvgpr_write_b32 a250, v110
  v_accvgpr_write_b32 a251, v111
  s_add_u32 s67, s41, 524288
  buffer_load_dword v72, v30, s[88:91], s67 offen
  s_add_u32 s67, s41, 532480
  buffer_load_dword v73, v30, s[88:91], s67 offen
  s_add_u32 s67, s41, 655360
  buffer_load_dword v74, v30, s[88:91], s67 offen
  s_add_u32 s67, s41, 663552
  buffer_load_dword v75, v30, s[88:91], s67 offen
  s_add_u32 s67, s41, 540672
  buffer_load_dword v76, v30, s[88:91], s67 offen
  s_add_u32 s67, s41, 548864
  buffer_load_dword v77, v30, s[88:91], s67 offen
  s_add_u32 s67, s41, 671744
  buffer_load_dword v78, v30, s[88:91], s67 offen
  s_add_u32 s67, s41, 679936
  buffer_load_dword v79, v30, s[88:91], s67 offen
  s_waitcnt vmcnt(54)
  v_perm_b32 v104, v89, v88, s78
  s_waitcnt vmcnt(52)
  v_perm_b32 v105, v91, v90, s78
  s_waitcnt vmcnt(50)
  v_perm_b32 v106, v93, v92, s78
  s_waitcnt vmcnt(48)
  v_perm_b32 v107, v95, v94, s78
  v_perm_b32 v108, v89, v88, s79
  v_perm_b32 v109, v91, v90, s79
  v_perm_b32 v110, v93, v92, s79
  v_perm_b32 v111, v95, v94, s79
  v_accvgpr_write_b32 a188, v104
  v_accvgpr_write_b32 a189, v105
  v_accvgpr_write_b32 a190, v106
  v_accvgpr_write_b32 a191, v107
  v_accvgpr_write_b32 a252, v108
  v_accvgpr_write_b32 a253, v109
  v_accvgpr_write_b32 a254, v110
  v_accvgpr_write_b32 a255, v111
  s_add_u32 s67, s41, 32768
  buffer_load_dword v80, v30, s[88:91], s67 offen
  s_add_u32 s67, s41, 40960
  buffer_load_dword v81, v30, s[88:91], s67 offen
  s_add_u32 s67, s41, 163840
  buffer_load_dword v82, v30, s[88:91], s67 offen
  s_add_u32 s67, s41, 172032
  buffer_load_dword v83, v30, s[88:91], s67 offen
  s_add_u32 s67, s41, 49152
  buffer_load_dword v84, v30, s[88:91], s67 offen
  s_add_u32 s67, s41, 57344
  buffer_load_dword v85, v30, s[88:91], s67 offen
  s_add_u32 s67, s41, 180224
  buffer_load_dword v86, v30, s[88:91], s67 offen
  s_add_u32 s67, s41, 188416
  buffer_load_dword v87, v30, s[88:91], s67 offen
  s_waitcnt vmcnt(54)
  v_perm_b32 v104, v33, v32, s78
  s_waitcnt vmcnt(52)
  v_perm_b32 v105, v35, v34, s78
  s_waitcnt vmcnt(50)
  v_perm_b32 v106, v37, v36, s78
  s_waitcnt vmcnt(48)
  v_perm_b32 v107, v39, v38, s78
  v_perm_b32 v108, v33, v32, s79
  v_perm_b32 v109, v35, v34, s79
  v_perm_b32 v110, v37, v36, s79
  v_perm_b32 v111, v39, v38, s79
  ds_write_b128 v2, v[104:107] offset:0
  ds_write_b128 v2, v[108:111] offset:2048
  s_add_u32 s67, s41, 557056
  buffer_load_dword v88, v30, s[88:91], s67 offen
  s_add_u32 s67, s41, 565248
  buffer_load_dword v89, v30, s[88:91], s67 offen
  s_add_u32 s67, s41, 688128
  buffer_load_dword v90, v30, s[88:91], s67 offen
  s_add_u32 s67, s41, 696320
  buffer_load_dword v91, v30, s[88:91], s67 offen
  s_add_u32 s67, s41, 573440
  buffer_load_dword v92, v30, s[88:91], s67 offen
  s_add_u32 s67, s41, 581632
  buffer_load_dword v93, v30, s[88:91], s67 offen
  s_add_u32 s67, s41, 704512
  buffer_load_dword v94, v30, s[88:91], s67 offen
  s_add_u32 s67, s41, 712704
  buffer_load_dword v95, v30, s[88:91], s67 offen
  s_waitcnt vmcnt(54)
  v_perm_b32 v104, v41, v40, s78
  s_waitcnt vmcnt(52)
  v_perm_b32 v105, v43, v42, s78
  s_waitcnt vmcnt(50)
  v_perm_b32 v106, v45, v44, s78
  s_waitcnt vmcnt(48)
  v_perm_b32 v107, v47, v46, s78
  v_perm_b32 v108, v41, v40, s79
  v_perm_b32 v109, v43, v42, s79
  v_perm_b32 v110, v45, v44, s79
  v_perm_b32 v111, v47, v46, s79
  ds_write_b128 v2, v[104:107] offset:1024
  ds_write_b128 v2, v[108:111] offset:3072
  s_add_u32 s67, s42, 0
  buffer_load_dword v32, v30, s[88:91], s67 offen
  s_add_u32 s67, s42, 8192
  buffer_load_dword v33, v30, s[88:91], s67 offen
  s_add_u32 s67, s42, 131072
  buffer_load_dword v34, v30, s[88:91], s67 offen
  s_add_u32 s67, s42, 139264
  buffer_load_dword v35, v30, s[88:91], s67 offen
  s_add_u32 s67, s42, 16384
  buffer_load_dword v36, v30, s[88:91], s67 offen
  s_add_u32 s67, s42, 24576
  buffer_load_dword v37, v30, s[88:91], s67 offen
  s_add_u32 s67, s42, 147456
  buffer_load_dword v38, v30, s[88:91], s67 offen
  s_add_u32 s67, s42, 155648
  buffer_load_dword v39, v30, s[88:91], s67 offen
  s_waitcnt vmcnt(54)
  v_perm_b32 v104, v49, v48, s78
  s_waitcnt vmcnt(52)
  v_perm_b32 v105, v51, v50, s78
  s_waitcnt vmcnt(50)
  v_perm_b32 v106, v53, v52, s78
  s_waitcnt vmcnt(48)
  v_perm_b32 v107, v55, v54, s78
  v_perm_b32 v108, v49, v48, s79
  v_perm_b32 v109, v51, v50, s79
  v_perm_b32 v110, v53, v52, s79
  v_perm_b32 v111, v55, v54, s79
  ds_write_b128 v2, v[104:107] offset:4096
  ds_write_b128 v2, v[108:111] offset:6144
  s_add_u32 s67, s42, 524288
  buffer_load_dword v40, v30, s[88:91], s67 offen
  s_add_u32 s67, s42, 532480
  buffer_load_dword v41, v30, s[88:91], s67 offen
  s_add_u32 s67, s42, 655360
  buffer_load_dword v42, v30, s[88:91], s67 offen
  s_add_u32 s67, s42, 663552
  buffer_load_dword v43, v30, s[88:91], s67 offen
  s_add_u32 s67, s42, 540672
  buffer_load_dword v44, v30, s[88:91], s67 offen
  s_add_u32 s67, s42, 548864
  buffer_load_dword v45, v30, s[88:91], s67 offen
  s_add_u32 s67, s42, 671744
  buffer_load_dword v46, v30, s[88:91], s67 offen
  s_add_u32 s67, s42, 679936
  buffer_load_dword v47, v30, s[88:91], s67 offen
  s_waitcnt vmcnt(54)
  v_perm_b32 v104, v57, v56, s78
  s_waitcnt vmcnt(52)
  v_perm_b32 v105, v59, v58, s78
  s_waitcnt vmcnt(50)
  v_perm_b32 v106, v61, v60, s78
  s_waitcnt vmcnt(48)
  v_perm_b32 v107, v63, v62, s78
  v_perm_b32 v108, v57, v56, s79
  v_perm_b32 v109, v59, v58, s79
  v_perm_b32 v110, v61, v60, s79
  v_perm_b32 v111, v63, v62, s79
  ds_write_b128 v2, v[104:107] offset:5120
  ds_write_b128 v2, v[108:111] offset:7168
  s_add_u32 s67, s42, 32768
  buffer_load_dword v48, v30, s[88:91], s67 offen
  s_add_u32 s67, s42, 40960
  buffer_load_dword v49, v30, s[88:91], s67 offen
  s_add_u32 s67, s42, 163840
  buffer_load_dword v50, v30, s[88:91], s67 offen
  s_add_u32 s67, s42, 172032
  buffer_load_dword v51, v30, s[88:91], s67 offen
  s_add_u32 s67, s42, 49152
  buffer_load_dword v52, v30, s[88:91], s67 offen
  s_add_u32 s67, s42, 57344
  buffer_load_dword v53, v30, s[88:91], s67 offen
  s_add_u32 s67, s42, 180224
  buffer_load_dword v54, v30, s[88:91], s67 offen
  s_add_u32 s67, s42, 188416
  buffer_load_dword v55, v30, s[88:91], s67 offen
  s_waitcnt vmcnt(54)
  v_perm_b32 v104, v65, v64, s78
  s_waitcnt vmcnt(52)
  v_perm_b32 v105, v67, v66, s78
  s_waitcnt vmcnt(50)
  v_perm_b32 v106, v69, v68, s78
  s_waitcnt vmcnt(48)
  v_perm_b32 v107, v71, v70, s78
  v_perm_b32 v108, v65, v64, s79
  v_perm_b32 v109, v67, v66, s79
  v_perm_b32 v110, v69, v68, s79
  v_perm_b32 v111, v71, v70, s79
  ds_write_b128 v2, v[104:107] offset:8192
  ds_write_b128 v2, v[108:111] offset:10240
  s_add_u32 s67, s42, 557056
  buffer_load_dword v56, v30, s[88:91], s67 offen
  s_add_u32 s67, s42, 565248
  buffer_load_dword v57, v30, s[88:91], s67 offen
  s_add_u32 s67, s42, 688128
  buffer_load_dword v58, v30, s[88:91], s67 offen
  s_add_u32 s67, s42, 696320
  buffer_load_dword v59, v30, s[88:91], s67 offen
  s_add_u32 s67, s42, 573440
  buffer_load_dword v60, v30, s[88:91], s67 offen
  s_add_u32 s67, s42, 581632
  buffer_load_dword v61, v30, s[88:91], s67 offen
  s_add_u32 s67, s42, 704512
  buffer_load_dword v62, v30, s[88:91], s67 offen
  s_add_u32 s67, s42, 712704
  buffer_load_dword v63, v30, s[88:91], s67 offen
  s_waitcnt vmcnt(54)
  v_perm_b32 v104, v73, v72, s78
  s_waitcnt vmcnt(52)
  v_perm_b32 v105, v75, v74, s78
  s_waitcnt vmcnt(50)
  v_perm_b32 v106, v77, v76, s78
  s_waitcnt vmcnt(48)
  v_perm_b32 v107, v79, v78, s78
  v_perm_b32 v108, v73, v72, s79
  v_perm_b32 v109, v75, v74, s79
  v_perm_b32 v110, v77, v76, s79
  v_perm_b32 v111, v79, v78, s79
  ds_write_b128 v2, v[104:107] offset:9216
  ds_write_b128 v2, v[108:111] offset:11264
  s_add_u32 s67, s43, 0
  buffer_load_dword v64, v30, s[88:91], s67 offen
  s_add_u32 s67, s43, 8192
  buffer_load_dword v65, v30, s[88:91], s67 offen
  s_add_u32 s67, s43, 131072
  buffer_load_dword v66, v30, s[88:91], s67 offen
  s_add_u32 s67, s43, 139264
  buffer_load_dword v67, v30, s[88:91], s67 offen
  s_add_u32 s67, s43, 16384
  buffer_load_dword v68, v30, s[88:91], s67 offen
  s_add_u32 s67, s43, 24576
  buffer_load_dword v69, v30, s[88:91], s67 offen
  s_add_u32 s67, s43, 147456
  buffer_load_dword v70, v30, s[88:91], s67 offen
  s_add_u32 s67, s43, 155648
  buffer_load_dword v71, v30, s[88:91], s67 offen
  s_waitcnt vmcnt(54)
  v_perm_b32 v104, v81, v80, s78
  s_waitcnt vmcnt(52)
  v_perm_b32 v105, v83, v82, s78
  s_waitcnt vmcnt(50)
  v_perm_b32 v106, v85, v84, s78
  s_waitcnt vmcnt(48)
  v_perm_b32 v107, v87, v86, s78
  v_perm_b32 v108, v81, v80, s79
  v_perm_b32 v109, v83, v82, s79
  v_perm_b32 v110, v85, v84, s79
  v_perm_b32 v111, v87, v86, s79
  ds_write_b128 v2, v[104:107] offset:12288
  ds_write_b128 v2, v[108:111] offset:14336
  s_add_u32 s67, s43, 524288
  buffer_load_dword v72, v30, s[88:91], s67 offen
  s_add_u32 s67, s43, 532480
  buffer_load_dword v73, v30, s[88:91], s67 offen
  s_add_u32 s67, s43, 655360
  buffer_load_dword v74, v30, s[88:91], s67 offen
  s_add_u32 s67, s43, 663552
  buffer_load_dword v75, v30, s[88:91], s67 offen
  s_add_u32 s67, s43, 540672
  buffer_load_dword v76, v30, s[88:91], s67 offen
  s_add_u32 s67, s43, 548864
  buffer_load_dword v77, v30, s[88:91], s67 offen
  s_add_u32 s67, s43, 671744
  buffer_load_dword v78, v30, s[88:91], s67 offen
  s_add_u32 s67, s43, 679936
  buffer_load_dword v79, v30, s[88:91], s67 offen
  s_waitcnt vmcnt(54)
  v_perm_b32 v104, v89, v88, s78
  s_waitcnt vmcnt(52)
  v_perm_b32 v105, v91, v90, s78
  s_waitcnt vmcnt(50)
  v_perm_b32 v106, v93, v92, s78
  s_waitcnt vmcnt(48)
  v_perm_b32 v107, v95, v94, s78
  v_perm_b32 v108, v89, v88, s79
  v_perm_b32 v109, v91, v90, s79
  v_perm_b32 v110, v93, v92, s79
  v_perm_b32 v111, v95, v94, s79
  ds_write_b128 v2, v[104:107] offset:13312
  ds_write_b128 v2, v[108:111] offset:15360
  s_add_u32 s67, s43, 32768
  buffer_load_dword v80, v30, s[88:91], s67 offen
  s_add_u32 s67, s43, 40960
  buffer_load_dword v81, v30, s[88:91], s67 offen
  s_add_u32 s67, s43, 163840
  buffer_load_dword v82, v30, s[88:91], s67 offen
  s_add_u32 s67, s43, 172032
  buffer_load_dword v83, v30, s[88:91], s67 offen
  s_add_u32 s67, s43, 49152
  buffer_load_dword v84, v30, s[88:91], s67 offen
  s_add_u32 s67, s43, 57344
  buffer_load_dword v85, v30, s[88:91], s67 offen
  s_add_u32 s67, s43, 180224
  buffer_load_dword v86, v30, s[88:91], s67 offen
  s_add_u32 s67, s43, 188416
  buffer_load_dword v87, v30, s[88:91], s67 offen
  s_waitcnt vmcnt(54)
  v_perm_b32 v104, v33, v32, s78
  s_waitcnt vmcnt(52)
  v_perm_b32 v105, v35, v34, s78
  s_waitcnt vmcnt(50)
  v_perm_b32 v106, v37, v36, s78
  s_waitcnt vmcnt(48)
  v_perm_b32 v107, v39, v38, s78
  v_perm_b32 v108, v33, v32, s79
  v_perm_b32 v109, v35, v34, s79
  v_perm_b32 v110, v37, v36, s79
  v_perm_b32 v111, v39, v38, s79
  ds_write_b128 v2, v[104:107] offset:16384
  ds_write_b128 v2, v[108:111] offset:18432
  s_add_u32 s67, s43, 557056
  buffer_load_dword v88, v30, s[88:91], s67 offen
  s_add_u32 s67, s43, 565248
  buffer_load_dword v89, v30, s[88:91], s67 offen
  s_add_u32 s67, s43, 688128
  buffer_load_dword v90, v30, s[88:91], s67 offen
  s_add_u32 s67, s43, 696320
  buffer_load_dword v91, v30, s[88:91], s67 offen
  s_add_u32 s67, s43, 573440
  buffer_load_dword v92, v30, s[88:91], s67 offen
  s_add_u32 s67, s43, 581632
  buffer_load_dword v93, v30, s[88:91], s67 offen
  s_add_u32 s67, s43, 704512
  buffer_load_dword v94, v30, s[88:91], s67 offen
  s_add_u32 s67, s43, 712704
  buffer_load_dword v95, v30, s[88:91], s67 offen
  s_waitcnt vmcnt(54)
  v_perm_b32 v104, v41, v40, s78
  s_waitcnt vmcnt(52)
  v_perm_b32 v105, v43, v42, s78
  s_waitcnt vmcnt(50)
  v_perm_b32 v106, v45, v44, s78
  s_waitcnt vmcnt(48)
  v_perm_b32 v107, v47, v46, s78
  v_perm_b32 v108, v41, v40, s79
  v_perm_b32 v109, v43, v42, s79
  v_perm_b32 v110, v45, v44, s79
  v_perm_b32 v111, v47, v46, s79
  ds_write_b128 v2, v[104:107] offset:17408
  ds_write_b128 v2, v[108:111] offset:19456
  s_waitcnt vmcnt(46)
  v_perm_b32 v104, v49, v48, s78
  s_waitcnt vmcnt(44)
  v_perm_b32 v105, v51, v50, s78
  s_waitcnt vmcnt(42)
  v_perm_b32 v106, v53, v52, s78
  s_waitcnt vmcnt(40)
  v_perm_b32 v107, v55, v54, s78
  v_perm_b32 v108, v49, v48, s79
  v_perm_b32 v109, v51, v50, s79
  v_perm_b32 v110, v53, v52, s79
  v_perm_b32 v111, v55, v54, s79
  ds_write_b128 v2, v[104:107] offset:20480
  ds_write_b128 v2, v[108:111] offset:22528
  s_waitcnt vmcnt(38)
  v_perm_b32 v104, v57, v56, s78
  s_waitcnt vmcnt(36)
  v_perm_b32 v105, v59, v58, s78
  s_waitcnt vmcnt(34)
  v_perm_b32 v106, v61, v60, s78
  s_waitcnt vmcnt(32)
  v_perm_b32 v107, v63, v62, s78
  v_perm_b32 v108, v57, v56, s79
  v_perm_b32 v109, v59, v58, s79
  v_perm_b32 v110, v61, v60, s79
  v_perm_b32 v111, v63, v62, s79
  ds_write_b128 v2, v[104:107] offset:21504
  ds_write_b128 v2, v[108:111] offset:23552
  s_waitcnt vmcnt(30)
  v_perm_b32 v104, v65, v64, s78
  s_waitcnt vmcnt(28)
  v_perm_b32 v105, v67, v66, s78
  s_waitcnt vmcnt(26)
  v_perm_b32 v106, v69, v68, s78
  s_waitcnt vmcnt(24)
  v_perm_b32 v107, v71, v70, s78
  v_perm_b32 v108, v65, v64, s79
  v_perm_b32 v109, v67, v66, s79
  v_perm_b32 v110, v69, v68, s79
  v_perm_b32 v111, v71, v70, s79
  ds_write_b128 v2, v[104:107] offset:24576
  ds_write_b128 v2, v[108:111] offset:26624
  s_waitcnt vmcnt(22)
  v_perm_b32 v104, v73, v72, s78
  s_waitcnt vmcnt(20)
  v_perm_b32 v105, v75, v74, s78
  s_waitcnt vmcnt(18)
  v_perm_b32 v106, v77, v76, s78
  s_waitcnt vmcnt(16)
  v_perm_b32 v107, v79, v78, s78
  v_perm_b32 v108, v73, v72, s79
  v_perm_b32 v109, v75, v74, s79
  v_perm_b32 v110, v77, v76, s79
  v_perm_b32 v111, v79, v78, s79
  ds_write_b128 v2, v[104:107] offset:25600
  ds_write_b128 v2, v[108:111] offset:27648
  s_waitcnt vmcnt(14)
  v_perm_b32 v104, v81, v80, s78
  s_waitcnt vmcnt(12)
  v_perm_b32 v105, v83, v82, s78
  s_waitcnt vmcnt(10)
  v_perm_b32 v106, v85, v84, s78
  s_waitcnt vmcnt(8)
  v_perm_b32 v107, v87, v86, s78
  v_perm_b32 v108, v81, v80, s79
  v_perm_b32 v109, v83, v82, s79
  v_perm_b32 v110, v85, v84, s79
  v_perm_b32 v111, v87, v86, s79
  ds_write_b128 v2, v[104:107] offset:28672
  ds_write_b128 v2, v[108:111] offset:30720
  s_waitcnt vmcnt(6)
  v_perm_b32 v104, v89, v88, s78
  s_waitcnt vmcnt(4)
  v_perm_b32 v105, v91, v90, s78
  s_waitcnt vmcnt(2)
  v_perm_b32 v106, v93, v92, s78
  s_waitcnt vmcnt(0)
  v_perm_b32 v107, v95, v94, s78
  v_perm_b32 v108, v89, v88, s79
  v_perm_b32 v109, v91, v90, s79
  v_perm_b32 v110, v93, v92, s79
  v_perm_b32 v111, v95, v94, s79
  ds_write_b128 v2, v[104:107] offset:29696
  ds_write_b128 v2, v[108:111] offset:31744
  buffer_load_dwordx2 v[112:113], v19, s[8:11], 0 offen offset:0
  buffer_load_dwordx2 v[114:115], v19, s[8:11], 0 offen offset:16
  buffer_load_dwordx2 v[116:117], v19, s[8:11], 0 offen offset:8
  buffer_load_dwordx2 v[118:119], v19, s[8:11], 0 offen offset:24
  s_waitcnt vmcnt(2)
  ds_write_b128 v18, v[112:115] offset:16384
  s_waitcnt vmcnt(0)
  ds_write_b128 v18, v[116:119] offset:17408
  v_mov_b64 v[16:17], v[112:113]
  v_mov_b64 v[18:19], v[114:115]
  v_mov_b64 v[20:21], v[116:117]
  v_mov_b64 v[22:23], v[118:119]
  v_mov_b64 v[48:49], 0
  v_mov_b64 v[50:51], 0
  v_mov_b64 v[52:53], 0
  v_mov_b64 v[54:55], 0
  v_mov_b64 v[56:57], 0
  v_mov_b64 v[58:59], 0
  v_mov_b64 v[60:61], 0
  v_mov_b64 v[62:63], 0
  v_mov_b64 v[64:65], 0
  v_mov_b64 v[66:67], 0
  v_mov_b64 v[68:69], 0
  v_mov_b64 v[70:71], 0
  s_waitcnt lgkmcnt(0)
  v_mbcnt_lo_u32_b32 v102, -1, 0
  v_and_b32 v100, 1, v102
  v_lshlrev_b32 v100, 7, v100
  v_bfe_u32 v102, v102, 1, 2
  v_lshl_add_u32 v100, v102, 2, v100
  v_add_u32 v100, s2, v100
L_go_6:
  s_sub_u32 s66, s66, 1
  s_cbranch_scc1 L_abort
  global_load_dword v101, v100, s[62:63] sc1
  s_waitcnt vmcnt(0)
  v_and_b32 v102, 0xff, v101
  v_cmp_eq_u32 vcc, 32, v102
  v_bfe_u32 v102, v101, 8, 8
  v_lshrrev_b32 v103, 16, v101
  s_and_b32 s67, vcc_lo, 0xff
  s_cmp_eq_u32 s67, 0xff
  s_cbranch_scc1 L_go_6_ok
  v_and_b32 v102, 0xff, v101
  v_cmp_lt_u32 vcc, 32, v102
  s_cbranch_vccnz L_abort
  s_sleep 8
  s_branch L_go_6
L_go_6_ok:
  v_mul_u32_u24 v102, v102, v102
  v_lshlrev_b32 v103, 5, v103
  v_cmp_eq_u32 vcc, v102, v103
  s_nop 3
  s_and_b32 s67, vcc_lo, 0xff
  s_cmp_lg_u32 s67, 0xff
  s_cbranch_scc1 L_regroup
  ds_read_b128 v[72:75], v2 offset:0
  ds_read_b128 v[76:79], v2 offset:1024
  ds_read_b128 v[80:83], v2 offset:2048
  ds_read_b128 v[84:87], v2 offset:3072
  ds_read_b128 v[88:91], v2 offset:4096
  ds_read_b128 v[92:95], v2 offset:5120
  ds_read_b128 v[96:99], v2 offset:6144
  ds_read_b128 v[100:103], v2 offset:7168
  ds_read_b128 v[104:107], v2 offset:8192
  ds_read_b128 v[108:111], v2 offset:9216
  ds_read_b128 v[112:115], v2 offset:10240
  ds_read_b128 v[116:119], v2 offset:11264
  ds_read_b128 v[120:123], v2 offset:12288
  ds_read_b128 v[124:127], v2 offset:13312
  s_add_u32 s24, s23, 8192
  s_cmp_lt_u32 s15, 63
  s_cselect_b32 s67, s74, 536870912
  s_add_u32 s26, s23, s67
  s_and_b32 s67, s15, 7
  s_lshl_b32 s67, s67, 12
  s_add_u32 s28, s27, s67
  s_bfe_u32 s30, s15, 0x10001
  s_cmp_lt_u32 s15, 8
  s_cselect_b32 s29, 16, 0
  s_add_u32 s67, s15, 1
  s_and_b32 s67, s67, 3
  s_lshl_b32 s67, s67, 13
  s_add_u32 s21, s72, s67
  s_add_u32 s20, s21, s35
  s_xor_b32 s22, s20, 0x2000
  s_and_b32 s67, s15, 1
  s_lshl_b32 s67, s67, 14
  s_xor_b32 s22, s22, s67
  v_lshlrev_b32 v14, 3, v0
  v_xor_b32 v28, 2048, v13
  v_xor_b32 v36, 4096, v13
  v_xor_b32 v44, 6144, v13
  s_mov_b64 vcc, 0
  s_waitcnt lgkmcnt(0)
  s_branch L_rec_step
  .p2align 3
L_rec_top:
  s_waitcnt vmcnt(1)
L_rec_h2:
  ds_write_b128 v13, v[16:19] offset:16384
  ds_write_b128 v13, v[20:23] offset:17408
  v_max3_i32 v47, v16, v17, v18
  v_max3_i32 v47, v47, v19, v20
  v_max3_i32 v47, v47, v21, v22
  v_max_i32_e64 v47, v47, v23
  v_cmp_eq_u32 vcc, s60, v47
L_rec_step:
  v_smfmac_f32_16x16x64_bf16 v[48:51], v[16:19], a[0:7], v12
  v_smfmac_f32_16x16x64_bf16 v[52:55], v[16:19], a[64:71], v12
  s_cbranch_vccnz L_rec_h2_retry
  s_cmp_lg_u32 s31, 31
  s_cbranch_scc1 L_rec_spin
L_rec_spun:
  s_mov_b32 m0, s33
  v_smfmac_f32_16x16x64_bf16 v[48:51], v[20:23], a[8:15], v12
  buffer_load_dwordx4 v13, s[4:7], s23 offen offset:0 sc1 lds
  v_smfmac_f32_16x16x64_bf16 v[52:55], v[20:23], a[72:79], v12
  v_smfmac_f32_16x16x64_bf16 v[64:67], v[16:19], v[72:79], v12
  buffer_load_dwordx4 v13, s[4:7], s23 offen offset:1024 sc1 lds
  v_smfmac_f32_16x16x64_bf16 v[68:71], v[16:19], v[80:87], v12
  s_waitcnt lgkmcnt(0)
  s_barrier
  ds_read_b128 v[24:27], v28 offset:16384
  v_smfmac_f32_16x16x64_bf16 v[56:59], v[16:19], a[128:135], v12
  ds_read_b128 v[28:31], v28 offset:17408
  v_smfmac_f32_16x16x64_bf16 v[60:63], v[16:19], a[192:199], v12
  ds_read_b128 v[32:35], v36 offset:16384
  v_smfmac_f32_16x16x64_bf16 v[56:59], v[20:23], a[136:143], v12
  ds_read_b128 v[36:39], v36 offset:17408
  v_smfmac_f32_16x16x64_bf16 v[60:63], v[20:23], a[200:207], v12
  ds_read_b128 v[40:43], v44 offset:16384
  v_smfmac_f32_16x16x64_bf16 v[64:67], v[20:23], v[88:95], v12
  ds_read_b128 v[44:47], v44 offset:17408
  v_smfmac_f32_16x16x64_bf16 v[68:71], v[20:23], v[96:103], v12
  s_waitcnt lgkmcnt(4)
  v_smfmac_f32_16x16x64_bf16 v[48:51], v[24:27], a[16:23], v12
  s_mov_b32 m0, s34
  v_smfmac_f32_16x16x64_bf16 v[52:55], v[24:27], a[80:87], v12
  buffer_load_dwordx4 v13, s[4:7], s24 offen offset:0 sc1 lds
  v_smfmac_f32_16x16x64_bf16 v[48:51], v[28:31], a[24:31], v12
  ds_read_b128 v[72:75], v2 offset:14336
  v_smfmac_f32_16x16x64_bf16 v[52:55], v[28:31], a[88:95], v12
  s_waitcnt lgkmcnt(1)
  v_smfmac_f32_16x16x64_bf16 v[48:51], v[32:35], a[32:39], v12
  ds_read_b128 v[76:79], v2 offset:15360
  v_smfmac_f32_16x16x64_bf16 v[52:55], v[32:35], a[96:103], v12
  buffer_load_dwordx4 v13, s[4:7], s24 offen offset:1024 sc1 lds
  v_smfmac_f32_16x16x64_bf16 v[48:51], v[36:39], a[40:47], v12
  ds_read_b128 v[80:83], v2 offset:16384
  v_smfmac_f32_16x16x64_bf16 v[52:55], v[36:39], a[104:111], v12
  ds_read_b128 v[84:87], v2 offset:17408
  v_smfmac_f32_16x16x64_bf16 v[48:51], v[40:43], a[48:55], v12
  ds_read_b128 v[88:91], v2 offset:18432
  v_smfmac_f32_16x16x64_bf16 v[52:55], v[40:43], a[112:119], v12
  v_add_u32 v15, v15, v4
  v_smfmac_f32_16x16x64_bf16 v[48:51], v[44:47], a[56:63], v12
  ds_read_b128 v[92:95], v2 offset:19456
  v_smfmac_f32_16x16x64_bf16 v[52:55], v[44:47], a[120:127], v12
  ds_read_b128 v[96:99], v2 offset:20480
  ds_read_b128 v[100:103], v2 offset:21504
  v_smfmac_f32_16x16x64_bf16 v[64:67], v[24:27], v[104:111], v12
  ds_read_b128 v[104:107], v2 offset:22528
  ds_read_b128 v[108:111], v2 offset:23552
  v_smfmac_f32_16x16x64_bf16 v[68:71], v[24:27], v[112:119], v12
  ds_read_b128 v[112:115], v2 offset:24576
  ds_read_b128 v[116:119], v2 offset:25600
  v_smfmac_f32_16x16x64_bf16 v[64:67], v[28:31], v[120:127], v12
  ds_read_b128 v[120:123], v2 offset:26624
  ds_read_b128 v[124:127], v2 offset:27648
  s_waitcnt lgkmcnt(12)
  v_smfmac_f32_16x16x64_bf16 v[68:71], v[28:31], v[72:79], v12
  v_add_f32_e64 v48, v48, v50
  s_waitcnt lgkmcnt(10)
  v_smfmac_f32_16x16x64_bf16 v[64:67], v[32:35], v[80:87], v12
  v_add_f32_e64 v49, v49, v51
  v_add_f32 v52, v52, v54
  s_waitcnt lgkmcnt(8)
  v_smfmac_f32_16x16x64_bf16 v[68:71], v[32:35], v[88:95], v12
  v_add_f32_e64 v53, v53, v55
  v_cvt_pk_bf16_f32 v50, v48, v52
  s_waitcnt lgkmcnt(6)
  v_smfmac_f32_16x16x64_bf16 v[64:67], v[36:39], v[96:103], v12
  v_cvt_pk_bf16_f32 v51, v49, v53
  ds_write_b32 v3, v50
  s_waitcnt lgkmcnt(5)
  v_smfmac_f32_16x16x64_bf16 v[68:71], v[36:39], v[104:111], v12
  ds_write_b32 v3, v51 offset:288
  s_waitcnt lgkmcnt(4)
  v_smfmac_f32_16x16x64_bf16 v[64:67], v[40:43], v[112:119], v12
  v_smfmac_f32_16x16x64_bf16 v[56:59], v[24:27], a[144:151], v12
  v_smfmac_f32_16x16x64_bf16 v[60:63], v[24:27], a[208:215], v12
  s_waitcnt vmcnt(2) lgkmcnt(0)
  s_barrier
  s_nop 0
  v_smfmac_f32_16x16x64_bf16 v[56:59], v[28:31], a[152:159], v12
  ds_read_b128 v[72:75], v5 offset:0
  ds_read_b128 v[88:91], v0 offset:0
  v_smfmac_f32_16x16x64_bf16 v[60:63], v[28:31], a[216:223], v12
  ds_read_b128 v[92:95], v0 offset:4096
  ds_read_b128 v[76:79], v5 offset:64
  v_smfmac_f32_16x16x64_bf16 v[56:59], v[32:35], a[160:167], v12
  ds_read_b128 v[96:99], v0 offset:1024
  v_smfmac_f32_16x16x64_bf16 v[60:63], v[32:35], a[224:231], v12
  ds_read_b128 v[100:103], v0 offset:5120
  v_smfmac_f32_16x16x64_bf16 v[56:59], v[36:39], a[168:175], v12
  ds_read_b128 v[80:83], v5 offset:128
  v_smfmac_f32_16x16x64_bf16 v[60:63], v[36:39], a[232:239], v12
  ds_read_b128 v[104:107], v0 offset:2048
  v_smfmac_f32_16x16x64_bf16 v[56:59], v[40:43], a[176:183], v12
  ds_read_b128 v[108:111], v0 offset:6144
  v_smfmac_f32_16x16x64_bf16 v[60:63], v[40:43], a[240:247], v12
  ds_read_b128 v[84:87], v5 offset:192
  v_smfmac_f32_16x16x64_bf16 v[56:59], v[44:47], a[184:191], v12
  ds_read_b128 v[112:115], v0 offset:3072
  v_smfmac_f32_16x16x64_bf16 v[60:63], v[44:47], a[248:255], v12
  ds_read_b128 v[116:119], v0 offset:7168
  s_waitcnt lgkmcnt(10)
  v_mfma_f32_16x16x32_bf16 v[48:51], v[88:91], v[72:75], 0
  s_waitcnt lgkmcnt(9)
  v_mfma_f32_16x16x32_bf16 v[52:55], v[92:95], v[72:75], 0
  s_nop 0
  v_add_f32_e64 v56, v56, v58
  v_add_f32 v57, v57, v59
  v_add_f32 v60, v60, v62
  v_add_f32 v61, v61, v63
  v_cvt_pk_bf16_f32 v58, v56, v60
  v_cvt_pk_bf16_f32 v59, v57, v61
  ds_write_b32 v3, v58 offset:4096
  ds_write_b32 v3, v59 offset:4384
  s_waitcnt lgkmcnt(9)
  v_mfma_f32_16x16x32_bf16 v[48:51], v[96:99], v[76:79], v[48:51]
  buffer_store_dword v58, v7, s[4:7], s28 offen offset:0 sc1
  s_waitcnt lgkmcnt(8)
  v_mfma_f32_16x16x32_bf16 v[52:55], v[100:103], v[76:79], v[52:55]
  buffer_store_dword v59, v7, s[4:7], s28 offen offset:64 sc1
  s_waitcnt lgkmcnt(6)
  v_mfma_f32_16x16x32_bf16 v[48:51], v[104:107], v[80:83], v[48:51]
  s_waitcnt lgkmcnt(5)
  v_mfma_f32_16x16x32_bf16 v[52:55], v[108:111], v[80:83], v[52:55]
  s_waitcnt lgkmcnt(0)
  s_barrier
  ds_read_b128 v[88:91], v5 offset:4096
  ds_read_b128 v[92:95], v5 offset:4160
  ds_read_b128 v[96:99], v5 offset:4224
  ds_read_b128 v[100:103], v5 offset:4288
  ds_read_b128 v[104:107], v2 offset:28672
  v_mfma_f32_16x16x32_bf16 v[48:51], v[112:115], v[84:87], v[48:51]
  ds_read_b128 v[108:111], v2 offset:29696
  v_mfma_f32_16x16x32_bf16 v[52:55], v[116:119], v[84:87], v[52:55]
  ds_read_b128 v[112:115], v2 offset:30720
  v_smfmac_f32_16x16x64_bf16 v[68:71], v[40:43], v[120:127], v12
  ds_read_b128 v[116:119], v2 offset:31744
  s_waitcnt lgkmcnt(7)
  v_mfma_f32_16x16x32_bf16 v[60:63], v[88:91], v[72:75], 0
  s_nop 0
  v_max3_f32 v56, v48, v49, v50
  s_waitcnt lgkmcnt(6)
  v_mfma_f32_16x16x32_bf16 v[60:63], v[92:95], v[76:79], v[60:63]
  v_max3_f32 v56, v56, v51, v52
  s_waitcnt lgkmcnt(5)
  v_mfma_f32_16x16x32_bf16 v[60:63], v[96:99], v[80:83], v[60:63]
  v_max3_f32 v56, v56, v53, v54
  s_waitcnt lgkmcnt(4)
  v_mfma_f32_16x16x32_bf16 v[60:63], v[100:103], v[84:87], v[60:63]
  v_max_f32_e64 v56, v56, v55
  s_waitcnt lgkmcnt(2)
  v_smfmac_f32_16x16x64_bf16 v[64:67], v[44:47], v[104:111], v12
  s_waitcnt vmcnt(2)
  ds_read_b128 v[72:75], v8 offset:0
  s_waitcnt lgkmcnt(1)
  v_smfmac_f32_16x16x64_bf16 v[68:71], v[44:47], v[112:119], v12
  ds_read_b128 v[76:79], v8 offset:16
  buffer_load_dword v14, v14, s[4:7], s26 offen sc1
  buffer_load_dword v14, v15, s[4:7], 0 offen sc1
  v_max3_f32 v56, v56, v60, v61
  v_mov_b32_e64 v57, v56
  v_mov_b32 v88, 0x3f803f80
  v_mov_b32 v89, 0x3f803f80
  v_permlane32_swap_b32 v56, v57
  v_max_f32_e64 v56, v56, v57
  v_mov_b32 v57, v56
  v_mov_b32 v90, 0x3f803f80
  v_mov_b32 v91, 0x3f803f80
  v_permlane16_swap_b32 v56, v57
  v_max_f32_e64 v56, v56, v57
  v_mul_f32 v57, s36, v56
  v_pk_fma_f32 v[48:49], v[48:49], s[36:37], v[56:57] op_sel:[0,0,1] op_sel_hi:[1,1,1] neg_lo:[0,0,1] neg_hi:[0,0,1]
  v_pk_fma_f32 v[50:51], v[50:51], s[36:37], v[56:57] op_sel:[0,0,1] op_sel_hi:[1,1,1] neg_lo:[0,0,1] neg_hi:[0,0,1]
  v_exp_f32 v48, v48
  v_exp_f32 v49, v49
  v_pk_fma_f32 v[52:53], v[52:53], s[36:37], v[56:57] op_sel:[0,0,1] op_sel_hi:[1,1,1] neg_lo:[0,0,1] neg_hi:[0,0,1]
  v_exp_f32 v50, v50
  v_exp_f32 v51, v51
  v_pk_fma_f32 v[54:55], v[54:55], s[36:37], v[56:57] op_sel:[0,0,1] op_sel_hi:[1,1,1] neg_lo:[0,0,1] neg_hi:[0,0,1]
  v_exp_f32 v52, v52
  v_exp_f32 v53, v53
  v_pk_fma_f32 v[60:61], v[60:61], s[36:37], v[56:57] op_sel:[0,0,1] op_sel_hi:[1,1,1] neg_lo:[0,0,1] neg_hi:[0,0,1]
  v_exp_f32_e64 v54, v54
  v_cvt_pk_bf16_f32 v56, v48, v49
  v_exp_f32_e64 v55, v55
  v_cvt_pk_bf16_f32 v57, v50, v51
  v_exp_f32_e64 v60, v60
  v_cvt_pk_bf16_f32 v58, v52, v53
  v_exp_f32_e64 v61, v61
  v_cvt_pk_bf16_f32 v59, v54, v55
  v_add_f32 v64, v64, v66
  v_add_f32 v65, v65, v67
  v_mfma_f32_16x16x32_bf16 v[16:19], v[88:91], v[56:59], 0
  v_add_f32_e64 v68, v68, v70
  v_add_f32 v69, v69, v71
  s_waitcnt lgkmcnt(1)
  v_mfma_f32_16x16x32_bf16 v[48:51], v[72:75], v[56:59], 0
  v_cvt_pk_bf16_f32 v62, v60, v61
  v_mov_b32 v63, 0
  s_waitcnt lgkmcnt(0)
  v_mfma_f32_16x16x32_bf16 v[52:55], v[76:79], v[56:59], 0
  v_cvt_pk_bf16_f32 v64, v64, v65
  v_cvt_pk_bf16_f32 v65, v68, v69
  v_mfma_f32_16x16x16_bf16 v[16:19], v[88:89], v[62:63], v[16:19]
  v_cvt_pk_bf16_f32 v67, v60, v61
  v_mov_b32_e64 v66, 0
  v_mfma_f32_16x16x16_bf16 v[48:51], v[64:65], v[62:63], v[48:51]
  v_mov_b64 v[96:97], 0
  v_mov_b64 v[98:99], 0
  v_mfma_f32_16x16x16_bf16 v[52:55], v[64:65], v[66:67], v[52:55]
  buffer_store_dwordx2 v[64:65], v1, s[4:7], s28 offen offset:512 sc1
  v_mov_b64_e64 v[100:101], 0
  v_rcp_f32 v16, v16
  v_mov_b64 v[102:103], 0
  v_mov_b64 v[104:105], 0
  v_mov_b64 v[106:107], 0
  v_mov_b64 v[108:109], 0
  v_mov_b64 v[110:111], 0
  v_pk_mul_f32 v[48:49], v[48:49], v[16:17] op_sel_hi:[1,0]
  v_pk_mul_f32 v[50:51], v[50:51], v[16:17] op_sel_hi:[1,0]
  v_pk_mul_f32 v[52:53], v[52:53], v[16:17] op_sel_hi:[1,0]
  v_pk_mul_f32 v[54:55], v[54:55], v[16:17] op_sel_hi:[1,0]
  v_cvt_pk_bf16_f32 v56, v48, v52
  v_cvt_pk_bf16_f32 v57, v49, v53
  v_cvt_pk_bf16_f32 v58, v50, v54
  v_cvt_pk_bf16_f32 v59, v51, v55
  ds_write_b128 v6, v[56:59]
  s_nop 0
  v_smfmac_f32_16x16x64_bf16 v[96:99], v[56:59], v[128:135], v12
  v_xor_b32 v72, 1024, v6
  v_smfmac_f32_16x16x64_bf16 v[100:103], v[56:59], v[160:167], v12
  v_xor_b32 v76, 2048, v6
  v_smfmac_f32_16x16x64_bf16 v[104:107], v[56:59], v[192:199], v12
  v_xor_b32 v80, 3072, v6
  v_smfmac_f32_16x16x64_bf16 v[108:111], v[56:59], v[224:231], v12
  s_waitcnt lgkmcnt(0)
  s_barrier
  s_nop 0
  ds_read_b128 v[72:75], v72 offset:0
  ds_read_b128 v[76:79], v76 offset:0
  ds_read_b128 v[80:83], v80 offset:0
  v_cndmask_b32 v32, 0, v11, s[52:53]
  v_cndmask_b32 v33, 0, v11, s[54:55]
  v_cndmask_b32 v34, 0, v11, s[56:57]
  v_cndmask_b32 v35, 0, v11, s[58:59]
  v_mov_b64 v[48:49], 0
  v_mov_b64 v[50:51], 0
  v_mov_b64 v[52:53], 0
  v_mov_b64 v[54:55], 0
  v_mov_b64 v[56:57], 0
  v_mov_b64 v[58:59], 0
  v_mov_b64 v[60:61], 0
  s_waitcnt lgkmcnt(2)
  v_smfmac_f32_16x16x64_bf16 v[96:99], v[72:75], v[136:143], v12
  v_smfmac_f32_16x16x64_bf16 v[100:103], v[72:75], v[168:175], v12
  s_waitcnt lgkmcnt(1)
  v_smfmac_f32_16x16x64_bf16 v[96:99], v[76:79], v[144:151], v12
  v_smfmac_f32_16x16x64_bf16 v[100:103], v[76:79], v[176:183], v12
  v_mov_b64_e64 v[62:63], 0
  s_waitcnt lgkmcnt(0)
  v_smfmac_f32_16x16x64_bf16 v[96:99], v[80:83], v[152:159], v12
  v_mov_b64_e64 v[64:65], 0
  v_smfmac_f32_16x16x64_bf16 v[100:103], v[80:83], v[184:191], v12
  v_mov_b64_e64 v[66:67], 0
  v_smfmac_f32_16x16x64_bf16 v[104:107], v[72:75], v[200:207], v12
  v_mov_b64_e64 v[68:69], 0
  v_smfmac_f32_16x16x64_bf16 v[108:111], v[72:75], v[232:239], v12
  v_mov_b64_e64 v[70:71], 0
  v_smfmac_f32_16x16x64_bf16 v[104:107], v[76:79], v[208:215], v12
  v_cvt_pk_bf16_f32 v112, v96, v98
  v_smfmac_f32_16x16x64_bf16 v[108:111], v[76:79], v[240:247], v12
  v_cvt_pk_bf16_f32 v113, v100, v102
  v_smfmac_f32_16x16x64_bf16 v[104:107], v[80:83], v[216:223], v12
  v_cvt_pk_bf16_f32 v114, v97, v99
  v_and_or_b32 v112, v112, -2, s30
  v_smfmac_f32_16x16x64_bf16 v[108:111], v[80:83], v[248:255], v12
  v_cvt_pk_bf16_f32 v115, v101, v103
  buffer_store_dwordx4 v[112:115], v9, s[4:7], s16 offen
  s_nop 2
  v_cvt_pk_bf16_f32 v116, v104, v106
  s_nop 1
  v_cvt_pk_bf16_f32 v117, v108, v110
  v_cvt_pk_bf16_f32 v118, v105, v107
  v_and_or_b32 v116, v116, -2, s30
  v_cvt_pk_bf16_f32 v119, v109, v111
  buffer_store_dwordx4 v[116:119], v9, s[4:7], s17 offen
  s_cmp_eq_u32 s15, 63
  s_cbranch_scc1 L_rec_done
  s_add_u32 s15, s15, 1
  s_mov_b32 s19, s18
  s_mov_b32 s76, s30
  s_xor_b32 s16, s16, 0x40000
  s_xor_b32 s17, s17, 0x40000
  s_xor_b32 s18, s18, 0x40000
  s_add_u32 s23, s23, 786432
  s_mov_b32 s77, s21
  s_mov_b32 s75, s20
  s_mov_b32 s73, s22
  s_add_u32 s24, s23, 8192
  s_cmp_lt_u32 s15, 63
  s_cselect_b32 s67, s74, 536870912
  s_add_u32 s26, s23, s67
  s_and_b32 s67, s15, 7
  s_lshl_b32 s67, s67, 12
  s_add_u32 s28, s27, s67
  s_bfe_u32 s30, s15, 0x10001
  s_cmp_lt_u32 s15, 8
  s_cselect_b32 s29, 16, 0
  s_add_u32 s67, s15, 1
  s_and_b32 s67, s67, 3
  s_lshl_b32 s67, s67, 13
  s_add_u32 s21, s72, s67
  s_add_u32 s20, s21, s35
  s_xor_b32 s22, s20, 0x2000
  s_and_b32 s67, s15, 1
  s_lshl_b32 s67, s67, 14
  s_xor_b32 s22, s22, s67
  v_mov_b64_e64 v[40:41], s[60:61]
  v_mov_b64 v[42:43], s[60:61]
  ds_read_b128 v[72:75], v2 offset:0
  ds_read_b128 v[76:79], v2 offset:1024
  ds_read_b128 v[80:83], v2 offset:2048
  ds_read_b128 v[84:87], v2 offset:3072
  ds_read_b128 v[88:91], v2 offset:4096
  ds_read_b128 v[92:95], v2 offset:5120
  s_sleep 5
  buffer_load_dwordx4 v[16:19], v13, s[4:7], s19 offen offset:0 sc1
  buffer_load_dwordx4 v[20:23], v13, s[4:7], s19 offen offset:1024 sc1
  s_waitcnt vmcnt(0)
L_rec_g:
  v_mfma_f32_16x16x32_bf16 v[36:39], v[32:35], v[16:19], 0
  v_mfma_f32_16x16x32_bf16 v[36:39], v[32:35], v[20:23], v[36:39]
  v_xor_b32 v44, s76, v16
  v_xor_b32 v45, s76, v20
  v_or_b32 v44, v44, v45
  v_and_b32 v44, 1, v44
  v_cmp_ne_u32 vcc, 0, v44
  s_nop 2
  v_add_f32_dpp v36, v36, v36 row_ror:4 row_mask:0xf bank_mask:0xf
  v_add_f32_dpp v37, v37, v37 row_ror:4 row_mask:0xf bank_mask:0xf
  v_add_f32_dpp v38, v38, v38 row_ror:4 row_mask:0xf bank_mask:0xf
  v_add_f32_dpp v39, v39, v39 row_ror:4 row_mask:0xf bank_mask:0xf
  v_add_f32_dpp v36, v36, v36 row_ror:8 row_mask:0xf bank_mask:0xf
  v_add_f32_dpp v37, v37, v37 row_ror:8 row_mask:0xf bank_mask:0xf
  v_add_f32_dpp v38, v38, v38 row_ror:8 row_mask:0xf bank_mask:0xf
  v_add_f32_dpp v39, v39, v39 row_ror:8 row_mask:0xf bank_mask:0xf
  v_cvt_pk_bf16_f32 v36, v36, v37
  v_cvt_pk_bf16_f32 v37, v38, v39
  s_cbranch_vccnz L_rec_g_retry
  buffer_store_dwordx2 v[36:37], v10, s[4:7], s75 offen
  v_cmp_ne_u32 vcc, 0, v14
  ds_read_b128 v[96:99], v2 offset:6144
  ds_read_b128 v[100:103], v2 offset:7168
  ds_read_b128 v[104:107], v2 offset:8192
  ds_read_b128 v[108:111], v2 offset:9216
  ds_read_b128 v[112:115], v2 offset:10240
  ds_read_b128 v[116:119], v2 offset:11264
  ds_read_b128 v[120:123], v2 offset:12288
  ds_read_b128 v[124:127], v2 offset:13312
  v_lshlrev_b32 v14, 3, v0
  s_and_b32 s31, vcc_lo, 31
  s_or_b32 s31, s31, s29
  s_sleep 2
  buffer_load_dwordx4 v[16:19], v13, s[4:7], s77 offen offset:0 sc1
  buffer_load_dwordx4 v[20:23], v13, s[4:7], s77 offen offset:1024 sc1
  buffer_store_dwordx2 v[40:41], v10, s[4:7], s73 offen
  v_xor_b32 v28, 2048, v13
  v_xor_b32 v36, 4096, v13
  v_xor_b32 v44, 6144, v13
  s_waitcnt lgkmcnt(0)
  s_branch L_rec_top
L_rec_end:
L_rec_g_retry:
  s_sub_u32 s66, s66, 1
  s_cbranch_scc1 L_abort
  s_nop 0
  s_nop 7
  buffer_load_dwordx4 v[16:19], v13, s[4:7], s19 offen offset:0 sc1
  buffer_load_dwordx4 v[20:23], v13, s[4:7], s19 offen offset:1024 sc1
  s_waitcnt vmcnt(0)
  s_branch L_rec_g
L_rec_h2_retry:
  s_sub_u32 s66, s66, 1
  s_cbranch_scc1 L_abort
  s_nop 0
  buffer_load_dwordx4 v[16:19], v13, s[4:7], s77 offen offset:0 sc1
  buffer_load_dwordx4 v[20:23], v13, s[4:7], s77 offen offset:1024 sc1
  s_nop 7
  v_mov_b64 v[48:49], 0
  v_mov_b64 v[50:51], 0
  v_mov_b64 v[52:53], 0
  v_mov_b64 v[54:55], 0
  s_waitcnt vmcnt(0)
  s_branch L_rec_h2
L_rec_spin:
  s_sub_u32 s66, s66, 1
  s_cbranch_scc1 L_abort
  buffer_load_dword v14, v15, s[4:7], 0 offen sc1
  s_waitcnt vmcnt(0)
  v_cmp_ne_u32 vcc, 0, v14
  v_lshlrev_b32 v14, 3, v0
  s_nop 3
  s_and_b32 s31, vcc_lo, 31
  s_or_b32 s31, s31, s29
  s_cmp_lg_u32 s31, 31
  s_cbranch_scc1 L_rec_spin
  s_branch L_rec_spun
L_rec_done:
  s_branch L_end
L_s1:
  s_lshl_b32 s29, s14, 10
  v_lshrrev_b32 v66, 4, v0
  v_and_b32 v67, 15, v0
  s_load_dwordx2 s[80:81], s[0:1], 16
  s_mov_b32 s82, 4194304
  s_mov_b32 s83, 0x20000
  s_load_dwordx2 s[84:85], s[0:1], 24
  s_mov_b32 s86, 4194304
  s_mov_b32 s87, 0x20000
  s_load_dwordx2 s[88:89], s[0:1], 32
  s_mov_b32 s90, 4194304
  s_mov_b32 s91, 0x20000
  s_lshl_b32 s67, s14, 2
  v_add_u32 v66, s67, v66
  v_mul_u32_u24 v66, 8192, v66
  v_lshl_add_u32 v24, v67, 4, v66
  s_lshl_b32 s40, s13, 8
  v_lshrrev_b32 v60, 5, v0
  v_bfe_u32 v61, v0, 2, 2
  v_lshl_add_u32 v60, v60, 3, v61
  v_lshlrev_b32 v60, 8, v60
  v_bfe_u32 v61, v0, 4, 1
  v_and_b32 v62, 3, v0
  v_lshl_add_u32 v61, v61, 2, v62
  v_and_b32 v63, 1, v61
  v_lshrrev_b32 v64, 1, v61
  v_lshlrev_b32 v62, 5, v63
  v_lshl_add_u32 v62, v64, 3, v62
  s_lshl_b32 s67, s14, 6
  v_add3_u32 v60, v60, v62, s67
  v_mov_b32 v28, v60
  v_add_u32 v29, 0x10000, v60
  v_add_u32 v30, 0x20000, v60
  v_lshrrev_b32 v60, 5, v0
  v_bfe_u32 v61, v0, 2, 2
  v_lshl_add_u32 v60, v60, 3, v61
  v_lshlrev_b32 v60, 8, v60
  v_bfe_u32 v61, v0, 4, 1
  v_and_b32 v62, 3, v0
  v_lshl_add_u32 v61, v61, 2, v62
  v_lshlrev_b32 v62, 3, v61
  s_lshl_b32 s67, s14, 6
  v_add3_u32 v60, v60, v62, s67
  v_mov_b32 v32, v60
  v_add_u32 v33, 0x10000, v60
  v_add_u32 v34, 0x20000, v60
  s_waitcnt lgkmcnt(0)
  s_add_u32 s67, s29, 0
  s_mov_b32 m0, s67
  s_add_u32 s68, s40, 0
  buffer_load_dwordx4 v24, s[80:83], s68 offen lds
  s_add_u32 s67, s29, 4096
  s_mov_b32 m0, s67
  s_add_u32 s68, s40, 131072
  buffer_load_dwordx4 v24, s[80:83], s68 offen lds
  s_add_u32 s67, s29, 8192
  s_mov_b32 m0, s67
  s_add_u32 s68, s40, 262144
  buffer_load_dwordx4 v24, s[80:83], s68 offen lds
  s_add_u32 s67, s29, 12288
  s_mov_b32 m0, s67
  s_add_u32 s68, s40, 393216
  buffer_load_dwordx4 v24, s[80:83], s68 offen lds
  s_add_u32 s67, s29, 16384
  s_mov_b32 m0, s67
  s_add_u32 s68, s40, 524288
  buffer_load_dwordx4 v24, s[80:83], s68 offen lds
  s_add_u32 s67, s29, 20480
  s_mov_b32 m0, s67
  s_add_u32 s68, s40, 655360
  buffer_load_dwordx4 v24, s[80:83], s68 offen lds
  s_add_u32 s67, s29, 24576
  s_mov_b32 m0, s67
  s_add_u32 s68, s40, 786432
  buffer_load_dwordx4 v24, s[80:83], s68 offen lds
  s_add_u32 s67, s29, 28672
  s_mov_b32 m0, s67
  s_add_u32 s68, s40, 917504
  buffer_load_dwordx4 v24, s[80:83], s68 offen lds
  s_add_u32 s67, s29, 32768
  s_mov_b32 m0, s67
  s_add_u32 s68, s40, 1048576
  buffer_load_dwordx4 v24, s[80:83], s68 offen lds
  s_add_u32 s67, s29, 36864
  s_mov_b32 m0, s67
  s_add_u32 s68, s40, 1179648
  buffer_load_dwordx4 v24, s[80:83], s68 offen lds
  s_add_u32 s67, s29, 40960
  s_mov_b32 m0, s67
  s_add_u32 s68, s40, 1310720
  buffer_load_dwordx4 v24, s[80:83], s68 offen lds
  s_add_u32 s67, s29, 45056
  s_mov_b32 m0, s67
  s_add_u32 s68, s40, 1441792
  buffer_load_dwordx4 v24, s[80:83], s68 offen lds
  s_add_u32 s67, s29, 49152
  s_mov_b32 m0, s67
  s_add_u32 s68, s40, 1572864
  buffer_load_dwordx4 v24, s[80:83], s68 offen lds
  s_add_u32 s67, s29, 53248
  s_mov_b32 m0, s67
  s_add_u32 s68, s40, 1703936
  buffer_load_dwordx4 v24, s[80:83], s68 offen lds
  s_add_u32 s67, s29, 57344
  s_mov_b32 m0, s67
  s_add_u32 s68, s40, 1835008
  buffer_load_dwordx4 v24, s[80:83], s68 offen lds
  s_add_u32 s67, s29, 61440
  s_mov_b32 m0, s67
  s_add_u32 s68, s40, 1966080
  buffer_load_dwordx4 v24, s[80:83], s68 offen lds
  s_add_u32 s67, s29, 65536
  s_mov_b32 m0, s67
  s_add_u32 s68, s40, 2097152
  buffer_load_dwordx4 v24, s[80:83], s68 offen lds
  s_add_u32 s67, s29, 69632
  s_mov_b32 m0, s67
  s_add_u32 s68, s40, 2228224
  buffer_load_dwordx4 v24, s[80:83], s68 offen lds
  s_add_u32 s67, s29, 73728
  s_mov_b32 m0, s67
  s_add_u32 s68, s40, 2359296
  buffer_load_dwordx4 v24, s[80:83], s68 offen lds
  s_add_u32 s67, s29, 77824
  s_mov_b32 m0, s67
  s_add_u32 s68, s40, 2490368
  buffer_load_dwordx4 v24, s[80:83], s68 offen lds
  s_add_u32 s67, s29, 81920
  s_mov_b32 m0, s67
  s_add_u32 s68, s40, 2621440
  buffer_load_dwordx4 v24, s[80:83], s68 offen lds
  s_add_u32 s67, s29, 86016
  s_mov_b32 m0, s67
  s_add_u32 s68, s40, 2752512
  buffer_load_dwordx4 v24, s[80:83], s68 offen lds
  s_add_u32 s67, s29, 90112
  s_mov_b32 m0, s67
  s_add_u32 s68, s40, 2883584
  buffer_load_dwordx4 v24, s[80:83], s68 offen lds
  s_add_u32 s67, s29, 94208
  s_mov_b32 m0, s67
  s_add_u32 s68, s40, 3014656
  buffer_load_dwordx4 v24, s[80:83], s68 offen lds
  s_add_u32 s67, s29, 98304
  s_mov_b32 m0, s67
  s_add_u32 s68, s40, 3145728
  buffer_load_dwordx4 v24, s[80:83], s68 offen lds
  s_add_u32 s67, s29, 102400
  s_mov_b32 m0, s67
  s_add_u32 s68, s40, 3276800
  buffer_load_dwordx4 v24, s[80:83], s68 offen lds
  s_add_u32 s67, s29, 106496
  s_mov_b32 m0, s67
  s_add_u32 s68, s40, 3407872
  buffer_load_dwordx4 v24, s[80:83], s68 offen lds
  s_add_u32 s67, s29, 110592
  s_mov_b32 m0, s67
  s_add_u32 s68, s40, 3538944
  buffer_load_dwordx4 v24, s[80:83], s68 offen lds
  s_add_u32 s67, s29, 114688
  s_mov_b32 m0, s67
  s_add_u32 s68, s40, 3670016
  buffer_load_dwordx4 v24, s[80:83], s68 offen lds
  s_add_u32 s67, s29, 118784
  s_mov_b32 m0, s67
  s_add_u32 s68, s40, 3801088
  buffer_load_dwordx4 v24, s[80:83], s68 offen lds
  s_add_u32 s67, s29, 122880
  s_mov_b32 m0, s67
  s_add_u32 s68, s40, 3932160
  buffer_load_dwordx4 v24, s[80:83], s68 offen lds
  s_add_u32 s67, s29, 126976
  s_mov_b32 m0, s67
  s_add_u32 s68, s40, 4063232
  buffer_load_dwordx4 v24, s[80:83], s68 offen lds
  s_waitcnt vmcnt(28)
  s_barrier
  s_add_u32 s67, s29, 131072
  s_mov_b32 m0, s67
  s_add_u32 s68, s40, 0
  buffer_load_dwordx4 v24, s[84:87], s68 offen lds
  s_add_u32 s67, s29, 135168
  s_mov_b32 m0, s67
  s_add_u32 s68, s40, 131072
  buffer_load_dwordx4 v24, s[84:87], s68 offen lds
  s_add_u32 s67, s29, 139264
  s_mov_b32 m0, s67
  s_add_u32 s68, s40, 262144
  buffer_load_dwordx4 v24, s[84:87], s68 offen lds
  s_add_u32 s67, s29, 143360
  s_mov_b32 m0, s67
  s_add_u32 s68, s40, 393216
  buffer_load_dwordx4 v24, s[84:87], s68 offen lds
  ds_read_b64_tr_b16 a[0:1], v28 offset:0
  ds_read_b64_tr_b16 a[2:3], v28 offset:1024
  ds_read_b64_tr_b16 a[4:5], v28 offset:4096
  ds_read_b64_tr_b16 a[6:7], v28 offset:5120
  ds_read_b64_tr_b16 a[8:9], v28 offset:8192
  ds_read_b64_tr_b16 a[10:11], v28 offset:9216
  ds_read_b64_tr_b16 a[12:13], v28 offset:12288
  ds_read_b64_tr_b16 a[14:15], v28 offset:13312
  s_waitcnt vmcnt(28) lgkmcnt(0)
  s_barrier
  s_add_u32 s67, s29, 0
  s_mov_b32 m0, s67
  s_add_u32 s68, s40, 524288
  buffer_load_dwordx4 v24, s[84:87], s68 offen lds
  s_add_u32 s67, s29, 4096
  s_mov_b32 m0, s67
  s_add_u32 s68, s40, 655360
  buffer_load_dwordx4 v24, s[84:87], s68 offen lds
  s_add_u32 s67, s29, 8192
  s_mov_b32 m0, s67
  s_add_u32 s68, s40, 786432
  buffer_load_dwordx4 v24, s[84:87], s68 offen lds
  s_add_u32 s67, s29, 12288
  s_mov_b32 m0, s67
  s_add_u32 s68, s40, 917504
  buffer_load_dwordx4 v24, s[84:87], s68 offen lds
  ds_read_b64_tr_b16 a[16:17], v28 offset:16384
  ds_read_b64_tr_b16 a[18:19], v28 offset:17408
  ds_read_b64_tr_b16 a[20:21], v28 offset:20480
  ds_read_b64_tr_b16 a[22:23], v28 offset:21504
  ds_read_b64_tr_b16 a[24:25], v28 offset:24576
  ds_read_b64_tr_b16 a[26:27], v28 offset:25600
  ds_read_b64_tr_b16 a[28:29], v28 offset:28672
  ds_read_b64_tr_b16 a[30:31], v28 offset:29696
  s_waitcnt vmcnt(28) lgkmcnt(0)
  s_barrier
  s_add_u32 s67, s29, 16384
  s_mov_b32 m0, s67
  s_add_u32 s68, s40, 1048576
  buffer_load_dwordx4 v24, s[84:87], s68 offen lds
  s_add_u32 s67, s29, 20480
  s_mov_b32 m0, s67
  s_add_u32 s68, s40, 1179648
  buffer_load_dwordx4 v24, s[84:87], s68 offen lds
  s_add_u32 s67, s29, 24576
  s_mov_b32 m0, s67
  s_add_u32 s68, s40, 1310720
  buffer_load_dwordx4 v24, s[84:87], s68 offen lds
  s_add_u32 s67, s29, 28672
  s_mov_b32 m0, s67
  s_add_u32 s68, s40, 1441792
  buffer_load_dwordx4 v24, s[84:87], s68 offen lds
  ds_read_b64_tr_b16 a[32:33], v28 offset:32768
  ds_read_b64_tr_b16 a[34:35], v28 offset:33792
  ds_read_b64_tr_b16 a[36:37], v28 offset:36864
  ds_read_b64_tr_b16 a[38:39], v28 offset:37888
  ds_read_b64_tr_b16 a[40:41], v28 offset:40960
  ds_read_b64_tr_b16 a[42:43], v28 offset:41984
  ds_read_b64_tr_b16 a[44:45], v28 offset:45056
  ds_read_b64_tr_b16 a[46:47], v28 offset:46080
  s_waitcnt vmcnt(28) lgkmcnt(0)
  s_barrier
  s_add_u32 s67, s29, 32768
  s_mov_b32 m0, s67
  s_add_u32 s68, s40, 1572864
  buffer_load_dwordx4 v24, s[84:87], s68 offen lds
  s_add_u32 s67, s29, 36864
  s_mov_b32 m0, s67
  s_add_u32 s68, s40, 1703936
  buffer_load_dwordx4 v24, s[84:87], s68 offen lds
  s_add_u32 s67, s29, 40960
  s_mov_b32 m0, s67
  s_add_u32 s68, s40, 1835008
  buffer_load_dwordx4 v24, s[84:87], s68 offen lds
  s_add_u32 s67, s29, 45056
  s_mov_b32 m0, s67
  s_add_u32 s68, s40, 1966080
  buffer_load_dwordx4 v24, s[84:87], s68 offen lds
  ds_read_b64_tr_b16 a[48:49], v28 offset:49152
  ds_read_b64_tr_b16 a[50:51], v28 offset:50176
  ds_read_b64_tr_b16 a[52:53], v28 offset:53248
  ds_read_b64_tr_b16 a[54:55], v28 offset:54272
  ds_read_b64_tr_b16 a[56:57], v28 offset:57344
  ds_read_b64_tr_b16 a[58:59], v28 offset:58368
  ds_read_b64_tr_b16 a[60:61], v28 offset:61440
  ds_read_b64_tr_b16 a[62:63], v28 offset:62464
  s_waitcnt vmcnt(28) lgkmcnt(0)
  s_barrier
  s_add_u32 s67, s29, 49152
  s_mov_b32 m0, s67
  s_add_u32 s68, s40, 2097152
  buffer_load_dwordx4 v24, s[84:87], s68 offen lds
  s_add_u32 s67, s29, 53248
  s_mov_b32 m0, s67
  s_add_u32 s68, s40, 2228224
  buffer_load_dwordx4 v24, s[84:87], s68 offen lds
  s_add_u32 s67, s29, 57344
  s_mov_b32 m0, s67
  s_add_u32 s68, s40, 2359296
  buffer_load_dwordx4 v24, s[84:87], s68 offen lds
  s_add_u32 s67, s29, 61440
  s_mov_b32 m0, s67
  s_add_u32 s68, s40, 2490368
  buffer_load_dwordx4 v24, s[84:87], s68 offen lds
  ds_read_b64_tr_b16 a[64:65], v29 offset:0
  ds_read_b64_tr_b16 a[66:67], v29 offset:1024
  ds_read_b64_tr_b16 a[68:69], v29 offset:4096
  ds_read_b64_tr_b16 a[70:71], v29 offset:5120
  ds_read_b64_tr_b16 a[72:73], v29 offset:8192
  ds_read_b64_tr_b16 a[74:75], v29 offset:9216
  ds_read_b64_tr_b16 a[76:77], v29 offset:12288
  ds_read_b64_tr_b16 a[78:79], v29 offset:13312
  s_waitcnt vmcnt(28) lgkmcnt(0)
  s_barrier
  s_add_u32 s67, s29, 65536
  s_mov_b32 m0, s67
  s_add_u32 s68, s40, 2621440
  buffer_load_dwordx4 v24, s[84:87], s68 offen lds
  s_add_u32 s67, s29, 69632
  s_mov_b32 m0, s67
  s_add_u32 s68, s40, 2752512
  buffer_load_dwordx4 v24, s[84:87], s68 offen lds
  s_add_u32 s67, s29, 73728
  s_mov_b32 m0, s67
  s_add_u32 s68, s40, 2883584
  buffer_load_dwordx4 v24, s[84:87], s68 offen lds
  s_add_u32 s67, s29, 77824
  s_mov_b32 m0, s67
  s_add_u32 s68, s40, 3014656
  buffer_load_dwordx4 v24, s[84:87], s68 offen lds
  ds_read_b64_tr_b16 a[80:81], v29 offset:16384
  ds_read_b64_tr_b16 a[82:83], v29 offset:17408
  ds_read_b64_tr_b16 a[84:85], v29 offset:20480
  ds_read_b64_tr_b16 a[86:87], v29 offset:21504
  ds_read_b64_tr_b16 a[88:89], v29 offset:24576
  ds_read_b64_tr_b16 a[90:91], v29 offset:25600
  ds_read_b64_tr_b16 a[92:93], v29 offset:28672
  ds_read_b64_tr_b16 a[94:95], v29 offset:29696
  s_waitcnt vmcnt(28) lgkmcnt(0)
  s_barrier
  s_add_u32 s67, s29, 81920
  s_mov_b32 m0, s67
  s_add_u32 s68, s40, 3145728
  buffer_load_dwordx4 v24, s[84:87], s68 offen lds
  s_add_u32 s67, s29, 86016
  s_mov_b32 m0, s67
  s_add_u32 s68, s40, 3276800
  buffer_load_dwordx4 v24, s[84:87], s68 offen lds
  s_add_u32 s67, s29, 90112
  s_mov_b32 m0, s67
  s_add_u32 s68, s40, 3407872
  buffer_load_dwordx4 v24, s[84:87], s68 offen lds
  s_add_u32 s67, s29, 94208
  s_mov_b32 m0, s67
  s_add_u32 s68, s40, 3538944
  buffer_load_dwordx4 v24, s[84:87], s68 offen lds
  ds_read_b64_tr_b16 a[96:97], v29 offset:32768
  ds_read_b64_tr_b16 a[98:99], v29 offset:33792
  ds_read_b64_tr_b16 a[100:101], v29 offset:36864
  ds_read_b64_tr_b16 a[102:103], v29 offset:37888
  ds_read_b64_tr_b16 a[104:105], v29 offset:40960
  ds_read_b64_tr_b16 a[106:107], v29 offset:41984
  ds_read_b64_tr_b16 a[108:109], v29 offset:45056
  ds_read_b64_tr_b16 a[110:111], v29 offset:46080
  s_waitcnt vmcnt(28) lgkmcnt(0)
  s_barrier
  s_add_u32 s67, s29, 98304
  s_mov_b32 m0, s67
  s_add_u32 s68, s40, 3670016
  buffer_load_dwordx4 v24, s[84:87], s68 offen lds
  s_add_u32 s67, s29, 102400
  s_mov_b32 m0, s67
  s_add_u32 s68, s40, 3801088
  buffer_load_dwordx4 v24, s[84:87], s68 offen lds
  s_add_u32 s67, s29, 106496
  s_mov_b32 m0, s67
  s_add_u32 s68, s40, 3932160
  buffer_load_dwordx4 v24, s[84:87], s68 offen lds
  s_add_u32 s67, s29, 110592
  s_mov_b32 m0, s67
  s_add_u32 s68, s40, 4063232
  buffer_load_dwordx4 v24, s[84:87], s68 offen lds
  ds_read_b64_tr_b16 a[112:113], v29 offset:49152
  ds_read_b64_tr_b16 a[114:115], v29 offset:50176
  ds_read_b64_tr_b16 a[116:117], v29 offset:53248
  ds_read_b64_tr_b16 a[118:119], v29 offset:54272
  ds_read_b64_tr_b16 a[120:121], v29 offset:57344
  ds_read_b64_tr_b16 a[122:123], v29 offset:58368
  ds_read_b64_tr_b16 a[124:125], v29 offset:61440
  ds_read_b64_tr_b16 a[126:127], v29 offset:62464
  s_waitcnt vmcnt(28) lgkmcnt(0)
  s_barrier
  s_add_u32 s67, s29, 114688
  s_mov_b32 m0, s67
  s_add_u32 s68, s40, 0
  buffer_load_dwordx4 v24, s[88:91], s68 offen lds
  s_add_u32 s67, s29, 118784
  s_mov_b32 m0, s67
  s_add_u32 s68, s40, 131072
  buffer_load_dwordx4 v24, s[88:91], s68 offen lds
  s_add_u32 s67, s29, 122880
  s_mov_b32 m0, s67
  s_add_u32 s68, s40, 262144
  buffer_load_dwordx4 v24, s[88:91], s68 offen lds
  s_add_u32 s67, s29, 126976
  s_mov_b32 m0, s67
  s_add_u32 s68, s40, 393216
  buffer_load_dwordx4 v24, s[88:91], s68 offen lds
  ds_read_b64_tr_b16 a[128:129], v30 offset:0
  ds_read_b64_tr_b16 a[130:131], v30 offset:1024
  ds_read_b64_tr_b16 a[132:133], v30 offset:4096
  ds_read_b64_tr_b16 a[134:135], v30 offset:5120
  ds_read_b64_tr_b16 a[136:137], v30 offset:8192
  ds_read_b64_tr_b16 a[138:139], v30 offset:9216
  ds_read_b64_tr_b16 a[140:141], v30 offset:12288
  ds_read_b64_tr_b16 a[142:143], v30 offset:13312
  s_waitcnt vmcnt(28) lgkmcnt(0)
  s_barrier
  s_add_u32 s67, s29, 131072
  s_mov_b32 m0, s67
  s_add_u32 s68, s40, 524288
  buffer_load_dwordx4 v24, s[88:91], s68 offen lds
  s_add_u32 s67, s29, 135168
  s_mov_b32 m0, s67
  s_add_u32 s68, s40, 655360
  buffer_load_dwordx4 v24, s[88:91], s68 offen lds
  s_add_u32 s67, s29, 139264
  s_mov_b32 m0, s67
  s_add_u32 s68, s40, 786432
  buffer_load_dwordx4 v24, s[88:91], s68 offen lds
  s_add_u32 s67, s29, 143360
  s_mov_b32 m0, s67
  s_add_u32 s68, s40, 917504
  buffer_load_dwordx4 v24, s[88:91], s68 offen lds
  ds_read_b64_tr_b16 a[144:145], v28 offset:0
  ds_read_b64_tr_b16 a[146:147], v28 offset:1024
  ds_read_b64_tr_b16 a[148:149], v28 offset:4096
  ds_read_b64_tr_b16 a[150:151], v28 offset:5120
  ds_read_b64_tr_b16 a[152:153], v28 offset:8192
  ds_read_b64_tr_b16 a[154:155], v28 offset:9216
  ds_read_b64_tr_b16 a[156:157], v28 offset:12288
  ds_read_b64_tr_b16 a[158:159], v28 offset:13312
  s_waitcnt vmcnt(28) lgkmcnt(0)
  s_barrier
  s_add_u32 s67, s29, 0
  s_mov_b32 m0, s67
  s_add_u32 s68, s40, 1048576
  buffer_load_dwordx4 v24, s[88:91], s68 offen lds
  s_add_u32 s67, s29, 4096
  s_mov_b32 m0, s67
  s_add_u32 s68, s40, 1179648
  buffer_load_dwordx4 v24, s[88:91], s68 offen lds
  s_add_u32 s67, s29, 8192
  s_mov_b32 m0, s67
  s_add_u32 s68, s40, 1310720
  buffer_load_dwordx4 v24, s[88:91], s68 offen lds
  s_add_u32 s67, s29, 12288
  s_mov_b32 m0, s67
  s_add_u32 s68, s40, 1441792
  buffer_load_dwordx4 v24, s[88:91], s68 offen lds
  ds_read_b64_tr_b16 a[160:161], v28 offset:16384
  ds_read_b64_tr_b16 a[162:163], v28 offset:17408
  ds_read_b64_tr_b16 a[164:165], v28 offset:20480
  ds_read_b64_tr_b16 a[166:167], v28 offset:21504
  ds_read_b64_tr_b16 a[168:169], v28 offset:24576
  ds_read_b64_tr_b16 a[170:171], v28 offset:25600
  ds_read_b64_tr_b16 a[172:173], v28 offset:28672
  ds_read_b64_tr_b16 a[174:175], v28 offset:29696
  s_waitcnt vmcnt(28) lgkmcnt(0)
  s_barrier
  s_add_u32 s67, s29, 16384
  s_mov_b32 m0, s67
  s_add_u32 s68, s40, 1572864
  buffer_load_dwordx4 v24, s[88:91], s68 offen lds
  s_add_u32 s67, s29, 20480
  s_mov_b32 m0, s67
  s_add_u32 s68, s40, 1703936
  buffer_load_dwordx4 v24, s[88:91], s68 offen lds
  s_add_u32 s67, s29, 24576
  s_mov_b32 m0, s67
  s_add_u32 s68, s40, 1835008
  buffer_load_dwordx4 v24, s[88:91], s68 offen lds
  s_add_u32 s67, s29, 28672
  s_mov_b32 m0, s67
  s_add_u32 s68, s40, 1966080
  buffer_load_dwordx4 v24, s[88:91], s68 offen lds
  ds_read_b64_tr_b16 a[176:177], v28 offset:32768
  ds_read_b64_tr_b16 a[178:179], v28 offset:33792
  ds_read_b64_tr_b16 a[180:181], v28 offset:36864
  ds_read_b64_tr_b16 a[182:183], v28 offset:37888
  ds_read_b64_tr_b16 a[184:185], v28 offset:40960
  ds_read_b64_tr_b16 a[186:187], v28 offset:41984
  ds_read_b64_tr_b16 a[188:189], v28 offset:45056
  ds_read_b64_tr_b16 a[190:191], v28 offset:46080
  s_waitcnt vmcnt(28) lgkmcnt(0)
  s_barrier
  s_add_u32 s67, s29, 32768
  s_mov_b32 m0, s67
  s_add_u32 s68, s40, 2097152
  buffer_load_dwordx4 v24, s[88:91], s68 offen lds
  s_add_u32 s67, s29, 36864
  s_mov_b32 m0, s67
  s_add_u32 s68, s40, 2228224
  buffer_load_dwordx4 v24, s[88:91], s68 offen lds
  s_add_u32 s67, s29, 40960
  s_mov_b32 m0, s67
  s_add_u32 s68, s40, 2359296
  buffer_load_dwordx4 v24, s[88:91], s68 offen lds
  s_add_u32 s67, s29, 45056
  s_mov_b32 m0, s67
  s_add_u32 s68, s40, 2490368
  buffer_load_dwordx4 v24, s[88:91], s68 offen lds
  ds_read_b64_tr_b16 a[192:193], v28 offset:49152
  ds_read_b64_tr_b16 a[194:195], v28 offset:50176
  ds_read_b64_tr_b16 a[196:197], v28 offset:53248
  ds_read_b64_tr_b16 a[198:199], v28 offset:54272
  ds_read_b64_tr_b16 a[200:201], v28 offset:57344
  ds_read_b64_tr_b16 a[202:203], v28 offset:58368
  ds_read_b64_tr_b16 a[204:205], v28 offset:61440
  ds_read_b64_tr_b16 a[206:207], v28 offset:62464
  s_waitcnt vmcnt(28) lgkmcnt(0)
  s_barrier
  s_add_u32 s67, s29, 49152
  s_mov_b32 m0, s67
  s_add_u32 s68, s40, 2621440
  buffer_load_dwordx4 v24, s[88:91], s68 offen lds
  s_add_u32 s67, s29, 53248
  s_mov_b32 m0, s67
  s_add_u32 s68, s40, 2752512
  buffer_load_dwordx4 v24, s[88:91], s68 offen lds
  s_add_u32 s67, s29, 57344
  s_mov_b32 m0, s67
  s_add_u32 s68, s40, 2883584
  buffer_load_dwordx4 v24, s[88:91], s68 offen lds
  s_add_u32 s67, s29, 61440
  s_mov_b32 m0, s67
  s_add_u32 s68, s40, 3014656
  buffer_load_dwordx4 v24, s[88:91], s68 offen lds
  ds_read_b64_tr_b16 a[208:209], v29 offset:0
  ds_read_b64_tr_b16 a[210:211], v29 offset:1024
  ds_read_b64_tr_b16 a[212:213], v29 offset:4096
  ds_read_b64_tr_b16 a[214:215], v29 offset:5120
  ds_read_b64_tr_b16 a[216:217], v29 offset:8192
  ds_read_b64_tr_b16 a[218:219], v29 offset:9216
  ds_read_b64_tr_b16 a[220:221], v29 offset:12288
  ds_read_b64_tr_b16 a[222:223], v29 offset:13312
  s_waitcnt vmcnt(28) lgkmcnt(0)
  s_barrier
  s_add_u32 s67, s29, 65536
  s_mov_b32 m0, s67
  s_add_u32 s68, s40, 3145728
  buffer_load_dwordx4 v24, s[88:91], s68 offen lds
  s_add_u32 s67, s29, 69632
  s_mov_b32 m0, s67
  s_add_u32 s68, s40, 3276800
  buffer_load_dwordx4 v24, s[88:91], s68 offen lds
  s_add_u32 s67, s29, 73728
  s_mov_b32 m0, s67
  s_add_u32 s68, s40, 3407872
  buffer_load_dwordx4 v24, s[88:91], s68 offen lds
  s_add_u32 s67, s29, 77824
  s_mov_b32 m0, s67
  s_add_u32 s68, s40, 3538944
  buffer_load_dwordx4 v24, s[88:91], s68 offen lds
  ds_read_b64_tr_b16 a[224:225], v29 offset:16384
  ds_read_b64_tr_b16 a[226:227], v29 offset:17408
  ds_read_b64_tr_b16 a[228:229], v29 offset:20480
  ds_read_b64_tr_b16 a[230:231], v29 offset:21504
  ds_read_b64_tr_b16 a[232:233], v29 offset:24576
  ds_read_b64_tr_b16 a[234:235], v29 offset:25600
  ds_read_b64_tr_b16 a[236:237], v29 offset:28672
  ds_read_b64_tr_b16 a[238:239], v29 offset:29696
  s_waitcnt vmcnt(28) lgkmcnt(0)
  s_barrier
  s_add_u32 s67, s29, 81920
  s_mov_b32 m0, s67
  s_add_u32 s68, s40, 3670016
  buffer_load_dwordx4 v24, s[88:91], s68 offen lds
  s_add_u32 s67, s29, 86016
  s_mov_b32 m0, s67
  s_add_u32 s68, s40, 3801088
  buffer_load_dwordx4 v24, s[88:91], s68 offen lds
  s_add_u32 s67, s29, 90112
  s_mov_b32 m0, s67
  s_add_u32 s68, s40, 3932160
  buffer_load_dwordx4 v24, s[88:91], s68 offen lds
  s_add_u32 s67, s29, 94208
  s_mov_b32 m0, s67
  s_add_u32 s68, s40, 4063232
  buffer_load_dwordx4 v24, s[88:91], s68 offen lds
  ds_read_b64_tr_b16 a[240:241], v29 offset:32768
  ds_read_b64_tr_b16 a[242:243], v29 offset:33792
  ds_read_b64_tr_b16 a[244:245], v29 offset:36864
  ds_read_b64_tr_b16 a[246:247], v29 offset:37888
  ds_read_b64_tr_b16 a[248:249], v29 offset:40960
  ds_read_b64_tr_b16 a[250:251], v29 offset:41984
  ds_read_b64_tr_b16 a[252:253], v29 offset:45056
  ds_read_b64_tr_b16 a[254:255], v29 offset:46080
  s_waitcnt vmcnt(28) lgkmcnt(0)
  s_barrier
  ds_read_b64_tr_b16 v[128:129], v33 offset:49152
  ds_read_b64_tr_b16 v[130:131], v33 offset:50176
  ds_read_b64_tr_b16 v[132:133], v33 offset:53248
  ds_read_b64_tr_b16 v[134:135], v33 offset:54272
  ds_read_b64_tr_b16 v[136:137], v33 offset:57344
  ds_read_b64_tr_b16 v[138:139], v33 offset:58368
  ds_read_b64_tr_b16 v[140:141], v33 offset:61440
  ds_read_b64_tr_b16 v[142:143], v33 offset:62464
  s_waitcnt vmcnt(24) lgkmcnt(0)
  s_barrier
  ds_read_b64_tr_b16 v[144:145], v34 offset:0
  ds_read_b64_tr_b16 v[146:147], v34 offset:1024
  ds_read_b64_tr_b16 v[148:149], v34 offset:4096
  ds_read_b64_tr_b16 v[150:151], v34 offset:5120
  ds_read_b64_tr_b16 v[152:153], v34 offset:8192
  ds_read_b64_tr_b16 v[154:155], v34 offset:9216
  ds_read_b64_tr_b16 v[156:157], v34 offset:12288
  ds_read_b64_tr_b16 v[158:159], v34 offset:13312
  s_waitcnt vmcnt(20) lgkmcnt(0)
  s_barrier
  ds_read_b64_tr_b16 v[160:161], v32 offset:0
  ds_read_b64_tr_b16 v[162:163], v32 offset:1024
  ds_read_b64_tr_b16 v[164:165], v32 offset:4096
  ds_read_b64_tr_b16 v[166:167], v32 offset:5120
  ds_read_b64_tr_b16 v[168:169], v32 offset:8192
  ds_read_b64_tr_b16 v[170:171], v32 offset:9216
  ds_read_b64_tr_b16 v[172:173], v32 offset:12288
  ds_read_b64_tr_b16 v[174:175], v32 offset:13312
  s_waitcnt vmcnt(16) lgkmcnt(0)
  s_barrier
  ds_read_b64_tr_b16 v[176:177], v32 offset:16384
  ds_read_b64_tr_b16 v[178:179], v32 offset:17408
  ds_read_b64_tr_b16 v[180:181], v32 offset:20480
  ds_read_b64_tr_b16 v[182:183], v32 offset:21504
  ds_read_b64_tr_b16 v[184:185], v32 offset:24576
  ds_read_b64_tr_b16 v[186:187], v32 offset:25600
  ds_read_b64_tr_b16 v[188:189], v32 offset:28672
  ds_read_b64_tr_b16 v[190:191], v32 offset:29696
  s_waitcnt vmcnt(12) lgkmcnt(0)
  s_barrier
  ds_read_b64_tr_b16 v[192:193], v32 offset:32768
  ds_read_b64_tr_b16 v[194:195], v32 offset:33792
  ds_read_b64_tr_b16 v[196:197], v32 offset:36864
  ds_read_b64_tr_b16 v[198:199], v32 offset:37888
  ds_read_b64_tr_b16 v[200:201], v32 offset:40960
  ds_read_b64_tr_b16 v[202:203], v32 offset:41984
  ds_read_b64_tr_b16 v[204:205], v32 offset:45056
  ds_read_b64_tr_b16 v[206:207], v32 offset:46080
  s_waitcnt vmcnt(8) lgkmcnt(0)
  s_barrier
  ds_read_b64_tr_b16 v[208:209], v32 offset:49152
  ds_read_b64_tr_b16 v[210:211], v32 offset:50176
  ds_read_b64_tr_b16 v[212:213], v32 offset:53248
  ds_read_b64_tr_b16 v[214:215], v32 offset:54272
  ds_read_b64_tr_b16 v[216:217], v32 offset:57344
  ds_read_b64_tr_b16 v[218:219], v32 offset:58368
  ds_read_b64_tr_b16 v[220:221], v32 offset:61440
  ds_read_b64_tr_b16 v[222:223], v32 offset:62464
  s_waitcnt vmcnt(4) lgkmcnt(0)
  s_barrier
  ds_read_b64_tr_b16 v[224:225], v33 offset:0
  ds_read_b64_tr_b16 v[226:227], v33 offset:1024
  ds_read_b64_tr_b16 v[228:229], v33 offset:4096
  ds_read_b64_tr_b16 v[230:231], v33 offset:5120
  ds_read_b64_tr_b16 v[232:233], v33 offset:8192
  ds_read_b64_tr_b16 v[234:235], v33 offset:9216
  ds_read_b64_tr_b16 v[236:237], v33 offset:12288
  ds_read_b64_tr_b16 v[238:239], v33 offset:13312
  s_waitcnt vmcnt(0) lgkmcnt(0)
  s_barrier
  ds_read_b64_tr_b16 v[240:241], v33 offset:16384
  ds_read_b64_tr_b16 v[242:243], v33 offset:17408
  ds_read_b64_tr_b16 v[244:245], v33 offset:20480
  ds_read_b64_tr_b16 v[246:247], v33 offset:21504
  ds_read_b64_tr_b16 v[248:249], v33 offset:24576
  ds_read_b64_tr_b16 v[250:251], v33 offset:25600
  ds_read_b64_tr_b16 v[252:253], v33 offset:28672
  ds_read_b64_tr_b16 v[254:255], v33 offset:29696
  s_waitcnt lgkmcnt(0)
  s_barrier
  v_and_b32 v60, 31, v0
  v_lshrrev_b32 v61, 5, v0
  v_and_b32 v62, 15, v0
  v_xor_b32 v62, v62, v61
  v_lshlrev_b32 v62, 4, v62
  v_lshl_add_u32 v62, v60, 8, v62
  v_xor_b32 v8, 0, v62
  v_xor_b32 v9, 32, v62
  v_xor_b32 v10, 64, v62
  v_xor_b32 v11, 96, v62
  v_xor_b32 v12, 128, v62
  v_xor_b32 v13, 160, v62
  v_xor_b32 v14, 192, v62
  v_xor_b32 v15, 224, v62
  s_and_b32 s67, s14, 1
  s_lshl_b32 s67, s67, 3
  v_lshrrev_b32 v63, 4, v0
  v_and_b32 v62, 15, v0
  v_xor_b32 v62, v62, v63
  v_xor_b32 v62, s67, v62
  v_lshlrev_b32 v62, 4, v62
  v_lshl_add_u32 v16, v63, 10, v62
  v_xor_b32 v62, 64, v16
  v_add_u32 v17, 4096, v62
  v_lshlrev_b32 v1, 5, v60
  s_lshl_b32 s29, s14, 11
  s_lshl_b32 s41, s14, 13
  s_mov_b32 s22, 1
  s_mov_b32 s17, 0x1000
  s_mov_b32 s18, 0x1000
  s_mov_b32 s19, 64
  s_lshl_b32 s15, s12, 6
  s_mov_b32 s20, 0
  s_mov_b32 s21, 0
  s_lshl_b32 s69, s14, 2
  s_mov_b32 s15, s12
  s_mov_b32 s17, 11
  s_add_u32 s20, s12, 3
  s_add_u32 s21, s12, 64
  s_mov_b32 s38, 30
  s_mov_b32 s45, 3
  s_mov_b32 s18, 4008636142
  s_mov_b32 s67, 10
  s_cmp_eq_u32 s12, 2
  s_cselect_b32 s19, s67, 59
  s_add_u32 s35, s41, 2097152
  s_mul_i32 s36, s13, 24576
  s_add_u32 s36, s36, 67108864
  s_lshl_b32 s37, s13, 10
  s_add_u32 s37, s37, s69
  s_lshl_b32 s67, s14, 10
  v_lshlrev_b32 v62, 9, v61
  v_add_u32 v62, s67, v62
  v_lshrrev_b32 v63, 4, v60
  v_and_b32 v64, 15, v60
  v_lshl_add_u32 v65, v63, 12, v62
  v_lshl_add_u32 v65, v64, 4, v65
  v_add_u32 v3, 16384, v65
  v_bfe_u32 v64, v60, 3, 1
  v_lshl_add_u32 v65, v64, 12, v62
  v_bfe_u32 v64, v60, 2, 1
  v_lshl_add_u32 v65, v64, 7, v65
  v_lshl_add_u32 v65, v63, 6, v65
  v_and_b32 v64, 3, v60
  v_lshl_add_u32 v4, v64, 4, v65
  v_lshlrev_b32 v62, 1, v62
  v_lshl_add_u32 v62, v60, 4, v62
  v_add_u32 v5, 8192, v62
  s_lshr_b32 s67, s15, 6
  s_and_b32 s68, s15, 63
  s_lshl_b32 s69, s67, 7
  s_add_u32 s69, s69, s68
  s_lshl_b32 s70, s69, 15
  s_add_u32 s30, s70, s35
  s_lshl_b32 s70, s69, 10
  s_add_u32 s31, s70, 131072
  s_mul_i32 s70, s15, 786432
  s_add_u32 s32, s70, s36
  s_lshl_b32 s70, s67, 15
  s_lshl_b32 s68, s68, 4
  s_add_u32 s70, s70, s68
  s_add_u32 s33, s70, s37
  s_mov_b32 s25, s30
  s_mov_b32 s26, s31
  s_mov_b32 s27, s32
  s_mov_b32 s28, s33
  s_mov_b32 s16, 0
  s_mov_b32 s43, 536870912
  s_mov_b32 s47, 536870912
  s_mov_b32 s46, 536870912
  s_mov_b32 s23, 0
  s_mov_b32 s24, 536870912
  v_mov_b32 v7, 1
  v_mov_b32 v2, 0
  v_mbcnt_lo_u32_b32 v102, -1, 0
  v_and_b32 v100, 1, v102
  v_lshlrev_b32 v100, 7, v100
  v_bfe_u32 v102, v102, 1, 2
  v_lshl_add_u32 v100, v102, 2, v100
  v_add_u32 v100, s2, v100
L_go_7:
  s_sub_u32 s66, s66, 1
  s_cbranch_scc1 L_abort
  global_load_dword v101, v100, s[62:63] sc1
  s_waitcnt vmcnt(0)
  v_and_b32 v102, 0xff, v101
  v_cmp_eq_u32 vcc, 32, v102
  v_bfe_u32 v102, v101, 8, 8
  v_lshrrev_b32 v103, 16, v101
  s_and_b32 s67, vcc_lo, 0xff
  s_cmp_eq_u32 s67, 0xff
  s_cbranch_scc1 L_go_7_ok
  v_and_b32 v102, 0xff, v101
  v_cmp_lt_u32 vcc, 32, v102
  s_cbranch_vccnz L_abort
  s_sleep 8
  s_branch L_go_7
L_go_7_ok:
  v_mul_u32_u24 v102, v102, v102
  v_lshlrev_b32 v103, 5, v103
  v_cmp_eq_u32 vcc, v102, v103
  s_nop 3
  s_and_b32 s67, vcc_lo, 0xff
  s_cmp_lg_u32 s67, 0xff
  s_cbranch_scc1 L_regroup
L_s1_top:
  s_mov_b32 s42, 0
  s_waitcnt vmcnt(2)
  v_cmp_ne_u32 vcc, 0, v2
  s_nop 0
  s_cmp_eq_u64 vcc, exec
  s_cbranch_scc1 L_s1_dma
  s_waitcnt vmcnt(0)
  s_mov_b64 exec, 1
  buffer_store_dword v7, off, s[4:7], s24 sc1
  buffer_store_dword v7, off, s[4:7], s47 sc1
  s_mov_b64 exec, -1
  s_mov_b32 s24, 536870912
  s_mov_b32 s47, 536870912
L_s1_poll:
  s_sub_u32 s66, s66, 1
  s_cbranch_scc1 L_abort
  buffer_load_dword v2, v1, s[4:7], s26 offen sc1
  s_waitcnt vmcnt(0)
  v_cmp_ne_u32 vcc, 0, v2
  s_nop 0
  s_cmp_eq_u64 vcc, exec
  s_cbranch_scc0 L_s1_poll
L_s1_dma:
  s_add_u32 m0, s29, 0
  s_nop 0
  buffer_load_dwordx4 v16, s[4:7], s25 offen offset:0 sc1 lds
  s_add_u32 m0, s29, 1024
  s_nop 0
  buffer_load_dwordx4 v17, s[4:7], s25 offen offset:0 sc1 lds
  s_add_u32 m0, s29, 7936
  s_nop 0
  buffer_load_dwordx4 v16, s[4:7], s25 offen offset:256 sc1 lds
  s_add_u32 m0, s29, 8960
  s_nop 0
  buffer_load_dwordx4 v17, s[4:7], s25 offen offset:256 sc1 lds
  s_add_u32 m0, s29, 15872
  s_nop 0
  buffer_load_dwordx4 v16, s[4:7], s25 offen offset:512 sc1 lds
  s_add_u32 m0, s29, 16896
  s_nop 0
  buffer_load_dwordx4 v17, s[4:7], s25 offen offset:512 sc1 lds
  s_add_u32 m0, s29, 23808
  s_nop 0
  buffer_load_dwordx4 v16, s[4:7], s25 offen offset:768 sc1 lds
  s_add_u32 m0, s29, 24832
  s_nop 0
  buffer_load_dwordx4 v17, s[4:7], s25 offen offset:768 sc1 lds
  s_waitcnt vmcnt(8)
  s_mov_b64 exec, 1
  buffer_store_dword v7, off, s[4:7], s24 sc1
  buffer_store_dword v7, off, s[4:7], s47 sc1
  s_mov_b64 exec, -1
  s_mov_b32 s24, 536870912
  s_mov_b32 s47, 536870912
  s_waitcnt vmcnt(6)
  s_mov_b32 s44, 536870912
  s_mov_b32 s46, 536870912
  .p2align 3
L_s1_go:
  s_barrier
  s_nop 0
  ds_read_b128 v[24:27], v8 offset:0
  ds_read_b128 v[28:31], v9 offset:0
  ds_read_b128 v[32:35], v10 offset:0
  ds_read_b128 v[36:39], v11 offset:0
  ds_read_b128 v[40:43], v12 offset:0
  s_xor_b32 s29, s29, 32768
  s_waitcnt lgkmcnt(4)
  v_mfma_f32_32x32x16_bf16 v[64:79], a[128:131], v[24:27], 0
  ds_read_b128 v[44:47], v13 offset:0
  v_mfma_f32_32x32x16_bf16 v[80:95], v[24:27], v[128:131], 0
  v_cvt_pk_bf16_f32 v96, v48, v49
  v_cvt_pk_bf16_f32 v97, v50, v51
  v_cvt_pk_bf16_f32 v98, v52, v53
  v_cvt_pk_bf16_f32 v99, v54, v55
  s_waitcnt lgkmcnt(4)
  v_mfma_f32_32x32x16_bf16 v[64:79], a[132:135], v[28:31], v[64:79]
  ds_read_b128 v[24:27], v14 offset:0
  v_mfma_f32_32x32x16_bf16 v[80:95], v[28:31], v[132:135], v[80:95]
  v_cvt_pk_bf16_f32 v100, v56, v57
  v_cvt_pk_bf16_f32 v101, v58, v59
  v_cvt_pk_bf16_f32 v102, v60, v61
  v_cvt_pk_bf16_f32 v103, v62, v63
  s_waitcnt lgkmcnt(4)
  v_mfma_f32_32x32x16_bf16 v[64:79], a[136:139], v[32:35], v[64:79]
  ds_read_b128 v[28:31], v15 offset:0
  s_add_u32 s16, s16, 1
  s_lshr_b32 s22, s15, 6
  s_lshr_b32 s67, s18, s22
  v_mfma_f32_32x32x16_bf16 v[80:95], v[32:35], v[136:139], v[80:95]
  buffer_store_dwordx4 v[96:99], v3, s[4:7], s44 offen offset:0 sc1
  s_and_b32 s68, s18, s22
  s_mov_b32 s18, s67
  s_cmp_lt_u32 s20, 64
  s_waitcnt lgkmcnt(4)
  v_mfma_f32_32x32x16_bf16 v[64:79], a[140:143], v[36:39], v[64:79]
  ds_read_b128 v[32:35], v8 offset:8192
  s_cselect_b32 s67, s68, 0
  s_cmp_lt_u32 s16, s17
  s_cselect_b32 s67, 1, s67
  v_mfma_f32_32x32x16_bf16 v[80:95], v[36:39], v[140:143], v[80:95]
  buffer_store_dwordx4 v[100:103], v3, s[4:7], s44 offen offset:256 sc1
  s_cmp_lg_u32 s67, 0
  s_cselect_b32 s15, s20, s21
  s_cselect_b32 s68, 0, 2
  s_waitcnt lgkmcnt(4)
  v_mfma_f32_32x32x16_bf16 v[64:79], a[144:147], v[40:43], v[64:79]
  ds_read_b128 v[36:39], v9 offset:8192
  s_cselect_b32 s67, s45, 0
  s_add_u32 s21, s21, s68
  s_cmp_ge_u32 s20, s38
  v_mfma_f32_32x32x16_bf16 v[80:95], v[40:43], v[144:147], v[80:95]
  s_cselect_b32 s68, 2, 3
  s_min_u32 s67, s67, s68
  s_add_u32 s20, s20, s67
  s_waitcnt lgkmcnt(4)
  v_mfma_f32_32x32x16_bf16 v[64:79], a[148:151], v[44:47], v[64:79]
  ds_read_b128 v[40:43], v10 offset:8192
  s_lshr_b32 s67, s15, 6
  s_and_b32 s68, s15, 63
  s_lshl_b32 s69, s67, 7
  v_mfma_f32_32x32x16_bf16 v[80:95], v[44:47], v[148:151], v[80:95]
  s_add_u32 s69, s69, s68
  s_lshl_b32 s70, s69, 15
  s_add_u32 s30, s70, s35
  s_waitcnt lgkmcnt(4)
  v_mfma_f32_32x32x16_bf16 v[64:79], a[152:155], v[24:27], v[64:79]
  ds_read_b128 v[44:47], v11 offset:8192
  s_lshl_b32 s70, s69, 10
  s_add_u32 s31, s70, 131072
  s_mul_i32 s70, s15, 786432
  v_mfma_f32_32x32x16_bf16 v[80:95], v[24:27], v[152:155], v[80:95]
  s_add_u32 s32, s70, s36
  s_lshl_b32 s70, s67, 15
  s_lshl_b32 s68, s68, 4
  s_waitcnt lgkmcnt(4)
  v_mfma_f32_32x32x16_bf16 v[64:79], a[156:159], v[28:31], v[64:79]
  ds_read_b128 v[24:27], v12 offset:8192
  s_add_u32 s70, s70, s68
  s_add_u32 s33, s70, s37
  v_mfma_f32_32x32x16_bf16 v[80:95], v[28:31], v[156:159], v[80:95]
  s_waitcnt lgkmcnt(4)
  v_mfma_f32_32x32x16_bf16 v[64:79], a[160:163], v[32:35], v[64:79]
  ds_read_b128 v[28:31], v13 offset:8192
  v_mfma_f32_32x32x16_bf16 v[80:95], v[32:35], v[160:163], v[80:95]
  s_mov_b32 s47, s46
  s_waitcnt lgkmcnt(4)
  v_mfma_f32_32x32x16_bf16 v[64:79], a[164:167], v[36:39], v[64:79]
  ds_read_b128 v[32:35], v14 offset:8192
  v_mfma_f32_32x32x16_bf16 v[80:95], v[36:39], v[164:167], v[80:95]
  s_waitcnt lgkmcnt(4)
  v_mfma_f32_32x32x16_bf16 v[64:79], a[168:171], v[40:43], v[64:79]
  ds_read_b128 v[36:39], v15 offset:8192
  v_mfma_f32_32x32x16_bf16 v[80:95], v[40:43], v[168:171], v[80:95]
  s_waitcnt lgkmcnt(4)
  v_mfma_f32_32x32x16_bf16 v[64:79], a[172:175], v[44:47], v[64:79]
  s_cmp_lg_u32 s42, 0
  s_cbranch_scc1 L_s1_c3
  s_waitcnt vmcnt(4)
L_s1_c3:
  s_waitcnt vmcnt(7)
  s_barrier
  ds_read_b128 v[40:43], v8 offset:16384
  v_mfma_f32_32x32x16_bf16 v[80:95], v[44:47], v[172:175], v[80:95]
  s_waitcnt lgkmcnt(4)
  v_mfma_f32_32x32x16_bf16 v[64:79], a[176:179], v[24:27], v[64:79]
  ds_read_b128 v[44:47], v9 offset:16384
  v_mfma_f32_32x32x16_bf16 v[80:95], v[24:27], v[176:179], v[80:95]
  buffer_load_dword v2, v1, s[4:7], s31 offen sc1
  s_waitcnt lgkmcnt(4)
  v_mfma_f32_32x32x16_bf16 v[64:79], a[180:183], v[28:31], v[64:79]
  ds_read_b128 v[24:27], v10 offset:16384
  v_mfma_f32_32x32x16_bf16 v[80:95], v[28:31], v[180:183], v[80:95]
  s_waitcnt lgkmcnt(4)
  v_mfma_f32_32x32x16_bf16 v[64:79], a[184:187], v[32:35], v[64:79]
  ds_read_b128 v[28:31], v11 offset:16384
  v_mfma_f32_32x32x16_bf16 v[80:95], v[32:35], v[184:187], v[80:95]
  s_waitcnt lgkmcnt(4)
  v_mfma_f32_32x32x16_bf16 v[64:79], a[188:191], v[36:39], v[64:79]
  ds_read_b128 v[32:35], v12 offset:16384
  v_mfma_f32_32x32x16_bf16 v[80:95], v[36:39], v[188:191], v[80:95]
  s_waitcnt lgkmcnt(4)
  v_mfma_f32_32x32x16_bf16 v[64:79], a[192:195], v[40:43], v[64:79]
  ds_read_b128 v[36:39], v13 offset:16384
  v_mfma_f32_32x32x16_bf16 v[80:95], v[40:43], v[192:195], v[80:95]
  s_waitcnt lgkmcnt(4)
  v_mfma_f32_32x32x16_bf16 v[64:79], a[196:199], v[44:47], v[64:79]
  ds_read_b128 v[40:43], v14 offset:16384
  v_mfma_f32_32x32x16_bf16 v[80:95], v[44:47], v[196:199], v[80:95]
  s_waitcnt lgkmcnt(4)
  v_mfma_f32_32x32x16_bf16 v[64:79], a[200:203], v[24:27], v[64:79]
  ds_read_b128 v[44:47], v15 offset:16384
  v_mfma_f32_32x32x16_bf16 v[80:95], v[24:27], v[200:203], v[80:95]
  s_waitcnt lgkmcnt(4)
  v_mfma_f32_32x32x16_bf16 v[64:79], a[204:207], v[28:31], v[64:79]
  ds_read_b128 v[24:27], v8 offset:24576
  v_mfma_f32_32x32x16_bf16 v[80:95], v[28:31], v[204:207], v[80:95]
  s_waitcnt lgkmcnt(4)
  v_mfma_f32_32x32x16_bf16 v[64:79], a[208:211], v[32:35], v[64:79]
  ds_read_b128 v[28:31], v9 offset:24576
  v_mfma_f32_32x32x16_bf16 v[80:95], v[32:35], v[208:211], v[80:95]
  s_waitcnt vmcnt(0)
  v_cmp_ne_u32 vcc, 0, v2
  s_mov_b64 exec, 1
  buffer_store_dword v7, off, s[4:7], s24 sc1
  buffer_store_dword v7, off, s[4:7], s47 sc1
  s_mov_b64 exec, -1
  s_mov_b32 s24, 536870912
  s_mov_b32 s47, 536870912
  s_waitcnt lgkmcnt(4)
  v_mfma_f32_32x32x16_bf16 v[64:79], a[212:215], v[36:39], v[64:79]
  ds_read_b128 v[32:35], v10 offset:24576
  s_cmp_eq_u64 vcc, exec
  s_cselect_b32 s23, 1, 0
  s_cselect_b32 s34, s30, 536870912
  s_cmp_lt_u32 s16, s19
  s_cselect_b32 s34, s34, 536870912
  v_mfma_f32_32x32x16_bf16 v[80:95], v[36:39], v[212:215], v[80:95]
  s_waitcnt lgkmcnt(4)
  v_mfma_f32_32x32x16_bf16 v[64:79], a[216:219], v[40:43], v[64:79]
  ds_read_b128 v[36:39], v11 offset:24576
  v_mfma_f32_32x32x16_bf16 v[80:95], v[40:43], v[216:219], v[80:95]
  s_add_u32 m0, s29, 0
  s_nop 0
  buffer_load_dwordx4 v16, s[4:7], s34 offen offset:0 sc1 lds
  s_waitcnt lgkmcnt(4)
  v_mfma_f32_32x32x16_bf16 v[64:79], a[220:223], v[44:47], v[64:79]
  ds_read_b128 v[40:43], v12 offset:24576
  v_mfma_f32_32x32x16_bf16 v[80:95], v[44:47], v[220:223], v[80:95]
  s_add_u32 m0, s29, 1024
  s_nop 0
  buffer_load_dwordx4 v17, s[4:7], s34 offen offset:0 sc1 lds
  s_waitcnt lgkmcnt(4)
  v_mfma_f32_32x32x16_bf16 v[64:79], a[224:227], v[24:27], v[64:79]
  ds_read_b128 v[44:47], v13 offset:24576
  v_mfma_f32_32x32x16_bf16 v[80:95], v[24:27], v[224:227], v[80:95]
  s_add_u32 m0, s29, 7936
  s_nop 0
  buffer_load_dwordx4 v16, s[4:7], s34 offen offset:256 sc1 lds
  s_waitcnt lgkmcnt(4)
  v_mfma_f32_32x32x16_bf16 v[64:79], a[228:231], v[28:31], v[64:79]
  ds_read_b128 v[24:27], v14 offset:24576
  v_mfma_f32_32x32x16_bf16 v[80:95], v[28:31], v[228:231], v[80:95]
  s_add_u32 m0, s29, 8960
  s_nop 0
  buffer_load_dwordx4 v17, s[4:7], s34 offen offset:256 sc1 lds
  s_waitcnt lgkmcnt(4)
  v_mfma_f32_32x32x16_bf16 v[64:79], a[232:235], v[32:35], v[64:79]
  ds_read_b128 v[28:31], v15 offset:24576
  v_mfma_f32_32x32x16_bf16 v[80:95], v[32:35], v[232:235], v[80:95]
  s_add_u32 m0, s29, 15872
  s_nop 0
  buffer_load_dwordx4 v16, s[4:7], s34 offen offset:512 sc1 lds
  s_waitcnt lgkmcnt(4)
  v_mfma_f32_32x32x16_bf16 v[64:79], a[236:239], v[36:39], v[64:79]
  ds_read_b128 v[32:35], v8 offset:0
  v_mfma_f32_32x32x16_bf16 v[80:95], v[36:39], v[236:239], v[80:95]
  s_add_u32 m0, s29, 16896
  s_nop 0
  buffer_load_dwordx4 v17, s[4:7], s34 offen offset:512 sc1 lds
  s_waitcnt lgkmcnt(4)
  v_mfma_f32_32x32x16_bf16 v[64:79], a[240:243], v[40:43], v[64:79]
  ds_read_b128 v[36:39], v9 offset:0
  v_mfma_f32_32x32x16_bf16 v[80:95], v[40:43], v[240:243], v[80:95]
  s_add_u32 m0, s29, 23808
  s_nop 0
  buffer_load_dwordx4 v16, s[4:7], s34 offen offset:768 sc1 lds
  s_waitcnt lgkmcnt(4)
  v_mfma_f32_32x32x16_bf16 v[64:79], a[244:247], v[44:47], v[64:79]
  ds_read_b128 v[40:43], v10 offset:0
  v_mfma_f32_32x32x16_bf16 v[80:95], v[44:47], v[244:247], v[80:95]
  s_add_u32 m0, s29, 24832
  s_nop 0
  buffer_load_dwordx4 v17, s[4:7], s34 offen offset:768 sc1 lds
  s_waitcnt lgkmcnt(4)
  v_mfma_f32_32x32x16_bf16 v[64:79], a[248:251], v[24:27], v[64:79]
  ds_read_b128 v[44:47], v11 offset:0
  v_mfma_f32_32x32x16_bf16 v[80:95], v[24:27], v[248:251], v[80:95]
  s_waitcnt lgkmcnt(4)
  v_mfma_f32_32x32x16_bf16 v[64:79], a[252:255], v[28:31], v[64:79]
  ds_read_b128 v[24:27], v12 offset:0
  v_mfma_f32_32x32x16_bf16 v[80:95], v[28:31], v[252:255], v[80:95]
  s_waitcnt lgkmcnt(4)
  v_mfma_f32_32x32x16_bf16 v[48:63], a[0:3], v[32:35], 0
  ds_read_b128 v[28:31], v13 offset:0
  s_waitcnt lgkmcnt(4)
  v_mfma_f32_32x32x16_bf16 v[48:63], a[4:7], v[36:39], v[48:63]
  ds_read_b128 v[32:35], v14 offset:0
  s_waitcnt lgkmcnt(4)
  v_mfma_f32_32x32x16_bf16 v[48:63], a[8:11], v[40:43], v[48:63]
  ds_read_b128 v[36:39], v15 offset:0
  s_nop 0
  v_cvt_pk_bf16_f32 v104, v64, v65
  v_cvt_pk_bf16_f32 v105, v66, v67
  v_cvt_pk_bf16_f32 v106, v68, v69
  s_waitcnt lgkmcnt(4)
  v_mfma_f32_32x32x16_bf16 v[48:63], a[12:15], v[44:47], v[48:63]
  ds_read_b128 v[40:43], v8 offset:8192
  v_cvt_pk_bf16_f32 v107, v70, v71
  buffer_store_dwordx4 v[104:107], v4, s[4:7], s27 offen offset:0 sc1
  v_cvt_pk_bf16_f32 v108, v72, v73
  s_waitcnt lgkmcnt(4)
  v_mfma_f32_32x32x16_bf16 v[48:63], a[16:19], v[24:27], v[48:63]
  ds_read_b128 v[44:47], v9 offset:8192
  v_cvt_pk_bf16_f32 v109, v74, v75
  v_cvt_pk_bf16_f32 v110, v76, v77
  v_cvt_pk_bf16_f32 v111, v78, v79
  s_waitcnt lgkmcnt(4)
  v_mfma_f32_32x32x16_bf16 v[48:63], a[20:23], v[28:31], v[48:63]
  ds_read_b128 v[24:27], v10 offset:8192
  buffer_store_dwordx4 v[108:111], v4, s[4:7], s27 offen offset:256 sc1
  v_cvt_pk_bf16_f32 v112, v80, v81
  v_cvt_pk_bf16_f32 v113, v82, v83
  s_waitcnt lgkmcnt(4)
  v_mfma_f32_32x32x16_bf16 v[48:63], a[24:27], v[32:35], v[48:63]
  ds_read_b128 v[28:31], v11 offset:8192
  v_cvt_pk_bf16_f32 v114, v84, v85
  v_cvt_pk_bf16_f32 v115, v86, v87
  buffer_store_dwordx4 v[112:115], v5, s[4:7], s27 offen offset:0 sc1
  s_waitcnt lgkmcnt(4)
  v_mfma_f32_32x32x16_bf16 v[48:63], a[28:31], v[36:39], v[48:63]
  ds_read_b128 v[32:35], v12 offset:8192
  v_cvt_pk_bf16_f32 v116, v88, v89
  v_cvt_pk_bf16_f32 v117, v90, v91
  v_cvt_pk_bf16_f32 v118, v92, v93
  s_waitcnt lgkmcnt(4)
  v_mfma_f32_32x32x16_bf16 v[48:63], a[32:35], v[40:43], v[48:63]
  ds_read_b128 v[36:39], v13 offset:8192
  v_cvt_pk_bf16_f32 v119, v94, v95
  buffer_store_dwordx4 v[116:119], v5, s[4:7], s27 offen offset:512 sc1
  s_waitcnt lgkmcnt(4)
  v_mfma_f32_32x32x16_bf16 v[48:63], a[36:39], v[44:47], v[48:63]
  ds_read_b128 v[40:43], v14 offset:8192
  s_waitcnt lgkmcnt(4)
  v_mfma_f32_32x32x16_bf16 v[48:63], a[40:43], v[24:27], v[48:63]
  ds_read_b128 v[44:47], v15 offset:8192
  s_waitcnt lgkmcnt(4)
  v_mfma_f32_32x32x16_bf16 v[48:63], a[44:47], v[28:31], v[48:63]
  ds_read_b128 v[24:27], v8 offset:16384
  s_waitcnt lgkmcnt(4)
  v_mfma_f32_32x32x16_bf16 v[48:63], a[48:51], v[32:35], v[48:63]
  ds_read_b128 v[28:31], v9 offset:16384
  s_waitcnt lgkmcnt(4)
  v_mfma_f32_32x32x16_bf16 v[48:63], a[52:55], v[36:39], v[48:63]
  ds_read_b128 v[32:35], v10 offset:16384
  s_waitcnt lgkmcnt(4)
  v_mfma_f32_32x32x16_bf16 v[48:63], a[56:59], v[40:43], v[48:63]
  ds_read_b128 v[36:39], v11 offset:16384
  s_waitcnt lgkmcnt(4)
  v_mfma_f32_32x32x16_bf16 v[48:63], a[60:63], v[44:47], v[48:63]
  ds_read_b128 v[40:43], v12 offset:16384
  s_waitcnt lgkmcnt(4)
  v_mfma_f32_32x32x16_bf16 v[48:63], a[64:67], v[24:27], v[48:63]
  ds_read_b128 v[44:47], v13 offset:16384
  s_waitcnt lgkmcnt(4)
  v_mfma_f32_32x32x16_bf16 v[48:63], a[68:71], v[28:31], v[48:63]
  ds_read_b128 v[24:27], v14 offset:16384
  s_waitcnt lgkmcnt(4)
  v_mfma_f32_32x32x16_bf16 v[48:63], a[72:75], v[32:35], v[48:63]
  ds_read_b128 v[28:31], v15 offset:16384
  s_waitcnt lgkmcnt(4)
  v_mfma_f32_32x32x16_bf16 v[48:63], a[76:79], v[36:39], v[48:63]
  ds_read_b128 v[32:35], v8 offset:24576
  s_waitcnt lgkmcnt(4)
  v_mfma_f32_32x32x16_bf16 v[48:63], a[80:83], v[40:43], v[48:63]
  ds_read_b128 v[36:39], v9 offset:24576
  s_waitcnt lgkmcnt(4)
  v_mfma_f32_32x32x16_bf16 v[48:63], a[84:87], v[44:47], v[48:63]
  ds_read_b128 v[40:43], v10 offset:24576
  s_waitcnt lgkmcnt(4)
  v_mfma_f32_32x32x16_bf16 v[48:63], a[88:91], v[24:27], v[48:63]
  ds_read_b128 v[44:47], v11 offset:24576
  buffer_load_dword v2, v1, s[4:7], s31 offen sc1
  s_waitcnt lgkmcnt(4)
  v_mfma_f32_32x32x16_bf16 v[48:63], a[92:95], v[28:31], v[48:63]
  ds_read_b128 v[24:27], v12 offset:24576
  s_waitcnt lgkmcnt(4)
  v_mfma_f32_32x32x16_bf16 v[48:63], a[96:99], v[32:35], v[48:63]
  ds_read_b128 v[28:31], v13 offset:24576
  s_waitcnt lgkmcnt(4)
  v_mfma_f32_32x32x16_bf16 v[48:63], a[100:103], v[36:39], v[48:63]
  ds_read_b128 v[32:35], v14 offset:24576
  s_mov_b32 s24, s28
  s_add_u32 s46, s28, 65536
  s_mov_b32 s43, s27
  s_waitcnt lgkmcnt(4)
  v_mfma_f32_32x32x16_bf16 v[48:63], a[104:107], v[40:43], v[48:63]
  ds_read_b128 v[36:39], v15 offset:24576
  s_mov_b32 s25, s30
  s_mov_b32 s26, s31
  s_mov_b32 s27, s32
  s_waitcnt lgkmcnt(4)
  v_mfma_f32_32x32x16_bf16 v[48:63], a[108:111], v[44:47], v[48:63]
  s_mov_b32 s28, s33
  s_cmp_lt_u32 s16, s19
  s_cselect_b32 s23, s23, 0
  s_waitcnt lgkmcnt(3)
  v_mfma_f32_32x32x16_bf16 v[48:63], a[112:115], v[24:27], v[48:63]
  v_xor_b32 v8, 32768, v8
  v_xor_b32 v9, 32768, v9
  s_waitcnt lgkmcnt(2)
  v_mfma_f32_32x32x16_bf16 v[48:63], a[116:119], v[28:31], v[48:63]
  v_xor_b32 v10, 32768, v10
  v_xor_b32 v11, 32768, v11
  s_waitcnt lgkmcnt(1)
  v_mfma_f32_32x32x16_bf16 v[48:63], a[120:123], v[32:35], v[48:63]
  v_xor_b32 v12, 32768, v12
  v_xor_b32 v13, 32768, v13
  s_waitcnt lgkmcnt(0)
  v_mfma_f32_32x32x16_bf16 v[48:63], a[124:127], v[36:39], v[48:63]
  v_xor_b32 v14, 32768, v14
  v_xor_b32 v15, 32768, v15
  s_cmp_eq_u32 s22, 0
  s_cbranch_scc1 L_s1_l1
  s_waitcnt vmcnt(1)
  s_mov_b64 exec, 1
  buffer_store_dword v7, off, s[4:7], s24 sc1
  s_mov_b64 exec, -1
  s_mov_b32 s24, 536870912
L_s1_l1:
  s_cmp_eq_u32 s23, 0
  s_cbranch_scc1 L_s1_slow
  s_mov_b32 s42, 1
  s_mov_b32 s44, s43
  s_waitcnt vmcnt(9)
  s_branch L_s1_go
L_s1_slow:
  s_nop 7
  s_nop 0
  v_cvt_pk_bf16_f32 v96, v48, v49
  v_cvt_pk_bf16_f32 v97, v50, v51
  v_cvt_pk_bf16_f32 v98, v52, v53
  v_cvt_pk_bf16_f32 v99, v54, v55
  v_cvt_pk_bf16_f32 v100, v56, v57
  v_cvt_pk_bf16_f32 v101, v58, v59
  v_cvt_pk_bf16_f32 v102, v60, v61
  v_cvt_pk_bf16_f32 v103, v62, v63
  buffer_store_dwordx4 v[96:99], v3, s[4:7], s43 offen offset:0 sc1
  buffer_store_dwordx4 v[100:103], v3, s[4:7], s43 offen offset:256 sc1
  s_mov_b32 s47, s46
  s_cmp_lt_u32 s16, s19
  s_cbranch_scc1 L_s1_top
L_s1_done:
  s_waitcnt vmcnt(0)
  s_mov_b64 exec, 1
  buffer_store_dword v7, off, s[4:7], s24 sc1
  buffer_store_dword v7, off, s[4:7], s47 sc1
  s_mov_b64 exec, -1
  s_mov_b32 s24, 536870912
  s_mov_b32 s47, 536870912
  s_cmp_eq_u32 s12, 2
  s_cbranch_scc1 L_helped
  s_branch L_end
L_s3:
  s_lshl_b32 s29, s14, 10
  v_lshrrev_b32 v66, 4, v0
  v_and_b32 v67, 15, v0
  s_load_dwordx2 s[80:81], s[0:1], 40
  s_mov_b32 s82, 4194304
  s_mov_b32 s83, 0x20000
  s_lshl_b32 s67, s14, 2
  v_add_u32 v66, s67, v66
  v_mul_u32_u24 v66, 1024, v66
  v_lshl_add_u32 v24, v67, 4, v66
  s_lshr_b32 s67, s13, 2
  s_mul_i32 s40, s67, 1048576
  s_and_b32 s68, s13, 3
  s_lshl_b32 s68, s68, 8
  s_add_u32 s40, s40, s68
  v_lshrrev_b32 v60, 5, v0
  v_bfe_u32 v61, v0, 2, 2
  v_lshl_add_u32 v60, v60, 3, v61
  v_lshlrev_b32 v60, 8, v60
  v_bfe_u32 v61, v0, 4, 1
  v_and_b32 v62, 3, v0
  v_lshl_add_u32 v61, v61, 2, v62
  v_lshrrev_b32 v63, 2, v61
  v_and_b32 v64, 3, v61
  v_lshlrev_b32 v62, 7, v63
  v_lshl_add_u32 v62, v64, 4, v62
  s_lshr_b32 s67, s14, 1
  s_lshl_b32 s67, s67, 6
  s_and_b32 s68, s14, 1
  s_lshl_b32 s68, s68, 3
  s_add_u32 s67, s67, s68
  v_add3_u32 v60, v60, v62, s67
  v_mov_b32 v28, v60
  v_add_u32 v29, 0x10000, v60
  v_add_u32 v30, 0x20000, v60
  s_waitcnt lgkmcnt(0)
  s_add_u32 s67, s29, 0
  s_mov_b32 m0, s67
  s_add_u32 s68, s40, 0
  buffer_load_dwordx4 v24, s[80:83], s68 offen lds
  s_add_u32 s67, s29, 4096
  s_mov_b32 m0, s67
  s_add_u32 s68, s40, 16384
  buffer_load_dwordx4 v24, s[80:83], s68 offen lds
  s_add_u32 s67, s29, 8192
  s_mov_b32 m0, s67
  s_add_u32 s68, s40, 32768
  buffer_load_dwordx4 v24, s[80:83], s68 offen lds
  s_add_u32 s67, s29, 12288
  s_mov_b32 m0, s67
  s_add_u32 s68, s40, 49152
  buffer_load_dwordx4 v24, s[80:83], s68 offen lds
  s_add_u32 s67, s29, 16384
  s_mov_b32 m0, s67
  s_add_u32 s68, s40, 65536
  buffer_load_dwordx4 v24, s[80:83], s68 offen lds
  s_add_u32 s67, s29, 20480
  s_mov_b32 m0, s67
  s_add_u32 s68, s40, 81920
  buffer_load_dwordx4 v24, s[80:83], s68 offen lds
  s_add_u32 s67, s29, 24576
  s_mov_b32 m0, s67
  s_add_u32 s68, s40, 98304
  buffer_load_dwordx4 v24, s[80:83], s68 offen lds
  s_add_u32 s67, s29, 28672
  s_mov_b32 m0, s67
  s_add_u32 s68, s40, 114688
  buffer_load_dwordx4 v24, s[80:83], s68 offen lds
  s_add_u32 s67, s29, 32768
  s_mov_b32 m0, s67
  s_add_u32 s68, s40, 131072
  buffer_load_dwordx4 v24, s[80:83], s68 offen lds
  s_add_u32 s67, s29, 36864
  s_mov_b32 m0, s67
  s_add_u32 s68, s40, 147456
  buffer_load_dwordx4 v24, s[80:83], s68 offen lds
  s_add_u32 s67, s29, 40960
  s_mov_b32 m0, s67
  s_add_u32 s68, s40, 163840
  buffer_load_dwordx4 v24, s[80:83], s68 offen lds
  s_add_u32 s67, s29, 45056
  s_mov_b32 m0, s67
  s_add_u32 s68, s40, 180224
  buffer_load_dwordx4 v24, s[80:83], s68 offen lds
  s_add_u32 s67, s29, 49152
  s_mov_b32 m0, s67
  s_add_u32 s68, s40, 196608
  buffer_load_dwordx4 v24, s[80:83], s68 offen lds
  s_add_u32 s67, s29, 53248
  s_mov_b32 m0, s67
  s_add_u32 s68, s40, 212992
  buffer_load_dwordx4 v24, s[80:83], s68 offen lds
  s_add_u32 s67, s29, 57344
  s_mov_b32 m0, s67
  s_add_u32 s68, s40, 229376
  buffer_load_dwordx4 v24, s[80:83], s68 offen lds
  s_add_u32 s67, s29, 61440
  s_mov_b32 m0, s67
  s_add_u32 s68, s40, 245760
  buffer_load_dwordx4 v24, s[80:83], s68 offen lds
  s_add_u32 s67, s29, 65536
  s_mov_b32 m0, s67
  s_add_u32 s68, s40, 262144
  buffer_load_dwordx4 v24, s[80:83], s68 offen lds
  s_add_u32 s67, s29, 69632
  s_mov_b32 m0, s67
  s_add_u32 s68, s40, 278528
  buffer_load_dwordx4 v24, s[80:83], s68 offen lds
  s_add_u32 s67, s29, 73728
  s_mov_b32 m0, s67
  s_add_u32 s68, s40, 294912
  buffer_load_dwordx4 v24, s[80:83], s68 offen lds
  s_add_u32 s67, s29, 77824
  s_mov_b32 m0, s67
  s_add_u32 s68, s40, 311296
  buffer_load_dwordx4 v24, s[80:83], s68 offen lds
  s_add_u32 s67, s29, 81920
  s_mov_b32 m0, s67
  s_add_u32 s68, s40, 327680
  buffer_load_dwordx4 v24, s[80:83], s68 offen lds
  s_add_u32 s67, s29, 86016
  s_mov_b32 m0, s67
  s_add_u32 s68, s40, 344064
  buffer_load_dwordx4 v24, s[80:83], s68 offen lds
  s_add_u32 s67, s29, 90112
  s_mov_b32 m0, s67
  s_add_u32 s68, s40, 360448
  buffer_load_dwordx4 v24, s[80:83], s68 offen lds
  s_add_u32 s67, s29, 94208
  s_mov_b32 m0, s67
  s_add_u32 s68, s40, 376832
  buffer_load_dwordx4 v24, s[80:83], s68 offen lds
  s_add_u32 s67, s29, 98304
  s_mov_b32 m0, s67
  s_add_u32 s68, s40, 393216
  buffer_load_dwordx4 v24, s[80:83], s68 offen lds
  s_add_u32 s67, s29, 102400
  s_mov_b32 m0, s67
  s_add_u32 s68, s40, 409600
  buffer_load_dwordx4 v24, s[80:83], s68 offen lds
  s_add_u32 s67, s29, 106496
  s_mov_b32 m0, s67
  s_add_u32 s68, s40, 425984
  buffer_load_dwordx4 v24, s[80:83], s68 offen lds
  s_add_u32 s67, s29, 110592
  s_mov_b32 m0, s67
  s_add_u32 s68, s40, 442368
  buffer_load_dwordx4 v24, s[80:83], s68 offen lds
  s_add_u32 s67, s29, 114688
  s_mov_b32 m0, s67
  s_add_u32 s68, s40, 458752
  buffer_load_dwordx4 v24, s[80:83], s68 offen lds
  s_add_u32 s67, s29, 118784
  s_mov_b32 m0, s67
  s_add_u32 s68, s40, 475136
  buffer_load_dwordx4 v24, s[80:83], s68 offen lds
  s_add_u32 s67, s29, 122880
  s_mov_b32 m0, s67
  s_add_u32 s68, s40, 491520
  buffer_load_dwordx4 v24, s[80:83], s68 offen lds
  s_add_u32 s67, s29, 126976
  s_mov_b32 m0, s67
  s_add_u32 s68, s40, 507904
  buffer_load_dwordx4 v24, s[80:83], s68 offen lds
  s_waitcnt vmcnt(28)
  s_barrier
  s_add_u32 s67, s29, 131072
  s_mov_b32 m0, s67
  s_add_u32 s68, s40, 524288
  buffer_load_dwordx4 v24, s[80:83], s68 offen lds
  s_add_u32 s67, s29, 135168
  s_mov_b32 m0, s67
  s_add_u32 s68, s40, 540672
  buffer_load_dwordx4 v24, s[80:83], s68 offen lds
  s_add_u32 s67, s29, 139264
  s_mov_b32 m0, s67
  s_add_u32 s68, s40, 557056
  buffer_load_dwordx4 v24, s[80:83], s68 offen lds
  s_add_u32 s67, s29, 143360
  s_mov_b32 m0, s67
  s_add_u32 s68, s40, 573440
  buffer_load_dwordx4 v24, s[80:83], s68 offen lds
  ds_read_b64_tr_b16 a[0:1], v28 offset:0
  ds_read_b64_tr_b16 a[2:3], v28 offset:1024
  ds_read_b64_tr_b16 a[4:5], v28 offset:4096
  ds_read_b64_tr_b16 a[6:7], v28 offset:5120
  ds_read_b64_tr_b16 a[8:9], v28 offset:8192
  ds_read_b64_tr_b16 a[10:11], v28 offset:9216
  ds_read_b64_tr_b16 a[12:13], v28 offset:12288
  ds_read_b64_tr_b16 a[14:15], v28 offset:13312
  s_waitcnt vmcnt(28) lgkmcnt(0)
  s_barrier
  s_add_u32 s67, s29, 0
  s_mov_b32 m0, s67
  s_add_u32 s68, s40, 589824
  buffer_load_dwordx4 v24, s[80:83], s68 offen lds
  s_add_u32 s67, s29, 4096
  s_mov_b32 m0, s67
  s_add_u32 s68, s40, 606208
  buffer_load_dwordx4 v24, s[80:83], s68 offen lds
  s_add_u32 s67, s29, 8192
  s_mov_b32 m0, s67
  s_add_u32 s68, s40, 622592
  buffer_load_dwordx4 v24, s[80:83], s68 offen lds
  s_add_u32 s67, s29, 12288
  s_mov_b32 m0, s67
  s_add_u32 s68, s40, 638976
  buffer_load_dwordx4 v24, s[80:83], s68 offen lds
  ds_read_b64_tr_b16 a[16:17], v28 offset:16384
  ds_read_b64_tr_b16 a[18:19], v28 offset:17408
  ds_read_b64_tr_b16 a[20:21], v28 offset:20480
  ds_read_b64_tr_b16 a[22:23], v28 offset:21504
  ds_read_b64_tr_b16 a[24:25], v28 offset:24576
  ds_read_b64_tr_b16 a[26:27], v28 offset:25600
  ds_read_b64_tr_b16 a[28:29], v28 offset:28672
  ds_read_b64_tr_b16 a[30:31], v28 offset:29696
  s_waitcnt vmcnt(28) lgkmcnt(0)
  s_barrier
  s_add_u32 s67, s29, 16384
  s_mov_b32 m0, s67
  s_add_u32 s68, s40, 655360
  buffer_load_dwordx4 v24, s[80:83], s68 offen lds
  s_add_u32 s67, s29, 20480
  s_mov_b32 m0, s67
  s_add_u32 s68, s40, 671744
  buffer_load_dwordx4 v24, s[80:83], s68 offen lds
  s_add_u32 s67, s29, 24576
  s_mov_b32 m0, s67
  s_add_u32 s68, s40, 688128
  buffer_load_dwordx4 v24, s[80:83], s68 offen lds
  s_add_u32 s67, s29, 28672
  s_mov_b32 m0, s67
  s_add_u32 s68, s40, 704512
  buffer_load_dwordx4 v24, s[80:83], s68 offen lds
  ds_read_b64_tr_b16 a[32:33], v28 offset:32768
  ds_read_b64_tr_b16 a[34:35], v28 offset:33792
  ds_read_b64_tr_b16 a[36:37], v28 offset:36864
  ds_read_b64_tr_b16 a[38:39], v28 offset:37888
  ds_read_b64_tr_b16 a[40:41], v28 offset:40960
  ds_read_b64_tr_b16 a[42:43], v28 offset:41984
  ds_read_b64_tr_b16 a[44:45], v28 offset:45056
  ds_read_b64_tr_b16 a[46:47], v28 offset:46080
  s_waitcnt vmcnt(28) lgkmcnt(0)
  s_barrier
  s_add_u32 s67, s29, 32768
  s_mov_b32 m0, s67
  s_add_u32 s68, s40, 720896
  buffer_load_dwordx4 v24, s[80:83], s68 offen lds
  s_add_u32 s67, s29, 36864
  s_mov_b32 m0, s67
  s_add_u32 s68, s40, 737280
  buffer_load_dwordx4 v24, s[80:83], s68 offen lds
  s_add_u32 s67, s29, 40960
  s_mov_b32 m0, s67
  s_add_u32 s68, s40, 753664
  buffer_load_dwordx4 v24, s[80:83], s68 offen lds
  s_add_u32 s67, s29, 45056
  s_mov_b32 m0, s67
  s_add_u32 s68, s40, 770048
  buffer_load_dwordx4 v24, s[80:83], s68 offen lds
  ds_read_b64_tr_b16 a[48:49], v28 offset:49152
  ds_read_b64_tr_b16 a[50:51], v28 offset:50176
  ds_read_b64_tr_b16 a[52:53], v28 offset:53248
  ds_read_b64_tr_b16 a[54:55], v28 offset:54272
  ds_read_b64_tr_b16 a[56:57], v28 offset:57344
  ds_read_b64_tr_b16 a[58:59], v28 offset:58368
  ds_read_b64_tr_b16 a[60:61], v28 offset:61440
  ds_read_b64_tr_b16 a[62:63], v28 offset:62464
  s_waitcnt vmcnt(28) lgkmcnt(0)
  s_barrier
  s_add_u32 s67, s29, 49152
  s_mov_b32 m0, s67
  s_add_u32 s68, s40, 786432
  buffer_load_dwordx4 v24, s[80:83], s68 offen lds
  s_add_u32 s67, s29, 53248
  s_mov_b32 m0, s67
  s_add_u32 s68, s40, 802816
  buffer_load_dwordx4 v24, s[80:83], s68 offen lds
  s_add_u32 s67, s29, 57344
  s_mov_b32 m0, s67
  s_add_u32 s68, s40, 819200
  buffer_load_dwordx4 v24, s[80:83], s68 offen lds
  s_add_u32 s67, s29, 61440
  s_mov_b32 m0, s67
  s_add_u32 s68, s40, 835584
  buffer_load_dwordx4 v24, s[80:83], s68 offen lds
  ds_read_b64_tr_b16 a[64:65], v29 offset:0
  ds_read_b64_tr_b16 a[66:67], v29 offset:1024
  ds_read_b64_tr_b16 a[68:69], v29 offset:4096
  ds_read_b64_tr_b16 a[70:71], v29 offset:5120
  ds_read_b64_tr_b16 a[72:73], v29 offset:8192
  ds_read_b64_tr_b16 a[74:75], v29 offset:9216
  ds_read_b64_tr_b16 a[76:77], v29 offset:12288
  ds_read_b64_tr_b16 a[78:79], v29 offset:13312
  s_waitcnt vmcnt(28) lgkmcnt(0)
  s_barrier
  s_add_u32 s67, s29, 65536
  s_mov_b32 m0, s67
  s_add_u32 s68, s40, 851968
  buffer_load_dwordx4 v24, s[80:83], s68 offen lds
  s_add_u32 s67, s29, 69632
  s_mov_b32 m0, s67
  s_add_u32 s68, s40, 868352
  buffer_load_dwordx4 v24, s[80:83], s68 offen lds
  s_add_u32 s67, s29, 73728
  s_mov_b32 m0, s67
  s_add_u32 s68, s40, 884736
  buffer_load_dwordx4 v24, s[80:83], s68 offen lds
  s_add_u32 s67, s29, 77824
  s_mov_b32 m0, s67
  s_add_u32 s68, s40, 901120
  buffer_load_dwordx4 v24, s[80:83], s68 offen lds
  ds_read_b64_tr_b16 a[80:81], v29 offset:16384
  ds_read_b64_tr_b16 a[82:83], v29 offset:17408
  ds_read_b64_tr_b16 a[84:85], v29 offset:20480
  ds_read_b64_tr_b16 a[86:87], v29 offset:21504
  ds_read_b64_tr_b16 a[88:89], v29 offset:24576
  ds_read_b64_tr_b16 a[90:91], v29 offset:25600
  ds_read_b64_tr_b16 a[92:93], v29 offset:28672
  ds_read_b64_tr_b16 a[94:95], v29 offset:29696
  s_waitcnt vmcnt(28) lgkmcnt(0)
  s_barrier
  s_add_u32 s67, s29, 81920
  s_mov_b32 m0, s67
  s_add_u32 s68, s40, 917504
  buffer_load_dwordx4 v24, s[80:83], s68 offen lds
  s_add_u32 s67, s29, 86016
  s_mov_b32 m0, s67
  s_add_u32 s68, s40, 933888
  buffer_load_dwordx4 v24, s[80:83], s68 offen lds
  s_add_u32 s67, s29, 90112
  s_mov_b32 m0, s67
  s_add_u32 s68, s40, 950272
  buffer_load_dwordx4 v24, s[80:83], s68 offen lds
  s_add_u32 s67, s29, 94208
  s_mov_b32 m0, s67
  s_add_u32 s68, s40, 966656
  buffer_load_dwordx4 v24, s[80:83], s68 offen lds
  ds_read_b64_tr_b16 a[96:97], v29 offset:32768
  ds_read_b64_tr_b16 a[98:99], v29 offset:33792
  ds_read_b64_tr_b16 a[100:101], v29 offset:36864
  ds_read_b64_tr_b16 a[102:103], v29 offset:37888
  ds_read_b64_tr_b16 a[104:105], v29 offset:40960
  ds_read_b64_tr_b16 a[106:107], v29 offset:41984
  ds_read_b64_tr_b16 a[108:109], v29 offset:45056
  ds_read_b64_tr_b16 a[110:111], v29 offset:46080
  s_waitcnt vmcnt(28) lgkmcnt(0)
  s_barrier
  s_add_u32 s67, s29, 98304
  s_mov_b32 m0, s67
  s_add_u32 s68, s40, 983040
  buffer_load_dwordx4 v24, s[80:83], s68 offen lds
  s_add_u32 s67, s29, 102400
  s_mov_b32 m0, s67
  s_add_u32 s68, s40, 999424
  buffer_load_dwordx4 v24, s[80:83], s68 offen lds
  s_add_u32 s67, s29, 106496
  s_mov_b32 m0, s67
  s_add_u32 s68, s40, 1015808
  buffer_load_dwordx4 v24, s[80:83], s68 offen lds
  s_add_u32 s67, s29, 110592
  s_mov_b32 m0, s67
  s_add_u32 s68, s40, 1032192
  buffer_load_dwordx4 v24, s[80:83], s68 offen lds
  ds_read_b64_tr_b16 a[112:113], v29 offset:49152
  ds_read_b64_tr_b16 a[114:115], v29 offset:50176
  ds_read_b64_tr_b16 a[116:117], v29 offset:53248
  ds_read_b64_tr_b16 a[118:119], v29 offset:54272
  ds_read_b64_tr_b16 a[120:121], v29 offset:57344
  ds_read_b64_tr_b16 a[122:123], v29 offset:58368
  ds_read_b64_tr_b16 a[124:125], v29 offset:61440
  ds_read_b64_tr_b16 a[126:127], v29 offset:62464
  s_waitcnt vmcnt(28) lgkmcnt(0)
  s_barrier
  ds_read_b64_tr_b16 a[128:129], v30 offset:0
  ds_read_b64_tr_b16 a[130:131], v30 offset:1024
  ds_read_b64_tr_b16 a[132:133], v30 offset:4096
  ds_read_b64_tr_b16 a[134:135], v30 offset:5120
  ds_read_b64_tr_b16 a[136:137], v30 offset:8192
  ds_read_b64_tr_b16 a[138:139], v30 offset:9216
  ds_read_b64_tr_b16 a[140:141], v30 offset:12288
  ds_read_b64_tr_b16 a[142:143], v30 offset:13312
  s_waitcnt vmcnt(24) lgkmcnt(0)
  s_barrier
  ds_read_b64_tr_b16 a[144:145], v28 offset:0
  ds_read_b64_tr_b16 a[146:147], v28 offset:1024
  ds_read_b64_tr_b16 a[148:149], v28 offset:4096
  ds_read_b64_tr_b16 a[150:151], v28 offset:5120
  ds_read_b64_tr_b16 a[152:153], v28 offset:8192
  ds_read_b64_tr_b16 a[154:155], v28 offset:9216
  ds_read_b64_tr_b16 a[156:157], v28 offset:12288
  ds_read_b64_tr_b16 a[158:159], v28 offset:13312
  s_waitcnt vmcnt(20) lgkmcnt(0)
  s_barrier
  ds_read_b64_tr_b16 a[160:161], v28 offset:16384
  ds_read_b64_tr_b16 a[162:163], v28 offset:17408
  ds_read_b64_tr_b16 a[164:165], v28 offset:20480
  ds_read_b64_tr_b16 a[166:167], v28 offset:21504
  ds_read_b64_tr_b16 a[168:169], v28 offset:24576
  ds_read_b64_tr_b16 a[170:171], v28 offset:25600
  ds_read_b64_tr_b16 a[172:173], v28 offset:28672
  ds_read_b64_tr_b16 a[174:175], v28 offset:29696
  s_waitcnt vmcnt(16) lgkmcnt(0)
  s_barrier
  ds_read_b64_tr_b16 a[176:177], v28 offset:32768
  ds_read_b64_tr_b16 a[178:179], v28 offset:33792
  ds_read_b64_tr_b16 a[180:181], v28 offset:36864
  ds_read_b64_tr_b16 a[182:183], v28 offset:37888
  ds_read_b64_tr_b16 a[184:185], v28 offset:40960
  ds_read_b64_tr_b16 a[186:187], v28 offset:41984
  ds_read_b64_tr_b16 a[188:189], v28 offset:45056
  ds_read_b64_tr_b16 a[190:191], v28 offset:46080
  s_waitcnt vmcnt(12) lgkmcnt(0)
  s_barrier
  ds_read_b64_tr_b16 a[192:193], v28 offset:49152
  ds_read_b64_tr_b16 a[194:195], v28 offset:50176
  ds_read_b64_tr_b16 a[196:197], v28 offset:53248
  ds_read_b64_tr_b16 a[198:199], v28 offset:54272
  ds_read_b64_tr_b16 a[200:201], v28 offset:57344
  ds_read_b64_tr_b16 a[202:203], v28 offset:58368
  ds_read_b64_tr_b16 a[204:205], v28 offset:61440
  ds_read_b64_tr_b16 a[206:207], v28 offset:62464
  s_waitcnt vmcnt(8) lgkmcnt(0)
  s_barrier
  ds_read_b64_tr_b16 a[208:209], v29 offset:0
  ds_read_b64_tr_b16 a[210:211], v29 offset:1024
  ds_read_b64_tr_b16 a[212:213], v29 offset:4096
  ds_read_b64_tr_b16 a[214:215], v29 offset:5120
  ds_read_b64_tr_b16 a[216:217], v29 offset:8192
  ds_read_b64_tr_b16 a[218:219], v29 offset:9216
  ds_read_b64_tr_b16 a[220:221], v29 offset:12288
  ds_read_b64_tr_b16 a[222:223], v29 offset:13312
  s_waitcnt vmcnt(4) lgkmcnt(0)
  s_barrier
  ds_read_b64_tr_b16 a[224:225], v29 offset:16384
  ds_read_b64_tr_b16 a[226:227], v29 offset:17408
  ds_read_b64_tr_b16 a[228:229], v29 offset:20480
  ds_read_b64_tr_b16 a[230:231], v29 offset:21504
  ds_read_b64_tr_b16 a[232:233], v29 offset:24576
  ds_read_b64_tr_b16 a[234:235], v29 offset:25600
  ds_read_b64_tr_b16 a[236:237], v29 offset:28672
  ds_read_b64_tr_b16 a[238:239], v29 offset:29696
  s_waitcnt vmcnt(0) lgkmcnt(0)
  s_barrier
  ds_read_b64_tr_b16 a[240:241], v29 offset:32768
  ds_read_b64_tr_b16 a[242:243], v29 offset:33792
  ds_read_b64_tr_b16 a[244:245], v29 offset:36864
  ds_read_b64_tr_b16 a[246:247], v29 offset:37888
  ds_read_b64_tr_b16 a[248:249], v29 offset:40960
  ds_read_b64_tr_b16 a[250:251], v29 offset:41984
  ds_read_b64_tr_b16 a[252:253], v29 offset:45056
  ds_read_b64_tr_b16 a[254:255], v29 offset:46080
  s_waitcnt lgkmcnt(0)
  s_barrier
  v_and_b32 v60, 31, v0
  v_lshrrev_b32 v61, 5, v0
  v_lshlrev_b32 v8, 4, v0
  v_add_u32 v16, 0, v8
  v_add_u32 v17, 16384, v8
  v_add_u32 v18, 32768, v8
  v_add_u32 v19, 49152, v8
  s_lshl_b32 s29, s14, 12
  s_mov_b32 s22, 1
  s_mov_b32 s17, 0x1000
  s_mov_b32 s18, 0x1000
  s_mov_b32 s19, 64
  s_lshl_b32 s15, s12, 6
  s_mov_b32 s20, 0
  s_mov_b32 s21, 0
  s_lshl_b32 s69, s14, 2
  s_lshl_b32 s48, s12, 21
  s_lshl_b32 s49, s12, 16
  s_lshr_b32 s70, s13, 2
  s_and_b32 s71, s13, 3
  s_mul_i32 s67, s70, 65536
  s_add_u32 s67, s67, s29
  s_lshl_b32 s68, s12, 24
  s_sub_u32 s67, s67, s68
  s_add_u32 s35, s67, 33554432
  s_lshl_b32 s67, s70, 8
  s_add_u32 s67, s67, 851968
  v_and_b32 v62, 7, v0
  v_lshl_add_u32 v62, v62, 5, s67
  s_add_u32 s67, s49, 253952
  v_lshl_add_u32 v63, v60, 5, s67
  s_lshl_b32 s67, s70, 15
  s_lshl_b32 s68, s71, 7
  s_add_u32 s67, s67, s68
  s_lshr_b32 s68, s14, 1
  s_lshl_b32 s68, s68, 6
  s_add_u32 s67, s67, s68
  s_and_b32 s68, s14, 1
  s_lshl_b32 s68, s68, 10
  s_add_u32 s67, s67, s68
  s_add_u32 s67, s67, s48
  s_add_u32 s36, s67, 167772160
  v_lshlrev_b32 v64, 12, v61
  v_bfe_u32 v65, v60, 1, 1
  v_lshl_add_u32 v64, v65, 9, v64
  v_bfe_u32 v65, v60, 2, 2
  v_lshl_add_u32 v64, v65, 4, v64
  v_lshrrev_b32 v65, 4, v60
  v_lshl_add_u32 v64, v65, 3, v64
  v_and_b32 v65, 1, v60
  v_lshl_add_u32 v3, v65, 2, v64
  v_cmp_eq_u32 vcc, 0, v61
  s_nop 1
  v_cndmask_b32 v1, v63, v62, vcc
  s_mov_b32 s38, 0
  s_lshl_b32 s67, s13, 6
  s_add_u32 s67, s67, s69
  s_add_u32 s37, s67, 458752
  s_and_b32 s71, s15, 7
  s_mul_i32 s70, s15, 262144
  s_add_u32 s30, s70, s35
  s_mul_i32 s70, s15, 1024
  s_add_u32 s31, s70, s38
  s_mul_i32 s70, s71, 131072
  s_add_u32 s32, s70, s36
  s_mul_i32 s70, s15, 1024
  s_add_u32 s33, s70, s37
  s_mov_b32 s25, s30
  s_mov_b32 s26, s31
  s_mov_b32 s27, s32
  s_mov_b32 s28, s33
  s_mov_b32 s16, 0
  s_mov_b32 s43, 536870912
  s_mov_b32 s23, 0
  s_mov_b32 s24, 536870912
  v_mov_b32 v7, 1
  v_mov_b32 v2, 0
  v_mbcnt_lo_u32_b32 v102, -1, 0
  v_and_b32 v100, 1, v102
  v_lshlrev_b32 v100, 7, v100
  v_bfe_u32 v102, v102, 1, 2
  v_lshl_add_u32 v100, v102, 2, v100
  v_add_u32 v100, s2, v100
L_go_8:
  s_sub_u32 s66, s66, 1
  s_cbranch_scc1 L_abort
  global_load_dword v101, v100, s[62:63] sc1
  s_waitcnt vmcnt(0)
  v_and_b32 v102, 0xff, v101
  v_cmp_eq_u32 vcc, 32, v102
  v_bfe_u32 v102, v101, 8, 8
  v_lshrrev_b32 v103, 16, v101
  s_and_b32 s67, vcc_lo, 0xff
  s_cmp_eq_u32 s67, 0xff
  s_cbranch_scc1 L_go_8_ok
  v_and_b32 v102, 0xff, v101
  v_cmp_lt_u32 vcc, 32, v102
  s_cbranch_vccnz L_abort
  s_sleep 8
  s_branch L_go_8
L_go_8_ok:
  v_mul_u32_u24 v102, v102, v102
  v_lshlrev_b32 v103, 5, v103
  v_cmp_eq_u32 vcc, v102, v103
  s_nop 3
  s_and_b32 s67, vcc_lo, 0xff
  s_cmp_lg_u32 s67, 0xff
  s_cbranch_scc1 L_regroup
L_s3_top:
  s_mov_b32 s42, s23
  s_cmp_lg_u32 s23, 0
  s_cbranch_scc1 L_s3_iss
  s_waitcnt vmcnt(8)
  v_cmp_ne_u32 vcc, 0, v2
  s_cmp_lt_u32 s16, 8
  s_cselect_b32 s68, -1, 0
  s_or_b32 vcc_hi, vcc_hi, s68
  s_cmp_eq_u64 vcc, exec
  s_cbranch_scc1 L_s3_dma
  s_waitcnt vmcnt(0)
  s_mov_b64 exec, 1
  buffer_store_dword v7, off, s[4:7], s24 sc1
  s_mov_b64 exec, -1
  s_mov_b32 s24, 536870912
L_s3_poll:
  s_sub_u32 s66, s66, 1
  s_cbranch_scc1 L_abort
  buffer_load_dword v2, v1, s[4:7], s26 offen sc1
  s_waitcnt vmcnt(0)
  v_cmp_ne_u32 vcc, 0, v2
  s_cmp_lt_u32 s16, 8
  s_cselect_b32 s68, -1, 0
  s_or_b32 vcc_hi, vcc_hi, s68
  s_cmp_eq_u64 vcc, exec
  s_cbranch_scc0 L_s3_poll
L_s3_dma:
  s_add_u32 m0, s29, 0
  s_nop 0
  buffer_load_dwordx4 v16, s[4:7], s25 offen offset:0 sc1 lds
  buffer_load_dwordx4 v16, s[4:7], s25 offen offset:1024 sc1 lds
  buffer_load_dwordx4 v16, s[4:7], s25 offen offset:2048 sc1 lds
  buffer_load_dwordx4 v16, s[4:7], s25 offen offset:3072 sc1 lds
  s_add_u32 m0, s29, 16384
  s_nop 0
  buffer_load_dwordx4 v17, s[4:7], s25 offen offset:0 sc1 lds
  buffer_load_dwordx4 v17, s[4:7], s25 offen offset:1024 sc1 lds
  buffer_load_dwordx4 v17, s[4:7], s25 offen offset:2048 sc1 lds
  buffer_load_dwordx4 v17, s[4:7], s25 offen offset:3072 sc1 lds
  s_add_u32 m0, s29, 32768
  s_nop 0
  buffer_load_dwordx4 v18, s[4:7], s25 offen offset:0 sc1 lds
  buffer_load_dwordx4 v18, s[4:7], s25 offen offset:1024 sc1 lds
  buffer_load_dwordx4 v18, s[4:7], s25 offen offset:2048 sc1 lds
  buffer_load_dwordx4 v18, s[4:7], s25 offen offset:3072 sc1 lds
  s_add_u32 m0, s29, 49152
  s_nop 0
  buffer_load_dwordx4 v19, s[4:7], s25 offen offset:0 sc1 lds
  buffer_load_dwordx4 v19, s[4:7], s25 offen offset:1024 sc1 lds
  buffer_load_dwordx4 v19, s[4:7], s25 offen offset:2048 sc1 lds
  buffer_load_dwordx4 v19, s[4:7], s25 offen offset:3072 sc1 lds
  s_waitcnt vmcnt(16)
  s_mov_b64 exec, 1
  buffer_store_dword v7, off, s[4:7], s24 sc1
  s_mov_b64 exec, -1
  s_mov_b32 s24, 536870912
  s_waitcnt vmcnt(13)
L_s3_iss:
  s_waitcnt vmcnt(21)
  .p2align 3
L_s3_go:
  s_barrier
  s_nop 0
  ds_read_b128 v[24:27], v8 offset:0
  ds_read_b128 v[28:31], v8 offset:1024
  ds_read_b128 v[32:35], v8 offset:2048
  ds_read_b128 v[36:39], v8 offset:3072
  ds_read_b128 v[40:43], v8 offset:4096
  s_xor_b32 s29, s29, 65536
  s_waitcnt lgkmcnt(4)
  v_mfma_f32_32x32x16_bf16 v[48:63], v[24:27], a[0:3], 0
  ds_read_b128 v[44:47], v8 offset:5120
  s_add_u32 s16, s16, 1
  s_add_u32 s15, s15, 1
  s_and_b32 s71, s15, 7
  s_waitcnt lgkmcnt(4)
  v_mfma_f32_32x32x16_bf16 v[48:63], v[28:31], a[4:7], v[48:63]
  ds_read_b128 v[24:27], v8 offset:6144
  s_mul_i32 s70, s15, 262144
  s_add_u32 s30, s70, s35
  s_mul_i32 s70, s15, 1024
  s_waitcnt lgkmcnt(4)
  v_mfma_f32_32x32x16_bf16 v[48:63], v[32:35], a[8:11], v[48:63]
  ds_read_b128 v[28:31], v8 offset:7168
  s_add_u32 s31, s70, s38
  s_mul_i32 s70, s71, 131072
  s_add_u32 s32, s70, s36
  s_waitcnt lgkmcnt(4)
  v_mfma_f32_32x32x16_bf16 v[48:63], v[36:39], a[12:15], v[48:63]
  ds_read_b128 v[32:35], v8 offset:8192
  s_mul_i32 s70, s15, 1024
  s_add_u32 s33, s70, s37
  s_waitcnt lgkmcnt(4)
  v_mfma_f32_32x32x16_bf16 v[48:63], v[40:43], a[16:19], v[48:63]
  ds_read_b128 v[36:39], v8 offset:9216
  s_waitcnt lgkmcnt(4)
  v_mfma_f32_32x32x16_bf16 v[48:63], v[44:47], a[20:23], v[48:63]
  ds_read_b128 v[40:43], v8 offset:10240
  s_waitcnt lgkmcnt(4)
  v_mfma_f32_32x32x16_bf16 v[48:63], v[24:27], a[24:27], v[48:63]
  ds_read_b128 v[44:47], v8 offset:11264
  s_waitcnt lgkmcnt(4)
  v_mfma_f32_32x32x16_bf16 v[48:63], v[28:31], a[28:31], v[48:63]
  ds_read_b128 v[24:27], v8 offset:12288
  s_waitcnt lgkmcnt(4)
  v_mfma_f32_32x32x16_bf16 v[48:63], v[32:35], a[32:35], v[48:63]
  ds_read_b128 v[28:31], v8 offset:13312
  s_waitcnt lgkmcnt(4)
  v_mfma_f32_32x32x16_bf16 v[48:63], v[36:39], a[36:39], v[48:63]
  ds_read_b128 v[32:35], v8 offset:14336
  s_waitcnt lgkmcnt(4)
  v_mfma_f32_32x32x16_bf16 v[48:63], v[40:43], a[40:43], v[48:63]
  ds_read_b128 v[36:39], v8 offset:15360
  s_waitcnt lgkmcnt(4)
  v_mfma_f32_32x32x16_bf16 v[48:63], v[44:47], a[44:47], v[48:63]
  s_cmp_lg_u32 s42, 0
  s_cbranch_scc1 L_s3_c1
  s_waitcnt vmcnt(9)
L_s3_c1:
  s_waitcnt vmcnt(17)
  s_barrier
  ds_read_b128 v[40:43], v8 offset:16384
  s_waitcnt lgkmcnt(4)
  v_mfma_f32_32x32x16_bf16 v[48:63], v[24:27], a[48:51], v[48:63]
  ds_read_b128 v[44:47], v8 offset:17408
  s_waitcnt lgkmcnt(4)
  v_mfma_f32_32x32x16_bf16 v[48:63], v[28:31], a[52:55], v[48:63]
  ds_read_b128 v[24:27], v8 offset:18432
  buffer_load_dword v2, v1, s[4:7], s31 offen sc1
  s_waitcnt lgkmcnt(4)
  v_mfma_f32_32x32x16_bf16 v[48:63], v[32:35], a[56:59], v[48:63]
  ds_read_b128 v[28:31], v8 offset:19456
  s_waitcnt lgkmcnt(4)
  v_mfma_f32_32x32x16_bf16 v[48:63], v[36:39], a[60:63], v[48:63]
  ds_read_b128 v[32:35], v8 offset:20480
  s_waitcnt lgkmcnt(4)
  v_mfma_f32_32x32x16_bf16 v[48:63], v[40:43], a[64:67], v[48:63]
  ds_read_b128 v[36:39], v8 offset:21504
  s_waitcnt lgkmcnt(4)
  v_mfma_f32_32x32x16_bf16 v[48:63], v[44:47], a[68:71], v[48:63]
  ds_read_b128 v[40:43], v8 offset:22528
  s_waitcnt lgkmcnt(4)
  v_mfma_f32_32x32x16_bf16 v[48:63], v[24:27], a[72:75], v[48:63]
  ds_read_b128 v[44:47], v8 offset:23552
  s_waitcnt lgkmcnt(4)
  v_mfma_f32_32x32x16_bf16 v[48:63], v[28:31], a[76:79], v[48:63]
  ds_read_b128 v[24:27], v8 offset:24576
  s_waitcnt lgkmcnt(4)
  v_mfma_f32_32x32x16_bf16 v[48:63], v[32:35], a[80:83], v[48:63]
  ds_read_b128 v[28:31], v8 offset:25600
  s_waitcnt lgkmcnt(4)
  v_mfma_f32_32x32x16_bf16 v[48:63], v[36:39], a[84:87], v[48:63]
  ds_read_b128 v[32:35], v8 offset:26624
  s_waitcnt lgkmcnt(4)
  v_mfma_f32_32x32x16_bf16 v[48:63], v[40:43], a[88:91], v[48:63]
  ds_read_b128 v[36:39], v8 offset:27648
  s_waitcnt lgkmcnt(4)
  v_mfma_f32_32x32x16_bf16 v[48:63], v[44:47], a[92:95], v[48:63]
  ds_read_b128 v[40:43], v8 offset:28672
  s_waitcnt lgkmcnt(4)
  v_mfma_f32_32x32x16_bf16 v[48:63], v[24:27], a[96:99], v[48:63]
  ds_read_b128 v[44:47], v8 offset:29696
  s_waitcnt lgkmcnt(4)
  v_mfma_f32_32x32x16_bf16 v[48:63], v[28:31], a[100:103], v[48:63]
  ds_read_b128 v[24:27], v8 offset:30720
  s_waitcnt lgkmcnt(4)
  v_mfma_f32_32x32x16_bf16 v[48:63], v[32:35], a[104:107], v[48:63]
  ds_read_b128 v[28:31], v8 offset:31744
  s_waitcnt lgkmcnt(4)
  v_mfma_f32_32x32x16_bf16 v[48:63], v[36:39], a[108:111], v[48:63]
  s_cmp_lg_u32 s42, 0
  s_cbranch_scc1 L_s3_c2
  s_waitcnt vmcnt(6)
L_s3_c2:
  s_waitcnt vmcnt(14)
  s_barrier
  ds_read_b128 v[32:35], v8 offset:32768
  s_waitcnt lgkmcnt(4)
  v_mfma_f32_32x32x16_bf16 v[48:63], v[40:43], a[112:115], v[48:63]
  ds_read_b128 v[36:39], v8 offset:33792
  s_waitcnt vmcnt(0)
  v_cmp_ne_u32_e64 vcc, 0, v2
  s_mov_b64 exec, 1
  buffer_store_dword v7, off, s[4:7], s24 sc1
  s_mov_b64 exec, -1
  s_mov_b32 s24, 536870912
  s_waitcnt lgkmcnt(4)
  v_mfma_f32_32x32x16_bf16 v[48:63], v[44:47], a[116:119], v[48:63]
  ds_read_b128 v[40:43], v8 offset:34816
  s_cmp_lt_u32 s16, 8
  s_cselect_b32 s68, -1, 0
  s_or_b32 vcc_hi, vcc_hi, s68
  s_cmp_eq_u64 vcc, exec
  s_cselect_b32 s23, 1, 0
  s_cselect_b32 s34, s30, 536870912
  s_cmp_lt_u32 s16, s19
  s_cselect_b32 s34, s34, 536870912
  s_waitcnt lgkmcnt(4)
  v_mfma_f32_32x32x16_bf16 v[48:63], v[24:27], a[120:123], v[48:63]
  ds_read_b128 v[44:47], v8 offset:35840
  s_add_u32 m0, s29, 0
  s_nop 0
  buffer_load_dwordx4 v16, s[4:7], s34 offen offset:0 sc1 lds
  s_waitcnt lgkmcnt(4)
  v_mfma_f32_32x32x16_bf16 v[48:63], v[28:31], a[124:127], v[48:63]
  ds_read_b128 v[24:27], v8 offset:36864
  s_waitcnt lgkmcnt(4)
  v_mfma_f32_32x32x16_bf16 v[48:63], v[32:35], a[128:131], v[48:63]
  ds_read_b128 v[28:31], v8 offset:37888
  buffer_load_dwordx4 v16, s[4:7], s34 offen offset:1024 sc1 lds
  s_waitcnt lgkmcnt(4)
  v_mfma_f32_32x32x16_bf16 v[48:63], v[36:39], a[132:135], v[48:63]
  ds_read_b128 v[32:35], v8 offset:38912
  s_waitcnt lgkmcnt(4)
  v_mfma_f32_32x32x16_bf16 v[48:63], v[40:43], a[136:139], v[48:63]
  ds_read_b128 v[36:39], v8 offset:39936
  buffer_load_dwordx4 v16, s[4:7], s34 offen offset:2048 sc1 lds
  s_waitcnt lgkmcnt(4)
  v_mfma_f32_32x32x16_bf16 v[48:63], v[44:47], a[140:143], v[48:63]
  ds_read_b128 v[40:43], v8 offset:40960
  s_waitcnt lgkmcnt(4)
  v_mfma_f32_32x32x16_bf16 v[48:63], v[24:27], a[144:147], v[48:63]
  ds_read_b128 v[44:47], v8 offset:41984
  buffer_load_dwordx4 v16, s[4:7], s34 offen offset:3072 sc1 lds
  s_waitcnt lgkmcnt(4)
  v_mfma_f32_32x32x16_bf16 v[48:63], v[28:31], a[148:151], v[48:63]
  ds_read_b128 v[24:27], v8 offset:43008
  s_waitcnt lgkmcnt(4)
  v_mfma_f32_32x32x16_bf16 v[48:63], v[32:35], a[152:155], v[48:63]
  ds_read_b128 v[28:31], v8 offset:44032
  s_add_u32 m0, s29, 16384
  s_nop 0
  buffer_load_dwordx4 v17, s[4:7], s34 offen offset:0 sc1 lds
  s_waitcnt lgkmcnt(4)
  v_mfma_f32_32x32x16_bf16 v[48:63], v[36:39], a[156:159], v[48:63]
  ds_read_b128 v[32:35], v8 offset:45056
  s_waitcnt lgkmcnt(4)
  v_mfma_f32_32x32x16_bf16 v[48:63], v[40:43], a[160:163], v[48:63]
  ds_read_b128 v[36:39], v8 offset:46080
  buffer_load_dwordx4 v17, s[4:7], s34 offen offset:1024 sc1 lds
  s_waitcnt lgkmcnt(4)
  v_mfma_f32_32x32x16_bf16 v[48:63], v[44:47], a[164:167], v[48:63]
  ds_read_b128 v[40:43], v8 offset:47104
  s_waitcnt lgkmcnt(4)
  v_mfma_f32_32x32x16_bf16 v[48:63], v[24:27], a[168:171], v[48:63]
  ds_read_b128 v[44:47], v8 offset:48128
  buffer_load_dwordx4 v17, s[4:7], s34 offen offset:2048 sc1 lds
  s_waitcnt lgkmcnt(4)
  v_mfma_f32_32x32x16_bf16 v[48:63], v[28:31], a[172:175], v[48:63]
  s_cmp_lg_u32 s42, 0
  s_cbranch_scc1 L_s3_c3
  s_waitcnt vmcnt(10)
L_s3_c3:
  s_waitcnt vmcnt(17)
  s_barrier
  ds_read_b128 v[24:27], v8 offset:49152
  s_waitcnt lgkmcnt(4)
  v_mfma_f32_32x32x16_bf16 v[48:63], v[32:35], a[176:179], v[48:63]
  ds_read_b128 v[28:31], v8 offset:50176
  buffer_load_dwordx4 v17, s[4:7], s34 offen offset:3072 sc1 lds
  s_waitcnt lgkmcnt(4)
  v_mfma_f32_32x32x16_bf16 v[48:63], v[36:39], a[180:183], v[48:63]
  ds_read_b128 v[32:35], v8 offset:51200
  s_waitcnt lgkmcnt(4)
  v_mfma_f32_32x32x16_bf16 v[48:63], v[40:43], a[184:187], v[48:63]
  ds_read_b128 v[36:39], v8 offset:52224
  s_add_u32 m0, s29, 32768
  s_nop 0
  buffer_load_dwordx4 v18, s[4:7], s34 offen offset:0 sc1 lds
  s_waitcnt lgkmcnt(4)
  v_mfma_f32_32x32x16_bf16 v[48:63], v[44:47], a[188:191], v[48:63]
  ds_read_b128 v[40:43], v8 offset:53248
  s_waitcnt lgkmcnt(4)
  v_mfma_f32_32x32x16_bf16 v[48:63], v[24:27], a[192:195], v[48:63]
  ds_read_b128 v[44:47], v8 offset:54272
  buffer_load_dwordx4 v18, s[4:7], s34 offen offset:1024 sc1 lds
  s_waitcnt lgkmcnt(4)
  v_mfma_f32_32x32x16_bf16 v[48:63], v[28:31], a[196:199], v[48:63]
  ds_read_b128 v[24:27], v8 offset:55296
  s_waitcnt lgkmcnt(4)
  v_mfma_f32_32x32x16_bf16 v[48:63], v[32:35], a[200:203], v[48:63]
  ds_read_b128 v[28:31], v8 offset:56320
  buffer_load_dwordx4 v18, s[4:7], s34 offen offset:2048 sc1 lds
  s_waitcnt lgkmcnt(4)
  v_mfma_f32_32x32x16_bf16 v[48:63], v[36:39], a[204:207], v[48:63]
  ds_read_b128 v[32:35], v8 offset:57344
  s_waitcnt lgkmcnt(4)
  v_mfma_f32_32x32x16_bf16 v[48:63], v[40:43], a[208:211], v[48:63]
  ds_read_b128 v[36:39], v8 offset:58368
  buffer_load_dwordx4 v18, s[4:7], s34 offen offset:3072 sc1 lds
  buffer_load_dword v2, v1, s[4:7], s31 offen sc1
  s_waitcnt lgkmcnt(4)
  v_mfma_f32_32x32x16_bf16 v[48:63], v[44:47], a[212:215], v[48:63]
  ds_read_b128 v[40:43], v8 offset:59392
  s_waitcnt lgkmcnt(4)
  v_mfma_f32_32x32x16_bf16 v[48:63], v[24:27], a[216:219], v[48:63]
  ds_read_b128 v[44:47], v8 offset:60416
  s_add_u32 m0, s29, 49152
  s_nop 0
  buffer_load_dwordx4 v19, s[4:7], s34 offen offset:0 sc1 lds
  s_waitcnt lgkmcnt(4)
  v_mfma_f32_32x32x16_bf16 v[48:63], v[28:31], a[220:223], v[48:63]
  ds_read_b128 v[24:27], v8 offset:61440
  s_waitcnt lgkmcnt(4)
  v_mfma_f32_32x32x16_bf16 v[48:63], v[32:35], a[224:227], v[48:63]
  ds_read_b128 v[28:31], v8 offset:62464
  buffer_load_dwordx4 v19, s[4:7], s34 offen offset:1024 sc1 lds
  s_waitcnt lgkmcnt(4)
  v_mfma_f32_32x32x16_bf16 v[48:63], v[36:39], a[228:231], v[48:63]
  ds_read_b128 v[32:35], v8 offset:63488
  s_waitcnt lgkmcnt(4)
  v_mfma_f32_32x32x16_bf16 v[48:63], v[40:43], a[232:235], v[48:63]
  ds_read_b128 v[36:39], v8 offset:64512
  buffer_load_dwordx4 v19, s[4:7], s34 offen offset:2048 sc1 lds
  s_waitcnt lgkmcnt(4)
  v_mfma_f32_32x32x16_bf16 v[48:63], v[44:47], a[236:239], v[48:63]
  s_waitcnt lgkmcnt(3)
  v_mfma_f32_32x32x16_bf16 v[48:63], v[24:27], a[240:243], v[48:63]
  buffer_load_dwordx4 v19, s[4:7], s34 offen offset:3072 sc1 lds
  v_xor_b32 v8, 65536, v8
  s_waitcnt lgkmcnt(2)
  v_mfma_f32_32x32x16_bf16 v[48:63], v[28:31], a[244:247], v[48:63]
  s_waitcnt lgkmcnt(1)
  v_mfma_f32_32x32x16_bf16 v[48:63], v[32:35], a[248:251], v[48:63]
  s_waitcnt lgkmcnt(0)
  v_mfma_f32_32x32x16_bf16 v[48:63], v[36:39], a[252:255], v[48:63]
  s_mov_b32 s24, s28
  s_mov_b32 s43, s27
  s_mov_b32 s25, s30
  s_mov_b32 s26, s31
  s_mov_b32 s27, s32
  s_mov_b32 s28, s33
  s_mov_b32 s68, s43
  s_nop 4
  v_cvt_pk_bf16_f32 v96, v48, v49
  buffer_store_dword v96, v3, s[4:7], s68 offen offset:0 sc1
  v_cvt_pk_bf16_f32 v97, v50, v51
  buffer_store_dword v97, v3, s[4:7], s68 offen offset:2048 sc1
  s_add_u32 s68, s68, 8192
  v_cvt_pk_bf16_f32 v98, v52, v53
  buffer_store_dword v98, v3, s[4:7], s68 offen offset:0 sc1
  v_cvt_pk_bf16_f32 v99, v54, v55
  buffer_store_dword v99, v3, s[4:7], s68 offen offset:2048 sc1
  s_add_u32 s68, s68, 8192
  v_cvt_pk_bf16_f32 v100, v56, v57
  buffer_store_dword v100, v3, s[4:7], s68 offen offset:0 sc1
  v_cvt_pk_bf16_f32 v101, v58, v59
  buffer_store_dword v101, v3, s[4:7], s68 offen offset:2048 sc1
  s_add_u32 s68, s68, 8192
  v_cvt_pk_bf16_f32 v102, v60, v61
  buffer_store_dword v102, v3, s[4:7], s68 offen offset:0 sc1
  v_cvt_pk_bf16_f32 v103, v62, v63
  buffer_store_dword v103, v3, s[4:7], s68 offen offset:2048 sc1
  s_add_u32 s68, s68, 8192
  s_cmp_lt_u32 s16, s19
  s_cbranch_scc1 L_s3_top
L_s3_done:
  s_waitcnt vmcnt(0)
  s_mov_b64 exec, 1
  buffer_store_dword v7, off, s[4:7], s24 sc1
  s_mov_b64 exec, -1
  s_mov_b32 s24, 536870912
  s_branch L_end
L_s4:
  s_lshl_b32 s67, s13, 2
  s_add_u32 s67, s67, s14
  s_lshl_b32 s67, s67, 11
  s_lshl_b32 s68, s12, 21
  s_add_u32 s67, s67, s68
  s_add_u32 s67, s67, 16777216
  v_lshrrev_b32 v69, 4, v0
  v_lshlrev_b32 v69, 17, v69
  v_and_b32 v70, 15, v0
  v_lshl_add_u32 v69, v70, 7, v69
  buffer_load_dword v70, v69, s[4:7], s67 offen sc1
  s_lshl_b32 s29, s14, 10
  v_lshrrev_b32 v66, 4, v0
  v_and_b32 v67, 15, v0
  s_load_dwordx2 s[80:81], s[0:1], 64
  s_mov_b32 s82, 1835008
  s_mov_b32 s83, 0x20000
  s_load_dwordx2 s[84:85], s[0:1], 72
  s_mov_b32 s86, 1835008
  s_mov_b32 s87, 0x20000
  s_lshl_b32 s67, s14, 2
  v_add_u32 v66, s67, v66
  v_mul_u32_u24 v66, 3584, v66
  v_lshl_add_u32 v24, v67, 4, v66
  s_lshl_b32 s40, s13, 8
  v_lshrrev_b32 v60, 5, v0
  v_bfe_u32 v61, v0, 2, 2
  v_lshl_add_u32 v60, v60, 3, v61
  v_lshlrev_b32 v60, 8, v60
  v_bfe_u32 v61, v0, 4, 1
  v_and_b32 v62, 3, v0
  v_lshl_add_u32 v61, v61, 2, v62
  v_and_b32 v63, 1, v61
  v_lshrrev_b32 v64, 1, v61
  v_lshrrev_b32 v65, 1, v64
  v_and_b32 v64, 1, v64
  v_lshlrev_b32 v62, 5, v65
  v_lshl_add_u32 v62, v63, 4, v62
  v_lshl_add_u32 v62, v64, 3, v62
  s_lshl_b32 s67, s14, 6
  v_add3_u32 v60, v60, v62, s67
  v_mov_b32 v28, v60
  v_add_u32 v29, 0x10000, v60
  v_add_u32 v30, 0x20000, v60
  s_waitcnt lgkmcnt(0)
  s_add_u32 s67, s29, 0
  s_mov_b32 m0, s67
  s_add_u32 s68, s40, 0
  buffer_load_dwordx4 v24, s[80:83], s68 offen lds
  s_add_u32 s67, s29, 4096
  s_mov_b32 m0, s67
  s_add_u32 s68, s40, 57344
  buffer_load_dwordx4 v24, s[80:83], s68 offen lds
  s_add_u32 s67, s29, 8192
  s_mov_b32 m0, s67
  s_add_u32 s68, s40, 114688
  buffer_load_dwordx4 v24, s[80:83], s68 offen lds
  s_add_u32 s67, s29, 12288
  s_mov_b32 m0, s67
  s_add_u32 s68, s40, 172032
  buffer_load_dwordx4 v24, s[80:83], s68 offen lds
  s_add_u32 s67, s29, 16384
  s_mov_b32 m0, s67
  s_add_u32 s68, s40, 229376
  buffer_load_dwordx4 v24, s[80:83], s68 offen lds
  s_add_u32 s67, s29, 20480
  s_mov_b32 m0, s67
  s_add_u32 s68, s40, 286720
  buffer_load_dwordx4 v24, s[80:83], s68 offen lds
  s_add_u32 s67, s29, 24576
  s_mov_b32 m0, s67
  s_add_u32 s68, s40, 344064
  buffer_load_dwordx4 v24, s[80:83], s68 offen lds
  s_add_u32 s67, s29, 28672
  s_mov_b32 m0, s67
  s_add_u32 s68, s40, 401408
  buffer_load_dwordx4 v24, s[80:83], s68 offen lds
  s_add_u32 s67, s29, 32768
  s_mov_b32 m0, s67
  s_add_u32 s68, s40, 458752
  buffer_load_dwordx4 v24, s[80:83], s68 offen lds
  s_add_u32 s67, s29, 36864
  s_mov_b32 m0, s67
  s_add_u32 s68, s40, 516096
  buffer_load_dwordx4 v24, s[80:83], s68 offen lds
  s_add_u32 s67, s29, 40960
  s_mov_b32 m0, s67
  s_add_u32 s68, s40, 573440
  buffer_load_dwordx4 v24, s[80:83], s68 offen lds
  s_add_u32 s67, s29, 45056
  s_mov_b32 m0, s67
  s_add_u32 s68, s40, 630784
  buffer_load_dwordx4 v24, s[80:83], s68 offen lds
  s_add_u32 s67, s29, 49152
  s_mov_b32 m0, s67
  s_add_u32 s68, s40, 688128
  buffer_load_dwordx4 v24, s[80:83], s68 offen lds
  s_add_u32 s67, s29, 53248
  s_mov_b32 m0, s67
  s_add_u32 s68, s40, 745472
  buffer_load_dwordx4 v24, s[80:83], s68 offen lds
  s_add_u32 s67, s29, 57344
  s_mov_b32 m0, s67
  s_add_u32 s68, s40, 802816
  buffer_load_dwordx4 v24, s[80:83], s68 offen lds
  s_add_u32 s67, s29, 61440
  s_mov_b32 m0, s67
  s_add_u32 s68, s40, 860160
  buffer_load_dwordx4 v24, s[80:83], s68 offen lds
  s_add_u32 s67, s29, 65536
  s_mov_b32 m0, s67
  s_add_u32 s68, s40, 917504
  buffer_load_dwordx4 v24, s[80:83], s68 offen lds
  s_add_u32 s67, s29, 69632
  s_mov_b32 m0, s67
  s_add_u32 s68, s40, 974848
  buffer_load_dwordx4 v24, s[80:83], s68 offen lds
  s_add_u32 s67, s29, 73728
  s_mov_b32 m0, s67
  s_add_u32 s68, s40, 1032192
  buffer_load_dwordx4 v24, s[80:83], s68 offen lds
  s_add_u32 s67, s29, 77824
  s_mov_b32 m0, s67
  s_add_u32 s68, s40, 1089536
  buffer_load_dwordx4 v24, s[80:83], s68 offen lds
  s_add_u32 s67, s29, 81920
  s_mov_b32 m0, s67
  s_add_u32 s68, s40, 1146880
  buffer_load_dwordx4 v24, s[80:83], s68 offen lds
  s_add_u32 s67, s29, 86016
  s_mov_b32 m0, s67
  s_add_u32 s68, s40, 1204224
  buffer_load_dwordx4 v24, s[80:83], s68 offen lds
  s_add_u32 s67, s29, 90112
  s_mov_b32 m0, s67
  s_add_u32 s68, s40, 1261568
  buffer_load_dwordx4 v24, s[80:83], s68 offen lds
  s_add_u32 s67, s29, 94208
  s_mov_b32 m0, s67
  s_add_u32 s68, s40, 1318912
  buffer_load_dwordx4 v24, s[80:83], s68 offen lds
  s_add_u32 s67, s29, 98304
  s_mov_b32 m0, s67
  s_add_u32 s68, s40, 1376256
  buffer_load_dwordx4 v24, s[80:83], s68 offen lds
  s_add_u32 s67, s29, 102400
  s_mov_b32 m0, s67
  s_add_u32 s68, s40, 1433600
  buffer_load_dwordx4 v24, s[80:83], s68 offen lds
  s_add_u32 s67, s29, 106496
  s_mov_b32 m0, s67
  s_add_u32 s68, s40, 1490944
  buffer_load_dwordx4 v24, s[80:83], s68 offen lds
  s_add_u32 s67, s29, 110592
  s_mov_b32 m0, s67
  s_add_u32 s68, s40, 1548288
  buffer_load_dwordx4 v24, s[80:83], s68 offen lds
  s_add_u32 s67, s29, 114688
  s_mov_b32 m0, s67
  s_add_u32 s68, s40, 1605632
  buffer_load_dwordx4 v24, s[80:83], s68 offen lds
  s_add_u32 s67, s29, 118784
  s_mov_b32 m0, s67
  s_add_u32 s68, s40, 1662976
  buffer_load_dwordx4 v24, s[80:83], s68 offen lds
  s_add_u32 s67, s29, 122880
  s_mov_b32 m0, s67
  s_add_u32 s68, s40, 1720320
  buffer_load_dwordx4 v24, s[80:83], s68 offen lds
  s_add_u32 s67, s29, 126976
  s_mov_b32 m0, s67
  s_add_u32 s68, s40, 1777664
  buffer_load_dwordx4 v24, s[80:83], s68 offen lds
  s_waitcnt vmcnt(28)
  s_barrier
  s_add_u32 s67, s29, 131072
  s_mov_b32 m0, s67
  s_add_u32 s68, s40, 0
  buffer_load_dwordx4 v24, s[84:87], s68 offen lds
  s_add_u32 s67, s29, 135168
  s_mov_b32 m0, s67
  s_add_u32 s68, s40, 57344
  buffer_load_dwordx4 v24, s[84:87], s68 offen lds
  s_add_u32 s67, s29, 139264
  s_mov_b32 m0, s67
  s_add_u32 s68, s40, 114688
  buffer_load_dwordx4 v24, s[84:87], s68 offen lds
  s_add_u32 s67, s29, 143360
  s_mov_b32 m0, s67
  s_add_u32 s68, s40, 172032
  buffer_load_dwordx4 v24, s[84:87], s68 offen lds
  ds_read_b64_tr_b16 a[0:1], v28 offset:0
  ds_read_b64_tr_b16 a[2:3], v28 offset:1024
  ds_read_b64_tr_b16 a[4:5], v28 offset:4096
  ds_read_b64_tr_b16 a[6:7], v28 offset:5120
  ds_read_b64_tr_b16 a[8:9], v28 offset:8192
  ds_read_b64_tr_b16 a[10:11], v28 offset:9216
  ds_read_b64_tr_b16 a[12:13], v28 offset:12288
  ds_read_b64_tr_b16 a[14:15], v28 offset:13312
  s_waitcnt vmcnt(28) lgkmcnt(0)
  s_barrier
  s_add_u32 s67, s29, 0
  s_mov_b32 m0, s67
  s_add_u32 s68, s40, 229376
  buffer_load_dwordx4 v24, s[84:87], s68 offen lds
  s_add_u32 s67, s29, 4096
  s_mov_b32 m0, s67
  s_add_u32 s68, s40, 286720
  buffer_load_dwordx4 v24, s[84:87], s68 offen lds
  s_add_u32 s67, s29, 8192
  s_mov_b32 m0, s67
  s_add_u32 s68, s40, 344064
  buffer_load_dwordx4 v24, s[84:87], s68 offen lds
  s_add_u32 s67, s29, 12288
  s_mov_b32 m0, s67
  s_add_u32 s68, s40, 401408
  buffer_load_dwordx4 v24, s[84:87], s68 offen lds
  ds_read_b64_tr_b16 a[16:17], v28 offset:16384
  ds_read_b64_tr_b16 a[18:19], v28 offset:17408
  ds_read_b64_tr_b16 a[20:21], v28 offset:20480
  ds_read_b64_tr_b16 a[22:23], v28 offset:21504
  ds_read_b64_tr_b16 a[24:25], v28 offset:24576
  ds_read_b64_tr_b16 a[26:27], v28 offset:25600
  ds_read_b64_tr_b16 a[28:29], v28 offset:28672
  ds_read_b64_tr_b16 a[30:31], v28 offset:29696
  s_waitcnt vmcnt(28) lgkmcnt(0)
  s_barrier
  s_add_u32 s67, s29, 16384
  s_mov_b32 m0, s67
  s_add_u32 s68, s40, 458752
  buffer_load_dwordx4 v24, s[84:87], s68 offen lds
  s_add_u32 s67, s29, 20480
  s_mov_b32 m0, s67
  s_add_u32 s68, s40, 516096
  buffer_load_dwordx4 v24, s[84:87], s68 offen lds
  s_add_u32 s67, s29, 24576
  s_mov_b32 m0, s67
  s_add_u32 s68, s40, 573440
  buffer_load_dwordx4 v24, s[84:87], s68 offen lds
  s_add_u32 s67, s29, 28672
  s_mov_b32 m0, s67
  s_add_u32 s68, s40, 630784
  buffer_load_dwordx4 v24, s[84:87], s68 offen lds
  ds_read_b64_tr_b16 a[32:33], v28 offset:32768
  ds_read_b64_tr_b16 a[34:35], v28 offset:33792
  ds_read_b64_tr_b16 a[36:37], v28 offset:36864
  ds_read_b64_tr_b16 a[38:39], v28 offset:37888
  ds_read_b64_tr_b16 a[40:41], v28 offset:40960
  ds_read_b64_tr_b16 a[42:43], v28 offset:41984
  ds_read_b64_tr_b16 a[44:45], v28 offset:45056
  ds_read_b64_tr_b16 a[46:47], v28 offset:46080
  s_waitcnt vmcnt(28) lgkmcnt(0)
  s_barrier
  s_add_u32 s67, s29, 32768
  s_mov_b32 m0, s67
  s_add_u32 s68, s40, 688128
  buffer_load_dwordx4 v24, s[84:87], s68 offen lds
  s_add_u32 s67, s29, 36864
  s_mov_b32 m0, s67
  s_add_u32 s68, s40, 745472
  buffer_load_dwordx4 v24, s[84:87], s68 offen lds
  s_add_u32 s67, s29, 40960
  s_mov_b32 m0, s67
  s_add_u32 s68, s40, 802816
  buffer_load_dwordx4 v24, s[84:87], s68 offen lds
  s_add_u32 s67, s29, 45056
  s_mov_b32 m0, s67
  s_add_u32 s68, s40, 860160
  buffer_load_dwordx4 v24, s[84:87], s68 offen lds
  ds_read_b64_tr_b16 a[48:49], v28 offset:49152
  ds_read_b64_tr_b16 a[50:51], v28 offset:50176
  ds_read_b64_tr_b16 a[52:53], v28 offset:53248
  ds_read_b64_tr_b16 a[54:55], v28 offset:54272
  ds_read_b64_tr_b16 a[56:57], v28 offset:57344
  ds_read_b64_tr_b16 a[58:59], v28 offset:58368
  ds_read_b64_tr_b16 a[60:61], v28 offset:61440
  ds_read_b64_tr_b16 a[62:63], v28 offset:62464
  s_waitcnt vmcnt(28) lgkmcnt(0)
  s_barrier
  s_add_u32 s67, s29, 49152
  s_mov_b32 m0, s67
  s_add_u32 s68, s40, 917504
  buffer_load_dwordx4 v24, s[84:87], s68 offen lds
  s_add_u32 s67, s29, 53248
  s_mov_b32 m0, s67
  s_add_u32 s68, s40, 974848
  buffer_load_dwordx4 v24, s[84:87], s68 offen lds
  s_add_u32 s67, s29, 57344
  s_mov_b32 m0, s67
  s_add_u32 s68, s40, 1032192
  buffer_load_dwordx4 v24, s[84:87], s68 offen lds
  s_add_u32 s67, s29, 61440
  s_mov_b32 m0, s67
  s_add_u32 s68, s40, 1089536
  buffer_load_dwordx4 v24, s[84:87], s68 offen lds
  ds_read_b64_tr_b16 a[64:65], v29 offset:0
  ds_read_b64_tr_b16 a[66:67], v29 offset:1024
  ds_read_b64_tr_b16 a[68:69], v29 offset:4096
  ds_read_b64_tr_b16 a[70:71], v29 offset:5120
  ds_read_b64_tr_b16 a[72:73], v29 offset:8192
  ds_read_b64_tr_b16 a[74:75], v29 offset:9216
  ds_read_b64_tr_b16 a[76:77], v29 offset:12288
  ds_read_b64_tr_b16 a[78:79], v29 offset:13312
  s_waitcnt vmcnt(28) lgkmcnt(0)
  s_barrier
  s_add_u32 s67, s29, 65536
  s_mov_b32 m0, s67
  s_add_u32 s68, s40, 1146880
  buffer_load_dwordx4 v24, s[84:87], s68 offen lds
  s_add_u32 s67, s29, 69632
  s_mov_b32 m0, s67
  s_add_u32 s68, s40, 1204224
  buffer_load_dwordx4 v24, s[84:87], s68 offen lds
  s_add_u32 s67, s29, 73728
  s_mov_b32 m0, s67
  s_add_u32 s68, s40, 1261568
  buffer_load_dwordx4 v24, s[84:87], s68 offen lds
  s_add_u32 s67, s29, 77824
  s_mov_b32 m0, s67
  s_add_u32 s68, s40, 1318912
  buffer_load_dwordx4 v24, s[84:87], s68 offen lds
  ds_read_b64_tr_b16 a[80:81], v29 offset:16384
  ds_read_b64_tr_b16 a[82:83], v29 offset:17408
  ds_read_b64_tr_b16 a[84:85], v29 offset:20480
  ds_read_b64_tr_b16 a[86:87], v29 offset:21504
  ds_read_b64_tr_b16 a[88:89], v29 offset:24576
  ds_read_b64_tr_b16 a[90:91], v29 offset:25600
  ds_read_b64_tr_b16 a[92:93], v29 offset:28672
  ds_read_b64_tr_b16 a[94:95], v29 offset:29696
  s_waitcnt vmcnt(28) lgkmcnt(0)
  s_barrier
  s_add_u32 s67, s29, 81920
  s_mov_b32 m0, s67
  s_add_u32 s68, s40, 1376256
  buffer_load_dwordx4 v24, s[84:87], s68 offen lds
  s_add_u32 s67, s29, 86016
  s_mov_b32 m0, s67
  s_add_u32 s68, s40, 1433600
  buffer_load_dwordx4 v24, s[84:87], s68 offen lds
  s_add_u32 s67, s29, 90112
  s_mov_b32 m0, s67
  s_add_u32 s68, s40, 1490944
  buffer_load_dwordx4 v24, s[84:87], s68 offen lds
  s_add_u32 s67, s29, 94208
  s_mov_b32 m0, s67
  s_add_u32 s68, s40, 1548288
  buffer_load_dwordx4 v24, s[84:87], s68 offen lds
  ds_read_b64_tr_b16 a[96:97], v29 offset:32768
  ds_read_b64_tr_b16 a[98:99], v29 offset:33792
  ds_read_b64_tr_b16 a[100:101], v29 offset:36864
  ds_read_b64_tr_b16 a[102:103], v29 offset:37888
  ds_read_b64_tr_b16 a[104:105], v29 offset:40960
  ds_read_b64_tr_b16 a[106:107], v29 offset:41984
  ds_read_b64_tr_b16 a[108:109], v29 offset:45056
  ds_read_b64_tr_b16 a[110:111], v29 offset:46080
  s_waitcnt vmcnt(28) lgkmcnt(0)
  s_barrier
  s_add_u32 s67, s29, 98304
  s_mov_b32 m0, s67
  s_add_u32 s68, s40, 1605632
  buffer_load_dwordx4 v24, s[84:87], s68 offen lds
  s_add_u32 s67, s29, 102400
  s_mov_b32 m0, s67
  s_add_u32 s68, s40, 1662976
  buffer_load_dwordx4 v24, s[84:87], s68 offen lds
  s_add_u32 s67, s29, 106496
  s_mov_b32 m0, s67
  s_add_u32 s68, s40, 1720320
  buffer_load_dwordx4 v24, s[84:87], s68 offen lds
  s_add_u32 s67, s29, 110592
  s_mov_b32 m0, s67
  s_add_u32 s68, s40, 1777664
  buffer_load_dwordx4 v24, s[84:87], s68 offen lds
  ds_read_b64_tr_b16 a[112:113], v29 offset:49152
  ds_read_b64_tr_b16 a[114:115], v29 offset:50176
  ds_read_b64_tr_b16 a[116:117], v29 offset:53248
  ds_read_b64_tr_b16 a[118:119], v29 offset:54272
  ds_read_b64_tr_b16 a[120:121], v29 offset:57344
  ds_read_b64_tr_b16 a[122:123], v29 offset:58368
  ds_read_b64_tr_b16 a[124:125], v29 offset:61440
  ds_read_b64_tr_b16 a[126:127], v29 offset:62464
  s_waitcnt vmcnt(28) lgkmcnt(0)
  s_barrier
  ds_read_b64_tr_b16 a[128:129], v30 offset:0
  ds_read_b64_tr_b16 a[130:131], v30 offset:1024
  ds_read_b64_tr_b16 a[132:133], v30 offset:4096
  ds_read_b64_tr_b16 a[134:135], v30 offset:5120
  ds_read_b64_tr_b16 a[136:137], v30 offset:8192
  ds_read_b64_tr_b16 a[138:139], v30 offset:9216
  ds_read_b64_tr_b16 a[140:141], v30 offset:12288
  ds_read_b64_tr_b16 a[142:143], v30 offset:13312
  s_waitcnt vmcnt(24) lgkmcnt(0)
  s_barrier
  ds_read_b64_tr_b16 a[144:145], v28 offset:0
  ds_read_b64_tr_b16 a[146:147], v28 offset:1024
  ds_read_b64_tr_b16 a[148:149], v28 offset:4096
  ds_read_b64_tr_b16 a[150:151], v28 offset:5120
  ds_read_b64_tr_b16 a[152:153], v28 offset:8192
  ds_read_b64_tr_b16 a[154:155], v28 offset:9216
  ds_read_b64_tr_b16 a[156:157], v28 offset:12288
  ds_read_b64_tr_b16 a[158:159], v28 offset:13312
  s_waitcnt vmcnt(20) lgkmcnt(0)
  s_barrier
  ds_read_b64_tr_b16 a[160:161], v28 offset:16384
  ds_read_b64_tr_b16 a[162:163], v28 offset:17408
  ds_read_b64_tr_b16 a[164:165], v28 offset:20480
  ds_read_b64_tr_b16 a[166:167], v28 offset:21504
  ds_read_b64_tr_b16 a[168:169], v28 offset:24576
  ds_read_b64_tr_b16 a[170:171], v28 offset:25600
  ds_read_b64_tr_b16 a[172:173], v28 offset:28672
  ds_read_b64_tr_b16 a[174:175], v28 offset:29696
  s_waitcnt vmcnt(16) lgkmcnt(0)
  s_barrier
  ds_read_b64_tr_b16 a[176:177], v28 offset:32768
  ds_read_b64_tr_b16 a[178:179], v28 offset:33792
  ds_read_b64_tr_b16 a[180:181], v28 offset:36864
  ds_read_b64_tr_b16 a[182:183], v28 offset:37888
  ds_read_b64_tr_b16 a[184:185], v28 offset:40960
  ds_read_b64_tr_b16 a[186:187], v28 offset:41984
  ds_read_b64_tr_b16 a[188:189], v28 offset:45056
  ds_read_b64_tr_b16 a[190:191], v28 offset:46080
  s_waitcnt vmcnt(12) lgkmcnt(0)
  s_barrier
  ds_read_b64_tr_b16 a[192:193], v28 offset:49152
  ds_read_b64_tr_b16 a[194:195], v28 offset:50176
  ds_read_b64_tr_b16 a[196:197], v28 offset:53248
  ds_read_b64_tr_b16 a[198:199], v28 offset:54272
  ds_read_b64_tr_b16 a[200:201], v28 offset:57344
  ds_read_b64_tr_b16 a[202:203], v28 offset:58368
  ds_read_b64_tr_b16 a[204:205], v28 offset:61440
  ds_read_b64_tr_b16 a[206:207], v28 offset:62464
  s_waitcnt vmcnt(8) lgkmcnt(0)
  s_barrier
  ds_read_b64_tr_b16 a[208:209], v29 offset:0
  ds_read_b64_tr_b16 a[210:211], v29 offset:1024
  ds_read_b64_tr_b16 a[212:213], v29 offset:4096
  ds_read_b64_tr_b16 a[214:215], v29 offset:5120
  ds_read_b64_tr_b16 a[216:217], v29 offset:8192
  ds_read_b64_tr_b16 a[218:219], v29 offset:9216
  ds_read_b64_tr_b16 a[220:221], v29 offset:12288
  ds_read_b64_tr_b16 a[222:223], v29 offset:13312
  s_waitcnt vmcnt(4) lgkmcnt(0)
  s_barrier
  ds_read_b64_tr_b16 a[224:225], v29 offset:16384
  ds_read_b64_tr_b16 a[226:227], v29 offset:17408
  ds_read_b64_tr_b16 a[228:229], v29 offset:20480
  ds_read_b64_tr_b16 a[230:231], v29 offset:21504
  ds_read_b64_tr_b16 a[232:233], v29 offset:24576
  ds_read_b64_tr_b16 a[234:235], v29 offset:25600
  ds_read_b64_tr_b16 a[236:237], v29 offset:28672
  ds_read_b64_tr_b16 a[238:239], v29 offset:29696
  s_waitcnt vmcnt(0) lgkmcnt(0)
  s_barrier
  ds_read_b64_tr_b16 a[240:241], v29 offset:32768
  ds_read_b64_tr_b16 a[242:243], v29 offset:33792
  ds_read_b64_tr_b16 a[244:245], v29 offset:36864
  ds_read_b64_tr_b16 a[246:247], v29 offset:37888
  ds_read_b64_tr_b16 a[248:249], v29 offset:40960
  ds_read_b64_tr_b16 a[250:251], v29 offset:41984
  ds_read_b64_tr_b16 a[252:253], v29 offset:45056
  ds_read_b64_tr_b16 a[254:255], v29 offset:46080
  s_waitcnt lgkmcnt(0)
  s_barrier
  v_and_b32 v60, 31, v0
  v_lshrrev_b32 v61, 5, v0
  v_and_b32 v62, 15, v0
  v_xor_b32 v62, v62, v61
  v_lshlrev_b32 v62, 4, v62
  v_lshl_add_u32 v62, v60, 8, v62
  v_xor_b32 v8, 0, v62
  v_xor_b32 v9, 32, v62
  v_xor_b32 v10, 64, v62
  v_xor_b32 v11, 96, v62
  v_xor_b32 v12, 128, v62
  v_xor_b32 v13, 160, v62
  v_xor_b32 v14, 192, v62
  v_xor_b32 v15, 224, v62
  s_and_b32 s67, s14, 1
  s_lshl_b32 s67, s67, 3
  v_lshrrev_b32 v63, 4, v0
  v_and_b32 v62, 15, v0
  v_xor_b32 v62, v62, v63
  v_xor_b32 v62, s67, v62
  v_lshlrev_b32 v62, 4, v62
  v_lshl_add_u32 v16, v63, 10, v62
  v_xor_b32 v62, 64, v16
  v_add_u32 v17, 4096, v62
  v_lshlrev_b32 v1, 5, v60
  s_lshl_b32 s29, s14, 11
  s_lshl_b32 s41, s14, 13
  s_mov_b32 s22, 1
  s_mov_b32 s17, 0x1000
  s_mov_b32 s18, 0x1000
  s_mov_b32 s19, 64
  s_lshl_b32 s15, s12, 6
  s_mov_b32 s20, 0
  s_mov_b32 s21, 0
  s_lshl_b32 s69, s14, 2
  s_lshl_b32 s48, s12, 21
  s_lshl_b32 s49, s12, 16
  s_lshl_b32 s67, s48, 1
  s_add_u32 s67, s67, s41
  s_add_u32 s35, s67, 4194304
  s_lshl_b32 s67, s13, 13
  s_lshl_b32 s68, s14, 11
  s_add_u32 s67, s67, s68
  s_add_u32 s67, s67, s48
  s_add_u32 s36, s67, 16777216
  v_lshlrev_b32 v3, 4, v0
  s_mov_b32 s46, 0xbfb8aa3b
  s_mov_b32 s47, 0xbfb8aa3b
  s_add_u32 s67, s49, 196608
  v_lshlrev_b32 v62, 5, v60
  v_add_u32 v62, s67, v62
  v_lshlrev_b32 v63, 2, v60
  v_add_u32 v63, 585728, v63
  v_cmp_eq_u32 vcc, 0, v61
  s_nop 1
  v_cndmask_b32 v1, v63, v62, vcc
  s_mov_b32 s38, 0
  s_lshl_b32 s67, s13, 4
  s_add_u32 s67, s67, s69
  s_add_u32 s37, s67, 720896
  s_and_b32 s71, s15, 3
  s_mul_i32 s70, s71, 32768
  s_add_u32 s30, s70, s35
  s_mul_i32 s70, s15, 1024
  s_add_u32 s31, s70, s38
  s_mul_i32 s70, s71, 131072
  s_add_u32 s32, s70, s36
  s_mul_i32 s70, s15, 1024
  s_add_u32 s33, s70, s37
  s_mov_b32 s25, s30
  s_mov_b32 s26, s31
  s_mov_b32 s27, s32
  s_mov_b32 s28, s33
  s_mov_b32 s16, 0
  s_mov_b32 s43, 536870912
  s_mov_b32 s23, 0
  s_mov_b32 s24, 536870912
  v_mov_b32 v7, 1
  v_mov_b32 v2, 0
  v_mbcnt_lo_u32_b32 v102, -1, 0
  v_and_b32 v100, 1, v102
  v_lshlrev_b32 v100, 7, v100
  v_bfe_u32 v102, v102, 1, 2
  v_lshl_add_u32 v100, v102, 2, v100
  v_add_u32 v100, s2, v100
L_go_9:
  s_sub_u32 s66, s66, 1
  s_cbranch_scc1 L_abort
  global_load_dword v101, v100, s[62:63] sc1
  s_waitcnt vmcnt(0)
  v_and_b32 v102, 0xff, v101
  v_cmp_eq_u32 vcc, 32, v102
  v_bfe_u32 v102, v101, 8, 8
  v_lshrrev_b32 v103, 16, v101
  s_and_b32 s67, vcc_lo, 0xff
  s_cmp_eq_u32 s67, 0xff
  s_cbranch_scc1 L_go_9_ok
  v_and_b32 v102, 0xff, v101
  v_cmp_lt_u32 vcc, 32, v102
  s_cbranch_vccnz L_abort
  s_sleep 8
  s_branch L_go_9
L_go_9_ok:
  v_mul_u32_u24 v102, v102, v102
  v_lshlrev_b32 v103, 5, v103
  v_cmp_eq_u32 vcc, v102, v103
  s_nop 3
  s_and_b32 s67, vcc_lo, 0xff
  s_cmp_lg_u32 s67, 0xff
  s_cbranch_scc1 L_regroup
L_s4_top:
  s_mov_b32 s42, s23
  s_cmp_lg_u32 s23, 0
  s_cbranch_scc1 L_s4_iss
  s_waitcnt vmcnt(2)
  v_cmp_ne_u32 vcc, 0, v2
  s_cmp_lt_u32 s16, 4
  s_cselect_b32 s68, -1, 0
  s_or_b32 vcc_hi, vcc_hi, s68
  s_cmp_eq_u64 vcc, exec
  s_cbranch_scc1 L_s4_dma
  s_waitcnt vmcnt(0)
  s_mov_b64 exec, 1
  buffer_store_dword v7, off, s[4:7], s24
  s_mov_b64 exec, -1
  s_mov_b32 s24, 536870912
L_s4_poll:
  s_sub_u32 s66, s66, 1
  s_cbranch_scc1 L_abort
  buffer_load_dword v2, v1, s[4:7], s26 offen sc1
  s_waitcnt vmcnt(0)
  v_cmp_ne_u32 vcc, 0, v2
  s_cmp_lt_u32 s16, 4
  s_cselect_b32 s68, -1, 0
  s_or_b32 vcc_hi, vcc_hi, s68
  s_cmp_eq_u64 vcc, exec
  s_cbranch_scc0 L_s4_poll
L_s4_dma:
  s_add_u32 m0, s29, 0
  s_nop 0
  buffer_load_dwordx4 v16, s[4:7], s25 offen offset:0 sc1 lds
  s_add_u32 m0, s29, 1024
  s_nop 0
  buffer_load_dwordx4 v17, s[4:7], s25 offen offset:0 sc1 lds
  s_add_u32 m0, s29, 7936
  s_nop 0
  buffer_load_dwordx4 v16, s[4:7], s25 offen offset:256 sc1 lds
  s_add_u32 m0, s29, 8960
  s_nop 0
  buffer_load_dwordx4 v17, s[4:7], s25 offen offset:256 sc1 lds
  s_add_u32 m0, s29, 15872
  s_nop 0
  buffer_load_dwordx4 v16, s[4:7], s25 offen offset:512 sc1 lds
  s_add_u32 m0, s29, 16896
  s_nop 0
  buffer_load_dwordx4 v17, s[4:7], s25 offen offset:512 sc1 lds
  s_add_u32 m0, s29, 23808
  s_nop 0
  buffer_load_dwordx4 v16, s[4:7], s25 offen offset:768 sc1 lds
  s_add_u32 m0, s29, 24832
  s_nop 0
  buffer_load_dwordx4 v17, s[4:7], s25 offen offset:768 sc1 lds
  s_waitcnt vmcnt(8)
  s_mov_b64 exec, 1
  buffer_store_dword v7, off, s[4:7], s24
  s_mov_b64 exec, -1
  s_mov_b32 s24, 536870912
  s_waitcnt vmcnt(7)
L_s4_iss:
  s_waitcnt vmcnt(9)
  .p2align 3
L_s4_go:
  s_barrier
  s_nop 0
  ds_read_b128 v[24:27], v8 offset:0
  ds_read_b128 v[28:31], v9 offset:0
  ds_read_b128 v[32:35], v10 offset:0
  ds_read_b128 v[36:39], v11 offset:0
  ds_read_b128 v[40:43], v12 offset:0
  s_xor_b32 s29, s29, 32768
  s_waitcnt lgkmcnt(4)
  v_mfma_f32_32x32x16_bf16 v[48:63], a[0:3], v[24:27], 0
  ds_read_b128 v[44:47], v13 offset:0
  s_add_u32 s16, s16, 1
  s_add_u32 s15, s15, 1
  s_and_b32 s71, s15, 3
  s_mul_i32 s70, s71, 32768
  v_mfma_f32_32x32x16_bf16 v[64:79], a[128:131], v[24:27], 0
  s_add_u32 s30, s70, s35
  s_mul_i32 s70, s15, 1024
  s_add_u32 s31, s70, s38
  s_mul_i32 s70, s71, 131072
  s_waitcnt lgkmcnt(4)
  v_mfma_f32_32x32x16_bf16 v[48:63], a[4:7], v[28:31], v[48:63]
  ds_read_b128 v[24:27], v14 offset:0
  s_add_u32 s32, s70, s36
  s_mul_i32 s70, s15, 1024
  s_add_u32 s33, s70, s37
  v_mfma_f32_32x32x16_bf16 v[64:79], a[132:135], v[28:31], v[64:79]
  s_waitcnt lgkmcnt(4)
  v_mfma_f32_32x32x16_bf16 v[48:63], a[8:11], v[32:35], v[48:63]
  ds_read_b128 v[28:31], v15 offset:0
  v_mfma_f32_32x32x16_bf16 v[64:79], a[136:139], v[32:35], v[64:79]
  s_waitcnt lgkmcnt(4)
  v_mfma_f32_32x32x16_bf16 v[48:63], a[12:15], v[36:39], v[48:63]
  s_cmp_lg_u32 s42, 0
  s_cbranch_scc1 L_s4_c1
  s_waitcnt vmcnt(5)
L_s4_c1:
  s_waitcnt vmcnt(7)
  s_barrier
  ds_read_b128 v[32:35], v8 offset:8192
  v_mfma_f32_32x32x16_bf16 v[64:79], a[140:143], v[36:39], v[64:79]
  s_waitcnt lgkmcnt(4)
  v_mfma_f32_32x32x16_bf16 v[48:63], a[16:19], v[40:43], v[48:63]
  ds_read_b128 v[36:39], v9 offset:8192
  v_mfma_f32_32x32x16_bf16 v[64:79], a[144:147], v[40:43], v[64:79]
  s_waitcnt lgkmcnt(4)
  v_mfma_f32_32x32x16_bf16 v[48:63], a[20:23], v[44:47], v[48:63]
  ds_read_b128 v[40:43], v10 offset:8192
  v_mfma_f32_32x32x16_bf16 v[64:79], a[148:151], v[44:47], v[64:79]
  s_waitcnt lgkmcnt(4)
  v_mfma_f32_32x32x16_bf16 v[48:63], a[24:27], v[24:27], v[48:63]
  ds_read_b128 v[44:47], v11 offset:8192
  v_mfma_f32_32x32x16_bf16 v[64:79], a[152:155], v[24:27], v[64:79]
  buffer_load_dword v2, v1, s[4:7], s31 offen sc1
  s_waitcnt lgkmcnt(4)
  v_mfma_f32_32x32x16_bf16 v[48:63], a[28:31], v[28:31], v[48:63]
  ds_read_b128 v[24:27], v12 offset:8192
  v_mfma_f32_32x32x16_bf16 v[64:79], a[156:159], v[28:31], v[64:79]
  s_waitcnt lgkmcnt(4)
  v_mfma_f32_32x32x16_bf16 v[48:63], a[32:35], v[32:35], v[48:63]
  ds_read_b128 v[28:31], v13 offset:8192
  v_mfma_f32_32x32x16_bf16 v[64:79], a[160:163], v[32:35], v[64:79]
  s_cmp_eq_u32 s42, 0
  s_cbranch_scc1 L_s4_kp
  s_waitcnt vmcnt(1)
  s_mov_b64 exec, 1
  buffer_store_dword v7, off, s[4:7], s24
  s_mov_b64 exec, -1
  s_mov_b32 s24, 536870912
L_s4_kp:
  s_waitcnt lgkmcnt(4)
  v_mfma_f32_32x32x16_bf16 v[48:63], a[36:39], v[36:39], v[48:63]
  ds_read_b128 v[32:35], v14 offset:8192
  v_mfma_f32_32x32x16_bf16 v[64:79], a[164:167], v[36:39], v[64:79]
  s_waitcnt lgkmcnt(4)
  v_mfma_f32_32x32x16_bf16 v[48:63], a[40:43], v[40:43], v[48:63]
  ds_read_b128 v[36:39], v15 offset:8192
  v_mfma_f32_32x32x16_bf16 v[64:79], a[168:171], v[40:43], v[64:79]
  s_waitcnt lgkmcnt(4)
  v_mfma_f32_32x32x16_bf16 v[48:63], a[44:47], v[44:47], v[48:63]
  s_cmp_lg_u32 s42, 0
  s_cbranch_scc1 L_s4_c2
  s_waitcnt vmcnt(4)
L_s4_c2:
  s_waitcnt vmcnt(6)
  s_barrier
  ds_read_b128 v[40:43], v8 offset:16384
  v_mfma_f32_32x32x16_bf16 v[64:79], a[172:175], v[44:47], v[64:79]
  s_waitcnt lgkmcnt(4)
  v_mfma_f32_32x32x16_bf16 v[48:63], a[48:51], v[24:27], v[48:63]
  ds_read_b128 v[44:47], v9 offset:16384
  v_mfma_f32_32x32x16_bf16 v[64:79], a[176:179], v[24:27], v[64:79]
  s_waitcnt lgkmcnt(4)
  v_mfma_f32_32x32x16_bf16 v[48:63], a[52:55], v[28:31], v[48:63]
  ds_read_b128 v[24:27], v10 offset:16384
  v_mfma_f32_32x32x16_bf16 v[64:79], a[180:183], v[28:31], v[64:79]
  s_waitcnt lgkmcnt(4)
  v_mfma_f32_32x32x16_bf16 v[48:63], a[56:59], v[32:35], v[48:63]
  ds_read_b128 v[28:31], v11 offset:16384
  v_mfma_f32_32x32x16_bf16 v[64:79], a[184:187], v[32:35], v[64:79]
  s_waitcnt lgkmcnt(4)
  v_mfma_f32_32x32x16_bf16 v[48:63], a[60:63], v[36:39], v[48:63]
  ds_read_b128 v[32:35], v12 offset:16384
  v_mfma_f32_32x32x16_bf16 v[64:79], a[188:191], v[36:39], v[64:79]
  s_waitcnt lgkmcnt(4)
  v_mfma_f32_32x32x16_bf16 v[48:63], a[64:67], v[40:43], v[48:63]
  ds_read_b128 v[36:39], v13 offset:16384
  v_mfma_f32_32x32x16_bf16 v[64:79], a[192:195], v[40:43], v[64:79]
  s_waitcnt vmcnt(0)
  v_cmp_ne_u32 vcc, 0, v2
  s_mov_b64 exec, 1
  buffer_store_dword v7, off, s[4:7], s24
  s_mov_b64 exec, -1
  s_mov_b32 s24, 536870912
  s_waitcnt lgkmcnt(4)
  v_mfma_f32_32x32x16_bf16 v[48:63], a[68:71], v[44:47], v[48:63]
  ds_read_b128 v[40:43], v14 offset:16384
  s_cmp_lt_u32 s16, 4
  s_cselect_b32 s68, -1, 0
  s_or_b32 vcc_hi, vcc_hi, s68
  s_cmp_eq_u64 vcc, exec
  s_cselect_b32 s23, 1, 0
  s_cselect_b32 s34, s30, 536870912
  s_cmp_lt_u32 s16, s19
  s_cselect_b32 s34, s34, 536870912
  v_mfma_f32_32x32x16_bf16 v[64:79], a[196:199], v[44:47], v[64:79]
  s_add_u32 m0, s29, 0
  s_nop 0
  buffer_load_dwordx4 v16, s[4:7], s34 offen offset:0 sc1 lds
  s_waitcnt lgkmcnt(4)
  v_mfma_f32_32x32x16_bf16 v[48:63], a[72:75], v[24:27], v[48:63]
  ds_read_b128 v[44:47], v15 offset:16384
  v_mfma_f32_32x32x16_bf16 v[64:79], a[200:203], v[24:27], v[64:79]
  s_add_u32 m0, s29, 1024
  s_nop 0
  buffer_load_dwordx4 v17, s[4:7], s34 offen offset:0 sc1 lds
  s_waitcnt lgkmcnt(4)
  v_mfma_f32_32x32x16_bf16 v[48:63], a[76:79], v[28:31], v[48:63]
  s_cmp_lg_u32 s42, 0
  s_cbranch_scc1 L_s4_c3
  s_waitcnt vmcnt(5)
L_s4_c3:
  s_waitcnt vmcnt(7)
  s_barrier
  ds_read_b128 v[24:27], v8 offset:24576
  v_mfma_f32_32x32x16_bf16 v[64:79], a[204:207], v[28:31], v[64:79]
  s_add_u32 m0, s29, 7936
  s_nop 0
  buffer_load_dwordx4 v16, s[4:7], s34 offen offset:256 sc1 lds
  s_waitcnt lgkmcnt(4)
  v_mfma_f32_32x32x16_bf16 v[48:63], a[80:83], v[32:35], v[48:63]
  ds_read_b128 v[28:31], v9 offset:24576
  v_mfma_f32_32x32x16_bf16 v[64:79], a[208:211], v[32:35], v[64:79]
  s_add_u32 m0, s29, 8960
  s_nop 0
  buffer_load_dwordx4 v17, s[4:7], s34 offen offset:256 sc1 lds
  s_waitcnt lgkmcnt(4)
  v_mfma_f32_32x32x16_bf16 v[48:63], a[84:87], v[36:39], v[48:63]
  ds_read_b128 v[32:35], v10 offset:24576
  v_mfma_f32_32x32x16_bf16 v[64:79], a[212:215], v[36:39], v[64:79]
  s_add_u32 m0, s29, 15872
  s_nop 0
  buffer_load_dwordx4 v16, s[4:7], s34 offen offset:512 sc1 lds
  s_waitcnt lgkmcnt(4)
  v_mfma_f32_32x32x16_bf16 v[48:63], a[88:91], v[40:43], v[48:63]
  ds_read_b128 v[36:39], v11 offset:24576
  v_mfma_f32_32x32x16_bf16 v[64:79], a[216:219], v[40:43], v[64:79]
  s_add_u32 m0, s29, 16896
  s_nop 0
  buffer_load_dwordx4 v17, s[4:7], s34 offen offset:512 sc1 lds
  s_waitcnt lgkmcnt(4)
  v_mfma_f32_32x32x16_bf16 v[48:63], a[92:95], v[44:47], v[48:63]
  ds_read_b128 v[40:43], v12 offset:24576
  v_mfma_f32_32x32x16_bf16 v[64:79], a[220:223], v[44:47], v[64:79]
  s_add_u32 m0, s29, 23808
  s_nop 0
  buffer_load_dwordx4 v16, s[4:7], s34 offen offset:768 sc1 lds
  s_waitcnt lgkmcnt(4)
  v_mfma_f32_32x32x16_bf16 v[48:63], a[96:99], v[24:27], v[48:63]
  ds_read_b128 v[44:47], v13 offset:24576
  v_mfma_f32_32x32x16_bf16 v[64:79], a[224:227], v[24:27], v[64:79]
  s_add_u32 m0, s29, 24832
  s_nop 0
  buffer_load_dwordx4 v17, s[4:7], s34 offen offset:768 sc1 lds
  s_waitcnt lgkmcnt(4)
  v_mfma_f32_32x32x16_bf16 v[48:63], a[100:103], v[28:31], v[48:63]
  ds_read_b128 v[24:27], v14 offset:24576
  v_mfma_f32_32x32x16_bf16 v[64:79], a[228:231], v[28:31], v[64:79]
  s_waitcnt lgkmcnt(4)
  v_mfma_f32_32x32x16_bf16 v[48:63], a[104:107], v[32:35], v[48:63]
  ds_read_b128 v[28:31], v15 offset:24576
  v_mfma_f32_32x32x16_bf16 v[64:79], a[232:235], v[32:35], v[64:79]
  s_waitcnt lgkmcnt(4)
  v_mfma_f32_32x32x16_bf16 v[48:63], a[108:111], v[36:39], v[48:63]
  v_mfma_f32_32x32x16_bf16 v[64:79], a[236:239], v[36:39], v[64:79]
  s_waitcnt lgkmcnt(3)
  v_mfma_f32_32x32x16_bf16 v[48:63], a[112:115], v[40:43], v[48:63]
  v_mfma_f32_32x32x16_bf16 v[64:79], a[240:243], v[40:43], v[64:79]
  v_xor_b32 v8, 32768, v8
  v_xor_b32 v9, 32768, v9
  s_waitcnt lgkmcnt(2)
  v_mfma_f32_32x32x16_bf16 v[48:63], a[116:119], v[44:47], v[48:63]
  v_mfma_f32_32x32x16_bf16 v[64:79], a[244:247], v[44:47], v[64:79]
  v_xor_b32 v10, 32768, v10
  v_xor_b32 v11, 32768, v11
  s_waitcnt lgkmcnt(1)
  v_mfma_f32_32x32x16_bf16 v[48:63], a[120:123], v[24:27], v[48:63]
  v_mfma_f32_32x32x16_bf16 v[64:79], a[248:251], v[24:27], v[64:79]
  buffer_load_dword v2, v1, s[4:7], s31 offen sc1
  v_xor_b32 v12, 32768, v12
  v_xor_b32 v13, 32768, v13
  s_waitcnt lgkmcnt(0)
  v_mfma_f32_32x32x16_bf16 v[48:63], a[124:127], v[28:31], v[48:63]
  v_mfma_f32_32x32x16_bf16 v[64:79], a[252:255], v[28:31], v[64:79]
  v_xor_b32 v14, 32768, v14
  v_xor_b32 v15, 32768, v15
  s_mov_b32 s24, s28
  s_mov_b32 s43, s27
  s_mov_b32 s25, s30
  s_mov_b32 s26, s31
  s_mov_b32 s27, s32
  s_mov_b32 s28, s33
  s_nop 2
  v_pk_mul_f32 v[48:49], v[48:49], s[46:47]
  v_pk_mul_f32 v[50:51], v[50:51], s[46:47]
  v_pk_mul_f32 v[52:53], v[52:53], s[46:47]
  v_pk_mul_f32 v[54:55], v[54:55], s[46:47]
  v_exp_f32_e64 v48, v48
  v_exp_f32 v49, v49
  v_exp_f32 v50, v50
  v_exp_f32 v51, v51
  v_exp_f32 v52, v52
  v_exp_f32 v53, v53
  v_exp_f32 v54, v54
  v_exp_f32 v55, v55
  v_pk_add_f32 v[48:49], v[48:49], 1.0 op_sel_hi:[1,0]
  v_pk_add_f32 v[50:51], v[50:51], 1.0 op_sel_hi:[1,0]
  v_pk_add_f32 v[52:53], v[52:53], 1.0 op_sel_hi:[1,0]
  v_pk_add_f32 v[54:55], v[54:55], 1.0 op_sel_hi:[1,0]
  v_rcp_f32 v48, v48
  v_rcp_f32 v49, v49
  v_rcp_f32 v50, v50
  v_rcp_f32 v51, v51
  v_rcp_f32 v52, v52
  v_rcp_f32 v53, v53
  v_rcp_f32 v54, v54
  v_rcp_f32 v55, v55
  v_pk_mul_f32 v[48:49], v[48:49], v[64:65]
  v_pk_mul_f32 v[50:51], v[50:51], v[66:67]
  v_pk_mul_f32 v[52:53], v[52:53], v[68:69]
  v_pk_mul_f32 v[54:55], v[54:55], v[70:71]
  v_cvt_pk_bf16_f32 v96, v48, v49
  v_cvt_pk_bf16_f32 v97, v50, v51
  v_cvt_pk_bf16_f32 v98, v52, v53
  v_cvt_pk_bf16_f32 v99, v54, v55
  buffer_store_dwordx4 v[96:99], v3, s[4:7], s43 offen offset:0
  v_pk_mul_f32 v[56:57], v[56:57], s[46:47]
  v_pk_mul_f32 v[58:59], v[58:59], s[46:47]
  v_pk_mul_f32 v[60:61], v[60:61], s[46:47]
  v_pk_mul_f32 v[62:63], v[62:63], s[46:47]
  v_exp_f32 v56, v56
  v_exp_f32 v57, v57
  v_exp_f32 v58, v58
  v_exp_f32 v59, v59
  v_exp_f32 v60, v60
  v_exp_f32 v61, v61
  v_exp_f32 v62, v62
  v_exp_f32 v63, v63
  v_pk_add_f32 v[56:57], v[56:57], 1.0 op_sel_hi:[1,0]
  v_pk_add_f32 v[58:59], v[58:59], 1.0 op_sel_hi:[1,0]
  v_pk_add_f32 v[60:61], v[60:61], 1.0 op_sel_hi:[1,0]
  v_pk_add_f32 v[62:63], v[62:63], 1.0 op_sel_hi:[1,0]
  v_rcp_f32 v56, v56
  v_rcp_f32 v57, v57
  v_rcp_f32 v58, v58
  v_rcp_f32 v59, v59
  v_rcp_f32 v60, v60
  v_rcp_f32 v61, v61
  v_rcp_f32 v62, v62
  v_rcp_f32 v63, v63
  v_pk_mul_f32 v[56:57], v[56:57], v[72:73]
  v_pk_mul_f32 v[58:59], v[58:59], v[74:75]
  v_pk_mul_f32 v[60:61], v[60:61], v[76:77]
  v_pk_mul_f32 v[62:63], v[62:63], v[78:79]
  v_cvt_pk_bf16_f32 v100, v56, v57
  v_cvt_pk_bf16_f32 v101, v58, v59
  v_cvt_pk_bf16_f32 v102, v60, v61
  v_cvt_pk_bf16_f32 v103, v62, v63
  buffer_store_dwordx4 v[100:103], v3, s[4:7], s43 offen offset:1024
  s_cmp_lt_u32 s16, s19
  s_cbranch_scc1 L_s4_top
L_s4_done:
  s_waitcnt vmcnt(0)
  s_mov_b64 exec, 1
  buffer_store_dword v7, off, s[4:7], s24
  s_mov_b64 exec, -1
  s_mov_b32 s24, 536870912
  s_branch L_end
L_s5:
  s_lshl_b32 s67, s13, 2
  s_add_u32 s67, s67, s14
  s_lshl_b32 s67, s67, 13
  s_lshl_b32 s68, s12, 21
  s_add_u32 s67, s67, s68
  s_add_u32 s67, s67, 234881024
  v_lshlrev_b32 v69, 7, v0
  buffer_load_dword v70, v69, s[4:7], s67 offen sc1
  s_lshl_b32 s29, s14, 10
  v_lshrrev_b32 v66, 4, v0
  v_and_b32 v67, 15, v0
  s_load_dwordx2 s[80:81], s[0:1], 80
  s_mov_b32 s82, 1835008
  s_mov_b32 s83, 0x20000
  s_lshl_b32 s67, s14, 2
  v_add_u32 v66, s67, v66
  v_mul_u32_u24 v66, 1024, v66
  v_lshl_add_u32 v24, v67, 4, v66
  s_lshr_b32 s67, s13, 2
  s_mul_i32 s40, s67, 917504
  s_and_b32 s68, s13, 3
  s_lshl_b32 s68, s68, 8
  s_add_u32 s40, s40, s68
  v_lshrrev_b32 v60, 5, v0
  v_bfe_u32 v61, v0, 2, 2
  v_lshl_add_u32 v60, v60, 3, v61
  v_lshlrev_b32 v60, 8, v60
  v_bfe_u32 v61, v0, 4, 1
  v_and_b32 v62, 3, v0
  v_lshl_add_u32 v61, v61, 2, v62
  v_lshrrev_b32 v63, 2, v61
  v_and_b32 v64, 3, v61
  v_lshlrev_b32 v62, 7, v63
  v_lshl_add_u32 v62, v64, 4, v62
  s_lshr_b32 s67, s14, 1
  s_lshl_b32 s67, s67, 6
  s_and_b32 s68, s14, 1
  s_lshl_b32 s68, s68, 3
  s_add_u32 s67, s67, s68
  v_add3_u32 v60, v60, v62, s67
  v_mov_b32 v28, v60
  v_add_u32 v29, 0x10000, v60
  v_add_u32 v30, 0x20000, v60
  s_waitcnt lgkmcnt(0)
  s_add_u32 s67, s29, 0
  s_mov_b32 m0, s67
  s_add_u32 s68, s40, 0
  buffer_load_dwordx4 v24, s[80:83], s68 offen lds
  s_add_u32 s67, s29, 4096
  s_mov_b32 m0, s67
  s_add_u32 s68, s40, 16384
  buffer_load_dwordx4 v24, s[80:83], s68 offen lds
  s_add_u32 s67, s29, 8192
  s_mov_b32 m0, s67
  s_add_u32 s68, s40, 32768
  buffer_load_dwordx4 v24, s[80:83], s68 offen lds
  s_add_u32 s67, s29, 12288
  s_mov_b32 m0, s67
  s_add_u32 s68, s40, 49152
  buffer_load_dwordx4 v24, s[80:83], s68 offen lds
  s_add_u32 s67, s29, 16384
  s_mov_b32 m0, s67
  s_add_u32 s68, s40, 65536
  buffer_load_dwordx4 v24, s[80:83], s68 offen lds
  s_add_u32 s67, s29, 20480
  s_mov_b32 m0, s67
  s_add_u32 s68, s40, 81920
  buffer_load_dwordx4 v24, s[80:83], s68 offen lds
  s_add_u32 s67, s29, 24576
  s_mov_b32 m0, s67
  s_add_u32 s68, s40, 98304
  buffer_load_dwordx4 v24, s[80:83], s68 offen lds
  s_add_u32 s67, s29, 28672
  s_mov_b32 m0, s67
  s_add_u32 s68, s40, 114688
  buffer_load_dwordx4 v24, s[80:83], s68 offen lds
  s_add_u32 s67, s29, 32768
  s_mov_b32 m0, s67
  s_add_u32 s68, s40, 131072
  buffer_load_dwordx4 v24, s[80:83], s68 offen lds
  s_add_u32 s67, s29, 36864
  s_mov_b32 m0, s67
  s_add_u32 s68, s40, 147456
  buffer_load_dwordx4 v24, s[80:83], s68 offen lds
  s_add_u32 s67, s29, 40960
  s_mov_b32 m0, s67
  s_add_u32 s68, s40, 163840
  buffer_load_dwordx4 v24, s[80:83], s68 offen lds
  s_add_u32 s67, s29, 45056
  s_mov_b32 m0, s67
  s_add_u32 s68, s40, 180224
  buffer_load_dwordx4 v24, s[80:83], s68 offen lds
  s_add_u32 s67, s29, 49152
  s_mov_b32 m0, s67
  s_add_u32 s68, s40, 196608
  buffer_load_dwordx4 v24, s[80:83], s68 offen lds
  s_add_u32 s67, s29, 53248
  s_mov_b32 m0, s67
  s_add_u32 s68, s40, 212992
  buffer_load_dwordx4 v24, s[80:83], s68 offen lds
  s_add_u32 s67, s29, 57344
  s_mov_b32 m0, s67
  s_add_u32 s68, s40, 229376
  buffer_load_dwordx4 v24, s[80:83], s68 offen lds
  s_add_u32 s67, s29, 61440
  s_mov_b32 m0, s67
  s_add_u32 s68, s40, 245760
  buffer_load_dwordx4 v24, s[80:83], s68 offen lds
  s_add_u32 s67, s29, 65536
  s_mov_b32 m0, s67
  s_add_u32 s68, s40, 262144
  buffer_load_dwordx4 v24, s[80:83], s68 offen lds
  s_add_u32 s67, s29, 69632
  s_mov_b32 m0, s67
  s_add_u32 s68, s40, 278528
  buffer_load_dwordx4 v24, s[80:83], s68 offen lds
  s_add_u32 s67, s29, 73728
  s_mov_b32 m0, s67
  s_add_u32 s68, s40, 294912
  buffer_load_dwordx4 v24, s[80:83], s68 offen lds
  s_add_u32 s67, s29, 77824
  s_mov_b32 m0, s67
  s_add_u32 s68, s40, 311296
  buffer_load_dwordx4 v24, s[80:83], s68 offen lds
  s_add_u32 s67, s29, 81920
  s_mov_b32 m0, s67
  s_add_u32 s68, s40, 327680
  buffer_load_dwordx4 v24, s[80:83], s68 offen lds
  s_add_u32 s67, s29, 86016
  s_mov_b32 m0, s67
  s_add_u32 s68, s40, 344064
  buffer_load_dwordx4 v24, s[80:83], s68 offen lds
  s_add_u32 s67, s29, 90112
  s_mov_b32 m0, s67
  s_add_u32 s68, s40, 360448
  buffer_load_dwordx4 v24, s[80:83], s68 offen lds
  s_add_u32 s67, s29, 94208
  s_mov_b32 m0, s67
  s_add_u32 s68, s40, 376832
  buffer_load_dwordx4 v24, s[80:83], s68 offen lds
  s_add_u32 s67, s29, 98304
  s_mov_b32 m0, s67
  s_add_u32 s68, s40, 393216
  buffer_load_dwordx4 v24, s[80:83], s68 offen lds
  s_add_u32 s67, s29, 102400
  s_mov_b32 m0, s67
  s_add_u32 s68, s40, 409600
  buffer_load_dwordx4 v24, s[80:83], s68 offen lds
  s_add_u32 s67, s29, 106496
  s_mov_b32 m0, s67
  s_add_u32 s68, s40, 425984
  buffer_load_dwordx4 v24, s[80:83], s68 offen lds
  s_add_u32 s67, s29, 110592
  s_mov_b32 m0, s67
  s_add_u32 s68, s40, 442368
  buffer_load_dwordx4 v24, s[80:83], s68 offen lds
  s_add_u32 s67, s29, 114688
  s_mov_b32 m0, s67
  s_add_u32 s68, s40, 458752
  buffer_load_dwordx4 v24, s[80:83], s68 offen lds
  s_add_u32 s67, s29, 118784
  s_mov_b32 m0, s67
  s_add_u32 s68, s40, 475136
  buffer_load_dwordx4 v24, s[80:83], s68 offen lds
  s_add_u32 s67, s29, 122880
  s_mov_b32 m0, s67
  s_add_u32 s68, s40, 491520
  buffer_load_dwordx4 v24, s[80:83], s68 offen lds
  s_add_u32 s67, s29, 126976
  s_mov_b32 m0, s67
  s_add_u32 s68, s40, 507904
  buffer_load_dwordx4 v24, s[80:83], s68 offen lds
  s_waitcnt vmcnt(28)
  s_barrier
  s_add_u32 s67, s29, 131072
  s_mov_b32 m0, s67
  s_add_u32 s68, s40, 524288
  buffer_load_dwordx4 v24, s[80:83], s68 offen lds
  s_add_u32 s67, s29, 135168
  s_mov_b32 m0, s67
  s_add_u32 s68, s40, 540672
  buffer_load_dwordx4 v24, s[80:83], s68 offen lds
  s_add_u32 s67, s29, 139264
  s_mov_b32 m0, s67
  s_add_u32 s68, s40, 557056
  buffer_load_dwordx4 v24, s[80:83], s68 offen lds
  s_add_u32 s67, s29, 143360
  s_mov_b32 m0, s67
  s_add_u32 s68, s40, 573440
  buffer_load_dwordx4 v24, s[80:83], s68 offen lds
  ds_read_b64_tr_b16 a[0:1], v28 offset:0
  ds_read_b64_tr_b16 a[2:3], v28 offset:1024
  ds_read_b64_tr_b16 a[4:5], v28 offset:4096
  ds_read_b64_tr_b16 a[6:7], v28 offset:5120
  ds_read_b64_tr_b16 a[8:9], v28 offset:8192
  ds_read_b64_tr_b16 a[10:11], v28 offset:9216
  ds_read_b64_tr_b16 a[12:13], v28 offset:12288
  ds_read_b64_tr_b16 a[14:15], v28 offset:13312
  s_waitcnt vmcnt(28) lgkmcnt(0)
  s_barrier
  s_add_u32 s67, s29, 0
  s_mov_b32 m0, s67
  s_add_u32 s68, s40, 589824
  buffer_load_dwordx4 v24, s[80:83], s68 offen lds
  s_add_u32 s67, s29, 4096
  s_mov_b32 m0, s67
  s_add_u32 s68, s40, 606208
  buffer_load_dwordx4 v24, s[80:83], s68 offen lds
  s_add_u32 s67, s29, 8192
  s_mov_b32 m0, s67
  s_add_u32 s68, s40, 622592
  buffer_load_dwordx4 v24, s[80:83], s68 offen lds
  s_add_u32 s67, s29, 12288
  s_mov_b32 m0, s67
  s_add_u32 s68, s40, 638976
  buffer_load_dwordx4 v24, s[80:83], s68 offen lds
  ds_read_b64_tr_b16 a[16:17], v28 offset:16384
  ds_read_b64_tr_b16 a[18:19], v28 offset:17408
  ds_read_b64_tr_b16 a[20:21], v28 offset:20480
  ds_read_b64_tr_b16 a[22:23], v28 offset:21504
  ds_read_b64_tr_b16 a[24:25], v28 offset:24576
  ds_read_b64_tr_b16 a[26:27], v28 offset:25600
  ds_read_b64_tr_b16 a[28:29], v28 offset:28672
  ds_read_b64_tr_b16 a[30:31], v28 offset:29696
  s_waitcnt vmcnt(28) lgkmcnt(0)
  s_barrier
  s_add_u32 s67, s29, 16384
  s_mov_b32 m0, s67
  s_add_u32 s68, s40, 655360
  buffer_load_dwordx4 v24, s[80:83], s68 offen lds
  s_add_u32 s67, s29, 20480
  s_mov_b32 m0, s67
  s_add_u32 s68, s40, 671744
  buffer_load_dwordx4 v24, s[80:83], s68 offen lds
  s_add_u32 s67, s29, 24576
  s_mov_b32 m0, s67
  s_add_u32 s68, s40, 688128
  buffer_load_dwordx4 v24, s[80:83], s68 offen lds
  s_add_u32 s67, s29, 28672
  s_mov_b32 m0, s67
  s_add_u32 s68, s40, 704512
  buffer_load_dwordx4 v24, s[80:83], s68 offen lds
  ds_read_b64_tr_b16 a[32:33], v28 offset:32768
  ds_read_b64_tr_b16 a[34:35], v28 offset:33792
  ds_read_b64_tr_b16 a[36:37], v28 offset:36864
  ds_read_b64_tr_b16 a[38:39], v28 offset:37888
  ds_read_b64_tr_b16 a[40:41], v28 offset:40960
  ds_read_b64_tr_b16 a[42:43], v28 offset:41984
  ds_read_b64_tr_b16 a[44:45], v28 offset:45056
  ds_read_b64_tr_b16 a[46:47], v28 offset:46080
  s_waitcnt vmcnt(28) lgkmcnt(0)
  s_barrier
  s_add_u32 s67, s29, 32768
  s_mov_b32 m0, s67
  s_add_u32 s68, s40, 720896
  buffer_load_dwordx4 v24, s[80:83], s68 offen lds
  s_add_u32 s67, s29, 36864
  s_mov_b32 m0, s67
  s_add_u32 s68, s40, 737280
  buffer_load_dwordx4 v24, s[80:83], s68 offen lds
  s_add_u32 s67, s29, 40960
  s_mov_b32 m0, s67
  s_add_u32 s68, s40, 753664
  buffer_load_dwordx4 v24, s[80:83], s68 offen lds
  s_add_u32 s67, s29, 45056
  s_mov_b32 m0, s67
  s_add_u32 s68, s40, 770048
  buffer_load_dwordx4 v24, s[80:83], s68 offen lds
  ds_read_b64_tr_b16 a[48:49], v28 offset:49152
  ds_read_b64_tr_b16 a[50:51], v28 offset:50176
  ds_read_b64_tr_b16 a[52:53], v28 offset:53248
  ds_read_b64_tr_b16 a[54:55], v28 offset:54272
  ds_read_b64_tr_b16 a[56:57], v28 offset:57344
  ds_read_b64_tr_b16 a[58:59], v28 offset:58368
  ds_read_b64_tr_b16 a[60:61], v28 offset:61440
  ds_read_b64_tr_b16 a[62:63], v28 offset:62464
  s_waitcnt vmcnt(28) lgkmcnt(0)
  s_barrier
  s_add_u32 s67, s29, 49152
  s_mov_b32 m0, s67
  s_add_u32 s68, s40, 786432
  buffer_load_dwordx4 v24, s[80:83], s68 offen lds
  s_add_u32 s67, s29, 53248
  s_mov_b32 m0, s67
  s_add_u32 s68, s40, 802816
  buffer_load_dwordx4 v24, s[80:83], s68 offen lds
  s_add_u32 s67, s29, 57344
  s_mov_b32 m0, s67
  s_add_u32 s68, s40, 819200
  buffer_load_dwordx4 v24, s[80:83], s68 offen lds
  s_add_u32 s67, s29, 61440
  s_mov_b32 m0, s67
  s_add_u32 s68, s40, 835584
  buffer_load_dwordx4 v24, s[80:83], s68 offen lds
  ds_read_b64_tr_b16 a[64:65], v29 offset:0
  ds_read_b64_tr_b16 a[66:67], v29 offset:1024
  ds_read_b64_tr_b16 a[68:69], v29 offset:4096
  ds_read_b64_tr_b16 a[70:71], v29 offset:5120
  ds_read_b64_tr_b16 a[72:73], v29 offset:8192
  ds_read_b64_tr_b16 a[74:75], v29 offset:9216
  ds_read_b64_tr_b16 a[76:77], v29 offset:12288
  ds_read_b64_tr_b16 a[78:79], v29 offset:13312
  s_waitcnt vmcnt(28) lgkmcnt(0)
  s_barrier
  s_add_u32 s67, s29, 65536
  s_mov_b32 m0, s67
  s_add_u32 s68, s40, 851968
  buffer_load_dwordx4 v24, s[80:83], s68 offen lds
  s_add_u32 s67, s29, 69632
  s_mov_b32 m0, s67
  s_add_u32 s68, s40, 868352
  buffer_load_dwordx4 v24, s[80:83], s68 offen lds
  s_add_u32 s67, s29, 73728
  s_mov_b32 m0, s67
  s_add_u32 s68, s40, 884736
  buffer_load_dwordx4 v24, s[80:83], s68 offen lds
  s_add_u32 s67, s29, 77824
  s_mov_b32 m0, s67
  s_add_u32 s68, s40, 901120
  buffer_load_dwordx4 v24, s[80:83], s68 offen lds
  ds_read_b64_tr_b16 a[80:81], v29 offset:16384
  ds_read_b64_tr_b16 a[82:83], v29 offset:17408
  ds_read_b64_tr_b16 a[84:85], v29 offset:20480
  ds_read_b64_tr_b16 a[86:87], v29 offset:21504
  ds_read_b64_tr_b16 a[88:89], v29 offset:24576
  ds_read_b64_tr_b16 a[90:91], v29 offset:25600
  ds_read_b64_tr_b16 a[92:93], v29 offset:28672
  ds_read_b64_tr_b16 a[94:95], v29 offset:29696
  s_waitcnt vmcnt(28) lgkmcnt(0)
  s_barrier
  ds_read_b64_tr_b16 a[96:97], v29 offset:32768
  ds_read_b64_tr_b16 a[98:99], v29 offset:33792
  ds_read_b64_tr_b16 a[100:101], v29 offset:36864
  ds_read_b64_tr_b16 a[102:103], v29 offset:37888
  ds_read_b64_tr_b16 a[104:105], v29 offset:40960
  ds_read_b64_tr_b16 a[106:107], v29 offset:41984
  ds_read_b64_tr_b16 a[108:109], v29 offset:45056
  ds_read_b64_tr_b16 a[110:111], v29 offset:46080
  s_waitcnt vmcnt(24) lgkmcnt(0)
  s_barrier
  ds_read_b64_tr_b16 a[112:113], v29 offset:49152
  ds_read_b64_tr_b16 a[114:115], v29 offset:50176
  ds_read_b64_tr_b16 a[116:117], v29 offset:53248
  ds_read_b64_tr_b16 a[118:119], v29 offset:54272
  ds_read_b64_tr_b16 a[120:121], v29 offset:57344
  ds_read_b64_tr_b16 a[122:123], v29 offset:58368
  ds_read_b64_tr_b16 a[124:125], v29 offset:61440
  ds_read_b64_tr_b16 a[126:127], v29 offset:62464
  s_waitcnt vmcnt(20) lgkmcnt(0)
  s_barrier
  ds_read_b64_tr_b16 a[128:129], v30 offset:0
  ds_read_b64_tr_b16 a[130:131], v30 offset:1024
  ds_read_b64_tr_b16 a[132:133], v30 offset:4096
  ds_read_b64_tr_b16 a[134:135], v30 offset:5120
  ds_read_b64_tr_b16 a[136:137], v30 offset:8192
  ds_read_b64_tr_b16 a[138:139], v30 offset:9216
  ds_read_b64_tr_b16 a[140:141], v30 offset:12288
  ds_read_b64_tr_b16 a[142:143], v30 offset:13312
  s_waitcnt vmcnt(16) lgkmcnt(0)
  s_barrier
  ds_read_b64_tr_b16 a[144:145], v28 offset:0
  ds_read_b64_tr_b16 a[146:147], v28 offset:1024
  ds_read_b64_tr_b16 a[148:149], v28 offset:4096
  ds_read_b64_tr_b16 a[150:151], v28 offset:5120
  ds_read_b64_tr_b16 a[152:153], v28 offset:8192
  ds_read_b64_tr_b16 a[154:155], v28 offset:9216
  ds_read_b64_tr_b16 a[156:157], v28 offset:12288
  ds_read_b64_tr_b16 a[158:159], v28 offset:13312
  s_waitcnt vmcnt(12) lgkmcnt(0)
  s_barrier
  ds_read_b64_tr_b16 a[160:161], v28 offset:16384
  ds_read_b64_tr_b16 a[162:163], v28 offset:17408
  ds_read_b64_tr_b16 a[164:165], v28 offset:20480
  ds_read_b64_tr_b16 a[166:167], v28 offset:21504
  ds_read_b64_tr_b16 a[168:169], v28 offset:24576
  ds_read_b64_tr_b16 a[170:171], v28 offset:25600
  ds_read_b64_tr_b16 a[172:173], v28 offset:28672
  ds_read_b64_tr_b16 a[174:175], v28 offset:29696
  s_waitcnt vmcnt(8) lgkmcnt(0)
  s_barrier
  ds_read_b64_tr_b16 a[176:177], v28 offset:32768
  ds_read_b64_tr_b16 a[178:179], v28 offset:33792
  ds_read_b64_tr_b16 a[180:181], v28 offset:36864
  ds_read_b64_tr_b16 a[182:183], v28 offset:37888
  ds_read_b64_tr_b16 a[184:185], v28 offset:40960
  ds_read_b64_tr_b16 a[186:187], v28 offset:41984
  ds_read_b64_tr_b16 a[188:189], v28 offset:45056
  ds_read_b64_tr_b16 a[190:191], v28 offset:46080
  s_waitcnt vmcnt(4) lgkmcnt(0)
  s_barrier
  ds_read_b64_tr_b16 a[192:193], v28 offset:49152
  ds_read_b64_tr_b16 a[194:195], v28 offset:50176
  ds_read_b64_tr_b16 a[196:197], v28 offset:53248
  ds_read_b64_tr_b16 a[198:199], v28 offset:54272
  ds_read_b64_tr_b16 a[200:201], v28 offset:57344
  ds_read_b64_tr_b16 a[202:203], v28 offset:58368
  ds_read_b64_tr_b16 a[204:205], v28 offset:61440
  ds_read_b64_tr_b16 a[206:207], v28 offset:62464
  s_waitcnt vmcnt(0) lgkmcnt(0)
  s_barrier
  ds_read_b64_tr_b16 a[208:209], v29 offset:0
  ds_read_b64_tr_b16 a[210:211], v29 offset:1024
  ds_read_b64_tr_b16 a[212:213], v29 offset:4096
  ds_read_b64_tr_b16 a[214:215], v29 offset:5120
  ds_read_b64_tr_b16 a[216:217], v29 offset:8192
  ds_read_b64_tr_b16 a[218:219], v29 offset:9216
  ds_read_b64_tr_b16 a[220:221], v29 offset:12288
  ds_read_b64_tr_b16 a[222:223], v29 offset:13312
  s_waitcnt lgkmcnt(0)
  s_barrier
  v_and_b32 v60, 31, v0
  v_lshrrev_b32 v61, 5, v0
  v_lshlrev_b32 v8, 4, v0
  v_add_u32 v16, 0, v8
  v_add_u32 v17, 16384, v8
  v_add_u32 v18, 32768, v8
  v_add_u32 v19, 49152, v8
  s_lshl_b32 s29, s14, 12
  s_mov_b32 s22, 1
  s_mov_b32 s17, 0x1000
  s_mov_b32 s18, 0x1000
  s_mov_b32 s19, 64
  s_lshl_b32 s15, s12, 6
  s_mov_b32 s20, 0
  s_mov_b32 s21, 0
  s_lshl_b32 s69, s14, 2
  s_lshl_b32 s48, s12, 21
  s_lshl_b32 s49, s12, 16
  s_lshr_b32 s70, s13, 2
  s_and_b32 s71, s13, 3
  s_mul_i32 s67, s70, 57344
  s_add_u32 s67, s67, s29
  s_add_u32 s67, s67, s48
  s_add_u32 s35, s67, 16777216
  s_mul_i32 s67, s70, 112
  s_add_u32 s67, s67, 720896
  v_min_u32 v62, 27, v0
  v_lshl_add_u32 v62, v62, 2, s67
  s_add_u32 s67, s49, 258048
  v_lshl_add_u32 v63, v60, 5, s67
  s_lshl_b32 s67, s70, 15
  s_lshl_b32 s68, s71, 7
  s_add_u32 s67, s67, s68
  s_lshr_b32 s68, s14, 1
  s_lshl_b32 s68, s68, 6
  s_add_u32 s67, s67, s68
  s_and_b32 s68, s14, 1
  s_lshl_b32 s68, s68, 10
  s_add_u32 s67, s67, s68
  s_add_u32 s67, s67, s48
  s_add_u32 s36, s67, 234881024
  v_lshlrev_b32 v64, 12, v61
  v_bfe_u32 v65, v60, 1, 1
  v_lshl_add_u32 v64, v65, 9, v64
  v_bfe_u32 v65, v60, 2, 2
  v_lshl_add_u32 v64, v65, 4, v64
  v_lshrrev_b32 v65, 4, v60
  v_lshl_add_u32 v64, v65, 3, v64
  v_and_b32 v65, 1, v60
  v_lshl_add_u32 v3, v65, 2, v64
  v_cmp_eq_u32 vcc, 0, v61
  s_nop 1
  v_cndmask_b32 v1, v63, v62, vcc
  s_mov_b32 s38, 0
  s_lshl_b32 s67, s13, 4
  s_add_u32 s67, s67, s69
  s_add_u32 s37, s67, 589824
  s_lshl_b32 s41, s14, 11
  v_subrev_u32 v19, s41, v19
  s_and_b32 s71, s15, 3
  s_mul_i32 s70, s71, 131072
  s_add_u32 s30, s70, s35
  s_mul_i32 s70, s15, 1024
  s_add_u32 s31, s70, s38
  s_mul_i32 s70, s71, 65536
  s_add_u32 s32, s70, s36
  s_mul_i32 s70, s15, 1024
  s_add_u32 s33, s70, s37
  s_mov_b32 s25, s30
  s_mov_b32 s26, s31
  s_mov_b32 s27, s32
  s_mov_b32 s28, s33
  s_mov_b32 s16, 0
  s_mov_b32 s43, 536870912
  s_mov_b32 s23, 0
  s_mov_b32 s24, 536870912
  v_mov_b32 v7, 1
  v_mov_b32 v2, 0
  v_mbcnt_lo_u32_b32 v102, -1, 0
  v_and_b32 v100, 1, v102
  v_lshlrev_b32 v100, 7, v100
  v_bfe_u32 v102, v102, 1, 2
  v_lshl_add_u32 v100, v102, 2, v100
  v_add_u32 v100, s2, v100
L_go_10:
  s_sub_u32 s66, s66, 1
  s_cbranch_scc1 L_abort
  global_load_dword v101, v100, s[62:63] sc1
  s_waitcnt vmcnt(0)
  v_and_b32 v102, 0xff, v101
  v_cmp_eq_u32 vcc, 32, v102
  v_bfe_u32 v102, v101, 8, 8
  v_lshrrev_b32 v103, 16, v101
  s_and_b32 s67, vcc_lo, 0xff
  s_cmp_eq_u32 s67, 0xff
  s_cbranch_scc1 L_go_10_ok
  v_and_b32 v102, 0xff, v101
  v_cmp_lt_u32 vcc, 32, v102
  s_cbranch_vccnz L_abort
  s_sleep 8
  s_branch L_go_10
L_go_10_ok:
  v_mul_u32_u24 v102, v102, v102
  v_lshlrev_b32 v103, 5, v103
  v_cmp_eq_u32 vcc, v102, v103
  s_nop 3
  s_and_b32 s67, vcc_lo, 0xff
  s_cmp_lg_u32 s67, 0xff
  s_cbranch_scc1 L_regroup
L_s5_top:
  s_mov_b32 s42, s23
  s_cmp_lg_u32 s23, 0
  s_cbranch_scc1 L_s5_iss
  s_waitcnt vmcnt(8)
  v_cmp_ne_u32 vcc, 0, v2
  s_cmp_lt_u32 s16, 4
  s_cselect_b32 s68, -1, 0
  s_or_b32 vcc_hi, vcc_hi, s68
  s_cmp_eq_u64 vcc, exec
  s_cbranch_scc1 L_s5_dma
  s_waitcnt vmcnt(0)
  s_mov_b64 exec, 1
  buffer_store_dword v7, off, s[4:7], s24
  s_mov_b64 exec, -1
  s_mov_b32 s24, 536870912
L_s5_poll:
  s_sub_u32 s66, s66, 1
  s_cbranch_scc1 L_abort
  buffer_load_dword v2, v1, s[4:7], s26 offen sc1
  s_waitcnt vmcnt(0)
  v_cmp_ne_u32 vcc, 0, v2
  s_cmp_lt_u32 s16, 4
  s_cselect_b32 s68, -1, 0
  s_or_b32 vcc_hi, vcc_hi, s68
  s_cmp_eq_u64 vcc, exec
  s_cbranch_scc0 L_s5_poll
L_s5_dma:
  s_add_u32 m0, s29, 0
  s_nop 0
  buffer_load_dwordx4 v16, s[4:7], s25 offen offset:0 sc1 lds
  buffer_load_dwordx4 v16, s[4:7], s25 offen offset:1024 sc1 lds
  buffer_load_dwordx4 v16, s[4:7], s25 offen offset:2048 sc1 lds
  buffer_load_dwordx4 v16, s[4:7], s25 offen offset:3072 sc1 lds
  s_add_u32 m0, s29, 16384
  s_nop 0
  buffer_load_dwordx4 v17, s[4:7], s25 offen offset:0 sc1 lds
  buffer_load_dwordx4 v17, s[4:7], s25 offen offset:1024 sc1 lds
  buffer_load_dwordx4 v17, s[4:7], s25 offen offset:2048 sc1 lds
  buffer_load_dwordx4 v17, s[4:7], s25 offen offset:3072 sc1 lds
  s_add_u32 m0, s29, 32768
  s_nop 0
  buffer_load_dwordx4 v18, s[4:7], s25 offen offset:0 sc1 lds
  buffer_load_dwordx4 v18, s[4:7], s25 offen offset:1024 sc1 lds
  buffer_load_dwordx4 v18, s[4:7], s25 offen offset:2048 sc1 lds
  buffer_load_dwordx4 v18, s[4:7], s25 offen offset:3072 sc1 lds
  s_add_u32 m0, s29, 49152
  s_sub_u32 m0, m0, s41
  s_nop 0
  buffer_load_dwordx4 v19, s[4:7], s25 offen offset:0 sc1 lds
  buffer_load_dwordx4 v19, s[4:7], s25 offen offset:1024 sc1 lds
  s_waitcnt vmcnt(14)
  s_mov_b64 exec, 1
  buffer_store_dword v7, off, s[4:7], s24
  s_mov_b64 exec, -1
  s_mov_b32 s24, 536870912
  s_waitcnt vmcnt(11)
L_s5_iss:
  s_waitcnt vmcnt(19)
  .p2align 3
L_s5_go:
  s_barrier
  s_nop 0
  ds_read_b128 v[24:27], v8 offset:0
  ds_read_b128 v[28:31], v8 offset:1024
  ds_read_b128 v[32:35], v8 offset:2048
  ds_read_b128 v[36:39], v8 offset:3072
  ds_read_b128 v[40:43], v8 offset:4096
  s_xor_b32 s29, s29, 65536
  s_waitcnt lgkmcnt(4)
  v_mfma_f32_32x32x16_bf16 v[48:63], v[24:27], a[0:3], 0
  ds_read_b128 v[44:47], v8 offset:5120
  s_add_u32 s16, s16, 1
  s_add_u32 s15, s15, 1
  s_and_b32 s71, s15, 3
  s_waitcnt lgkmcnt(4)
  v_mfma_f32_32x32x16_bf16 v[48:63], v[28:31], a[4:7], v[48:63]
  ds_read_b128 v[24:27], v8 offset:6144
  s_mul_i32 s70, s71, 131072
  s_add_u32 s30, s70, s35
  s_mul_i32 s70, s15, 1024
  s_waitcnt lgkmcnt(4)
  v_mfma_f32_32x32x16_bf16 v[48:63], v[32:35], a[8:11], v[48:63]
  ds_read_b128 v[28:31], v8 offset:7168
  s_add_u32 s31, s70, s38
  s_mul_i32 s70, s71, 65536
  s_add_u32 s32, s70, s36
  s_waitcnt lgkmcnt(4)
  v_mfma_f32_32x32x16_bf16 v[48:63], v[36:39], a[12:15], v[48:63]
  ds_read_b128 v[32:35], v8 offset:8192
  s_mul_i32 s70, s15, 1024
  s_add_u32 s33, s70, s37
  s_waitcnt lgkmcnt(4)
  v_mfma_f32_32x32x16_bf16 v[48:63], v[40:43], a[16:19], v[48:63]
  ds_read_b128 v[36:39], v8 offset:9216
  s_waitcnt lgkmcnt(4)
  v_mfma_f32_32x32x16_bf16 v[48:63], v[44:47], a[20:23], v[48:63]
  ds_read_b128 v[40:43], v8 offset:10240
  s_waitcnt lgkmcnt(4)
  v_mfma_f32_32x32x16_bf16 v[48:63], v[24:27], a[24:27], v[48:63]
  ds_read_b128 v[44:47], v8 offset:11264
  s_waitcnt lgkmcnt(4)
  v_mfma_f32_32x32x16_bf16 v[48:63], v[28:31], a[28:31], v[48:63]
  ds_read_b128 v[24:27], v8 offset:12288
  s_waitcnt lgkmcnt(4)
  v_mfma_f32_32x32x16_bf16 v[48:63], v[32:35], a[32:35], v[48:63]
  ds_read_b128 v[28:31], v8 offset:13312
  s_waitcnt lgkmcnt(4)
  v_mfma_f32_32x32x16_bf16 v[48:63], v[36:39], a[36:39], v[48:63]
  ds_read_b128 v[32:35], v8 offset:14336
  s_waitcnt lgkmcnt(4)
  v_mfma_f32_32x32x16_bf16 v[48:63], v[40:43], a[40:43], v[48:63]
  ds_read_b128 v[36:39], v8 offset:15360
  s_cmp_eq_u32 s42, 0
  s_cbranch_scc1 L_s5_kp
  s_waitcnt vmcnt(0)
  s_mov_b64 exec, 1
  buffer_store_dword v7, off, s[4:7], s24
  s_mov_b64 exec, -1
  s_mov_b32 s24, 536870912
L_s5_kp:
  s_waitcnt lgkmcnt(4)
  v_mfma_f32_32x32x16_bf16 v[48:63], v[44:47], a[44:47], v[48:63]
  s_cmp_lg_u32 s42, 0
  s_cbranch_scc1 L_s5_c1
  s_waitcnt vmcnt(7)
L_s5_c1:
  s_waitcnt vmcnt(15)
  s_barrier
  ds_read_b128 v[40:43], v8 offset:16384
  s_waitcnt lgkmcnt(4)
  v_mfma_f32_32x32x16_bf16 v[48:63], v[24:27], a[48:51], v[48:63]
  ds_read_b128 v[44:47], v8 offset:17408
  s_waitcnt lgkmcnt(4)
  v_mfma_f32_32x32x16_bf16 v[48:63], v[28:31], a[52:55], v[48:63]
  ds_read_b128 v[24:27], v8 offset:18432
  buffer_load_dword v2, v1, s[4:7], s31 offen sc1
  s_waitcnt lgkmcnt(4)
  v_mfma_f32_32x32x16_bf16 v[48:63], v[32:35], a[56:59], v[48:63]
  ds_read_b128 v[28:31], v8 offset:19456
  s_waitcnt lgkmcnt(4)
  v_mfma_f32_32x32x16_bf16 v[48:63], v[36:39], a[60:63], v[48:63]
  ds_read_b128 v[32:35], v8 offset:20480
  s_waitcnt lgkmcnt(4)
  v_mfma_f32_32x32x16_bf16 v[48:63], v[40:43], a[64:67], v[48:63]
  ds_read_b128 v[36:39], v8 offset:21504
  s_waitcnt lgkmcnt(4)
  v_mfma_f32_32x32x16_bf16 v[48:63], v[44:47], a[68:71], v[48:63]
  ds_read_b128 v[40:43], v8 offset:22528
  s_waitcnt lgkmcnt(4)
  v_mfma_f32_32x32x16_bf16 v[48:63], v[24:27], a[72:75], v[48:63]
  ds_read_b128 v[44:47], v8 offset:23552
  s_waitcnt lgkmcnt(4)
  v_mfma_f32_32x32x16_bf16 v[48:63], v[28:31], a[76:79], v[48:63]
  ds_read_b128 v[24:27], v8 offset:24576
  s_waitcnt lgkmcnt(4)
  v_mfma_f32_32x32x16_bf16 v[48:63], v[32:35], a[80:83], v[48:63]
  ds_read_b128 v[28:31], v8 offset:25600
  s_waitcnt lgkmcnt(4)
  v_mfma_f32_32x32x16_bf16 v[48:63], v[36:39], a[84:87], v[48:63]
  ds_read_b128 v[32:35], v8 offset:26624
  s_waitcnt lgkmcnt(4)
  v_mfma_f32_32x32x16_bf16 v[48:63], v[40:43], a[88:91], v[48:63]
  ds_read_b128 v[36:39], v8 offset:27648
  s_waitcnt lgkmcnt(4)
  v_mfma_f32_32x32x16_bf16 v[48:63], v[44:47], a[92:95], v[48:63]
  ds_read_b128 v[40:43], v8 offset:28672
  s_waitcnt lgkmcnt(4)
  v_mfma_f32_32x32x16_bf16 v[48:63], v[24:27], a[96:99], v[48:63]
  ds_read_b128 v[44:47], v8 offset:29696
  s_waitcnt lgkmcnt(4)
  v_mfma_f32_32x32x16_bf16 v[48:63], v[28:31], a[100:103], v[48:63]
  ds_read_b128 v[24:27], v8 offset:30720
  s_waitcnt lgkmcnt(4)
  v_mfma_f32_32x32x16_bf16 v[48:63], v[32:35], a[104:107], v[48:63]
  ds_read_b128 v[28:31], v8 offset:31744
  s_waitcnt lgkmcnt(4)
  v_mfma_f32_32x32x16_bf16 v[48:63], v[36:39], a[108:111], v[48:63]
  s_cmp_lg_u32 s42, 0
  s_cbranch_scc1 L_s5_c2
  s_waitcnt vmcnt(4)
L_s5_c2:
  s_waitcnt vmcnt(11)
  s_barrier
  ds_read_b128 v[32:35], v8 offset:32768
  s_waitcnt lgkmcnt(4)
  v_mfma_f32_32x32x16_bf16 v[48:63], v[40:43], a[112:115], v[48:63]
  ds_read_b128 v[36:39], v8 offset:33792
  s_waitcnt vmcnt(0)
  v_cmp_ne_u32 vcc, 0, v2
  s_mov_b64 exec, 1
  buffer_store_dword v7, off, s[4:7], s24
  s_mov_b64 exec, -1
  s_mov_b32 s24, 536870912
  s_waitcnt lgkmcnt(4)
  v_mfma_f32_32x32x16_bf16 v[48:63], v[44:47], a[116:119], v[48:63]
  ds_read_b128 v[40:43], v8 offset:34816
  s_cmp_lt_u32 s16, 4
  s_cselect_b32 s68, -1, 0
  s_or_b32 vcc_hi, vcc_hi, s68
  s_cmp_eq_u64 vcc, exec
  s_cselect_b32 s23, 1, 0
  s_cselect_b32 s34, s30, 536870912
  s_cmp_lt_u32 s16, s19
  s_cselect_b32 s34, s34, 536870912
  s_waitcnt lgkmcnt(4)
  v_mfma_f32_32x32x16_bf16 v[48:63], v[24:27], a[120:123], v[48:63]
  ds_read_b128 v[44:47], v8 offset:35840
  s_add_u32 m0, s29, 0
  s_nop 0
  buffer_load_dwordx4 v16, s[4:7], s34 offen offset:0 sc1 lds
  s_waitcnt lgkmcnt(4)
  v_mfma_f32_32x32x16_bf16 v[48:63], v[28:31], a[124:127], v[48:63]
  ds_read_b128 v[24:27], v8 offset:36864
  s_waitcnt lgkmcnt(4)
  v_mfma_f32_32x32x16_bf16 v[48:63], v[32:35], a[128:131], v[48:63]
  ds_read_b128 v[28:31], v8 offset:37888
  buffer_load_dwordx4 v16, s[4:7], s34 offen offset:1024 sc1 lds
  s_waitcnt lgkmcnt(4)
  v_mfma_f32_32x32x16_bf16 v[48:63], v[36:39], a[132:135], v[48:63]
  ds_read_b128 v[32:35], v8 offset:38912
  s_waitcnt lgkmcnt(4)
  v_mfma_f32_32x32x16_bf16 v[48:63], v[40:43], a[136:139], v[48:63]
  ds_read_b128 v[36:39], v8 offset:39936
  buffer_load_dwordx4 v16, s[4:7], s34 offen offset:2048 sc1 lds
  s_waitcnt lgkmcnt(4)
  v_mfma_f32_32x32x16_bf16 v[48:63], v[44:47], a[140:143], v[48:63]
  ds_read_b128 v[40:43], v8 offset:40960
  s_waitcnt lgkmcnt(4)
  v_mfma_f32_32x32x16_bf16 v[48:63], v[24:27], a[144:147], v[48:63]
  ds_read_b128 v[44:47], v8 offset:41984
  buffer_load_dwordx4 v16, s[4:7], s34 offen offset:3072 sc1 lds
  s_waitcnt lgkmcnt(4)
  v_mfma_f32_32x32x16_bf16 v[48:63], v[28:31], a[148:151], v[48:63]
  ds_read_b128 v[24:27], v8 offset:43008
  s_waitcnt lgkmcnt(4)
  v_mfma_f32_32x32x16_bf16 v[48:63], v[32:35], a[152:155], v[48:63]
  ds_read_b128 v[28:31], v8 offset:44032
  s_add_u32 m0, s29, 16384
  s_nop 0
  buffer_load_dwordx4 v17, s[4:7], s34 offen offset:0 sc1 lds
  s_waitcnt lgkmcnt(4)
  v_mfma_f32_32x32x16_bf16 v[48:63], v[36:39], a[156:159], v[48:63]
  ds_read_b128 v[32:35], v8 offset:45056
  s_waitcnt lgkmcnt(4)
  v_mfma_f32_32x32x16_bf16 v[48:63], v[40:43], a[160:163], v[48:63]
  ds_read_b128 v[36:39], v8 offset:46080
  buffer_load_dwordx4 v17, s[4:7], s34 offen offset:1024 sc1 lds
  s_waitcnt lgkmcnt(4)
  v_mfma_f32_32x32x16_bf16 v[48:63], v[44:47], a[164:167], v[48:63]
  ds_read_b128 v[40:43], v8 offset:47104
  s_waitcnt lgkmcnt(4)
  v_mfma_f32_32x32x16_bf16 v[48:63], v[24:27], a[168:171], v[48:63]
  ds_read_b128 v[44:47], v8 offset:48128
  buffer_load_dwordx4 v17, s[4:7], s34 offen offset:2048 sc1 lds
  s_waitcnt lgkmcnt(4)
  v_mfma_f32_32x32x16_bf16 v[48:63], v[28:31], a[172:175], v[48:63]
  s_cmp_lg_u32 s42, 0
  s_cbranch_scc1 L_s5_c3
  s_waitcnt vmcnt(10)
L_s5_c3:
  s_waitcnt vmcnt(17)
  s_barrier
  ds_read_b128 v[24:27], v8 offset:49152
  s_waitcnt lgkmcnt(4)
  v_mfma_f32_32x32x16_bf16 v[48:63], v[32:35], a[176:179], v[48:63]
  ds_read_b128 v[28:31], v8 offset:50176
  buffer_load_dwordx4 v17, s[4:7], s34 offen offset:3072 sc1 lds
  s_waitcnt lgkmcnt(4)
  v_mfma_f32_32x32x16_bf16 v[48:63], v[36:39], a[180:183], v[48:63]
  ds_read_b128 v[32:35], v8 offset:51200
  s_waitcnt lgkmcnt(4)
  v_mfma_f32_32x32x16_bf16 v[48:63], v[40:43], a[184:187], v[48:63]
  ds_read_b128 v[36:39], v8 offset:52224
  s_add_u32 m0, s29, 32768
  s_nop 0
  buffer_load_dwordx4 v18, s[4:7], s34 offen offset:0 sc1 lds
  buffer_load_dword v2, v1, s[4:7], s31 offen sc1
  s_waitcnt lgkmcnt(4)
  v_mfma_f32_32x32x16_bf16 v[48:63], v[44:47], a[188:191], v[48:63]
  ds_read_b128 v[40:43], v8 offset:53248
  s_waitcnt lgkmcnt(4)
  v_mfma_f32_32x32x16_bf16 v[48:63], v[24:27], a[192:195], v[48:63]
  ds_read_b128 v[44:47], v8 offset:54272
  buffer_load_dwordx4 v18, s[4:7], s34 offen offset:1024 sc1 lds
  s_waitcnt lgkmcnt(4)
  v_mfma_f32_32x32x16_bf16 v[48:63], v[28:31], a[196:199], v[48:63]
  ds_read_b128 v[24:27], v8 offset:55296
  s_waitcnt lgkmcnt(4)
  v_mfma_f32_32x32x16_bf16 v[48:63], v[32:35], a[200:203], v[48:63]
  ds_read_b128 v[28:31], v8 offset:56320
  buffer_load_dwordx4 v18, s[4:7], s34 offen offset:2048 sc1 lds
  s_waitcnt lgkmcnt(4)
  v_mfma_f32_32x32x16_bf16 v[48:63], v[36:39], a[204:207], v[48:63]
  s_waitcnt lgkmcnt(3)
  v_mfma_f32_32x32x16_bf16 v[48:63], v[40:43], a[208:211], v[48:63]
  buffer_load_dwordx4 v18, s[4:7], s34 offen offset:3072 sc1 lds
  v_xor_b32 v8, 65536, v8
  s_waitcnt lgkmcnt(2)
  v_mfma_f32_32x32x16_bf16 v[48:63], v[44:47], a[212:215], v[48:63]
  s_waitcnt lgkmcnt(1)
  v_mfma_f32_32x32x16_bf16 v[48:63], v[24:27], a[216:219], v[48:63]
  s_add_u32 m0, s29, 49152
  s_sub_u32 m0, m0, s41
  s_nop 0
  buffer_load_dwordx4 v19, s[4:7], s34 offen offset:0 sc1 lds
  s_waitcnt lgkmcnt(0)
  v_mfma_f32_32x32x16_bf16 v[48:63], v[28:31], a[220:223], v[48:63]
  buffer_load_dwordx4 v19, s[4:7], s34 offen offset:1024 sc1 lds
  s_mov_b32 s24, s28
  s_mov_b32 s43, s27
  s_mov_b32 s25, s30
  s_mov_b32 s26, s31
  s_mov_b32 s27, s32
  s_mov_b32 s28, s33
  s_mov_b32 s68, s43
  s_nop 3
  s_nop 0
  v_cvt_pk_bf16_f32 v96, v48, v49
  buffer_store_dword v96, v3, s[4:7], s68 offen offset:0
  v_cvt_pk_bf16_f32 v97, v50, v51
  buffer_store_dword v97, v3, s[4:7], s68 offen offset:2048
  s_add_u32 s68, s68, 8192
  v_cvt_pk_bf16_f32 v98, v52, v53
  buffer_store_dword v98, v3, s[4:7], s68 offen offset:0
  v_cvt_pk_bf16_f32 v99, v54, v55
  buffer_store_dword v99, v3, s[4:7], s68 offen offset:2048
  s_add_u32 s68, s68, 8192
  v_cvt_pk_bf16_f32 v100, v56, v57
  buffer_store_dword v100, v3, s[4:7], s68 offen offset:0
  v_cvt_pk_bf16_f32 v101, v58, v59
  buffer_store_dword v101, v3, s[4:7], s68 offen offset:2048
  s_add_u32 s68, s68, 8192
  v_cvt_pk_bf16_f32 v102, v60, v61
  buffer_store_dword v102, v3, s[4:7], s68 offen offset:0
  v_cvt_pk_bf16_f32 v103, v62, v63
  buffer_store_dword v103, v3, s[4:7], s68 offen offset:2048
  s_add_u32 s68, s68, 8192
  s_cmp_lt_u32 s16, s19
  s_cbranch_scc1 L_s5_top
L_s5_done:
  s_waitcnt vmcnt(0)
  s_mov_b64 exec, 1
  buffer_store_dword v7, off, s[4:7], s24
  s_mov_b64 exec, -1
  s_mov_b32 s24, 536870912
  s_branch L_end
L_s2:
  v_and_b32 v20, 15, v0
  v_lshrrev_b32 v21, 4, v0
  v_lshlrev_b32 v1, 4, v0
  v_lshlrev_b32 v4, 3, v0
  v_and_b32 v22, 3, v0
  v_lshlrev_b32 v12, 2, v22
  v_lshrrev_b32 v22, 2, v20
  v_and_b32 v23, 1, v20
  v_lshl_add_u32 v22, v22, 1, v23
  v_lshlrev_b32 v22, 6, v22
  v_lshl_add_u32 v3, v21, 4, v22
  v_lshlrev_b32 v22, 9, v21
  v_lshl_add_u32 v5, v20, 5, v22
  v_lshl_add_u32 v6, v20, 4, v22
  v_and_b32 v22, 1, v21
  v_lshlrev_b32 v22, 4, v22
  v_lshrrev_b32 v23, 1, v21
  v_lshl_add_u32 v22, v23, 2, v22
  v_add_u32 v23, 0, v22
  v_cmp_le_i32 s[16:17], v23, v20
  v_add_u32 v23, 1, v22
  v_cmp_le_i32 s[18:19], v23, v20
  v_add_u32 v23, 2, v22
  v_cmp_le_i32 s[20:21], v23, v20
  v_add_u32 v23, 3, v22
  v_cmp_le_i32 s[22:23], v23, v20
  v_add_u32 v23, 8, v22
  v_cmp_le_i32 s[24:25], v23, v20
  v_add_u32 v23, 9, v22
  v_cmp_le_i32 s[26:27], v23, v20
  v_add_u32 v23, 10, v22
  v_cmp_le_i32 s[28:29], v23, v20
  v_add_u32 v23, 11, v22
  v_cmp_le_i32 s[30:31], v23, v20
  v_add_u32 v23, -16, v22
  v_cmp_le_i32 s[32:33], v23, v20
  v_add_u32 v23, -15, v22
  v_cmp_le_i32 s[34:35], v23, v20
  v_add_u32 v23, -14, v22
  v_cmp_le_i32 s[36:37], v23, v20
  v_add_u32 v23, -13, v22
  v_cmp_le_i32 s[38:39], v23, v20
  v_add_u32 v23, -8, v22
  v_cmp_le_i32 s[40:41], v23, v20
  v_add_u32 v23, -7, v22
  v_cmp_le_i32 s[42:43], v23, v20
  v_add_u32 v23, -6, v22
  v_cmp_le_i32 s[44:45], v23, v20
  v_add_u32 v23, -5, v22
  v_cmp_le_i32 s[46:47], v23, v20
  v_mov_b32 v7, 0xff800000
  v_mov_b32 v8, 0x3f803f80
  v_mov_b32 v9, 0x3f803f80
  v_mov_b32 v10, 0x3f803f80
  v_mov_b32 v11, 0x3f803f80
  v_mov_b32 v173, 0
  v_mov_b32 v174, 0
  v_mov_b32 v177, 0
  v_mov_b32 v178, 0
  s_mov_b32 s56, 0x3e0293ee
  s_lshr_b32 s67, s14, 1
  s_and_b32 s15, s14, 1
  s_lshl_b32 s68, s67, 6
  s_add_u32 s68, s68, s15
  s_lshl_b32 s68, s68, 5
  s_add_u32 s68, s68, s13
  s_mul_i32 s48, s68, 24576
  s_add_u32 s48, s48, 67108864
  s_lshl_b32 s69, s68, 5
  s_add_u32 s55, s69, 851968
  s_lshl_b32 s69, s15, 5
  s_add_u32 s69, s69, s13
  s_lshl_b32 s53, s69, 13
  s_add_u32 s53, s53, 33554432
  s_lshl_b32 s67, s67, 5
  s_add_u32 s67, s67, s13
  s_lshl_b32 s57, s67, 15
  s_add_u32 s57, s57, 50331648
  s_lshl_b32 s67, s67, 6
  s_add_u32 s67, s67, s15
  s_lshl_b32 s50, s67, 4
  s_add_u32 s50, s50, 65536
  s_mov_b32 s58, 2139193217
  v_mov_b32 v252, s58
  v_mov_b32 v253, s58
  v_mov_b32 v254, s58
  v_mov_b32 v255, s58
  s_lshl_b32 s68, s15, 12
  s_add_u32 s52, s57, s68
  buffer_store_dwordx4 v[252:255], v1, s[4:7], s52 offen offset:0 sc1
  buffer_store_dwordx4 v[252:255], v1, s[4:7], s52 offen offset:1024 sc1
  buffer_store_dwordx4 v[252:255], v1, s[4:7], s52 offen offset:2048 sc1
  buffer_store_dwordx4 v[252:255], v1, s[4:7], s52 offen offset:3072 sc1
  s_add_u32 s52, s52, 8192
  buffer_store_dwordx4 v[252:255], v1, s[4:7], s52 offen offset:0 sc1
  buffer_store_dwordx4 v[252:255], v1, s[4:7], s52 offen offset:1024 sc1
  buffer_store_dwordx4 v[252:255], v1, s[4:7], s52 offen offset:2048 sc1
  buffer_store_dwordx4 v[252:255], v1, s[4:7], s52 offen offset:3072 sc1
  s_add_u32 s52, s52, 8192
  buffer_store_dwordx4 v[252:255], v1, s[4:7], s52 offen offset:0 sc1
  buffer_store_dwordx4 v[252:255], v1, s[4:7], s52 offen offset:1024 sc1
  buffer_store_dwordx4 v[252:255], v1, s[4:7], s52 offen offset:2048 sc1
  buffer_store_dwordx4 v[252:255], v1, s[4:7], s52 offen offset:3072 sc1
  s_add_u32 s52, s52, 8192
  buffer_store_dwordx4 v[252:255], v1, s[4:7], s52 offen offset:0 sc1
  buffer_store_dwordx4 v[252:255], v1, s[4:7], s52 offen offset:1024 sc1
  buffer_store_dwordx4 v[252:255], v1, s[4:7], s52 offen offset:2048 sc1
  buffer_store_dwordx4 v[252:255], v1, s[4:7], s52 offen offset:3072 sc1
  s_add_u32 s52, s52, 8192
  s_waitcnt vmcnt(0)
  s_barrier
  s_cmp_lg_u32 s14, 0
  s_cbranch_scc1 L_arr_11
  s_and_b32 s67, s3, 1
  s_lshl_b32 s67, s67, 7
  s_lshr_b32 s68, s3, 1
  s_lshl_b32 s68, s68, 2
  s_add_u32 s67, s67, s68
  s_add_u32 s67, s67, s2
  s_mul_i32 s68, s64, s64
  s_lshl_b32 s68, s68, 8
  s_add_u32 s68, s68, s64
  s_lshl_b32 s68, s68, 8
  s_add_u32 s68, s68, 1
  s_mov_b64 exec, 1
  v_mov_b32 v98, s67
  v_mov_b32 v99, s68
  global_atomic_add v98, v99, s[62:63] sc1
  s_mov_b64 exec, -1
L_arr_11:
  v_mbcnt_lo_u32_b32 v102, -1, 0
  v_and_b32 v100, 1, v102
  v_lshlrev_b32 v100, 7, v100
  v_bfe_u32 v102, v102, 1, 2
  v_lshl_add_u32 v100, v102, 2, v100
  v_add_u32 v100, s2, v100
L_go_12:
  s_sub_u32 s66, s66, 1
  s_cbranch_scc1 L_abort
  global_load_dword v101, v100, s[62:63] sc1
  s_waitcnt vmcnt(0)
  v_and_b32 v102, 0xff, v101
  v_cmp_eq_u32 vcc, 32, v102
  v_bfe_u32 v102, v101, 8, 8
  v_lshrrev_b32 v103, 16, v101
  s_and_b32 s67, vcc_lo, 0xff
  s_cmp_eq_u32 s67, 0xff
  s_cbranch_scc1 L_go_12_ok
  v_and_b32 v102, 0xff, v101
  v_cmp_lt_u32 vcc, 32, v102
  s_cbranch_vccnz L_abort
  s_sleep 8
  s_branch L_go_12
L_go_12_ok:
  v_mul_u32_u24 v102, v102, v102
  v_lshlrev_b32 v103, 5, v103
  v_cmp_eq_u32 vcc, v102, v103
  s_nop 3
  s_and_b32 s67, vcc_lo, 0xff
  s_cmp_lg_u32 s67, 0xff
  s_cbranch_scc1 L_regroup
  .p2align 3
L_s2_top:
L_s2_pq:
  s_sub_u32 s66, s66, 1
  s_cbranch_scc1 L_abort
  buffer_load_dword v2, v12, s[4:7], s50 offen sc1
  s_waitcnt vmcnt(0)
  v_cmp_ne_u32 vcc, 0, v2
  s_nop 0
  s_cmp_eq_u64 vcc, exec
  s_cbranch_scc0 L_s2_pq
  s_add_u32 s49, s48, 0
  buffer_load_dwordx4 v[16:19], v1, s[4:7], s49 offen offset:0 sc1
  buffer_load_dwordx4 v[24:27], v1, s[4:7], s49 offen offset:1024 sc1
  buffer_load_dwordx4 v[32:35], v1, s[4:7], s49 offen offset:2048 sc1
  buffer_load_dwordx4 v[40:43], v1, s[4:7], s49 offen offset:3072 sc1
  s_add_u32 s49, s48, 4096
  buffer_load_dwordx4 v[20:23], v1, s[4:7], s49 offen offset:0 sc1
  buffer_load_dwordx4 v[28:31], v1, s[4:7], s49 offen offset:1024 sc1
  buffer_load_dwordx4 v[36:39], v1, s[4:7], s49 offen offset:2048 sc1
  buffer_load_dwordx4 v[44:47], v1, s[4:7], s49 offen offset:3072 sc1
  s_add_u32 s49, s48, 16384
  buffer_load_dwordx4 v[48:51], v1, s[4:7], s49 offen offset:0 sc1
  buffer_load_dwordx4 v[52:55], v1, s[4:7], s49 offen offset:1024 sc1
  buffer_load_dwordx4 v[56:59], v1, s[4:7], s49 offen offset:2048 sc1
  buffer_load_dwordx4 v[60:63], v1, s[4:7], s49 offen offset:3072 sc1
  s_add_u32 s49, s48, 20480
  buffer_load_dwordx4 v[64:67], v1, s[4:7], s49 offen offset:0 sc1
  buffer_load_dwordx4 v[68:71], v1, s[4:7], s49 offen offset:1024 sc1
  buffer_load_dwordx4 v[72:75], v1, s[4:7], s49 offen offset:2048 sc1
  buffer_load_dwordx4 v[76:79], v1, s[4:7], s49 offen offset:3072 sc1
  s_add_u32 s49, s48, 8192
  buffer_load_dwordx4 v[80:83], v5, s[4:7], s49 offen offset:0 sc1
  buffer_load_dwordx4 v[84:87], v5, s[4:7], s49 offen offset:16 sc1
  buffer_load_dwordx4 v[88:91], v5, s[4:7], s49 offen offset:2048 sc1
  buffer_load_dwordx4 v[92:95], v5, s[4:7], s49 offen offset:2064 sc1
  s_add_u32 s49, s48, 12288
  buffer_load_dwordx4 v[96:99], v5, s[4:7], s49 offen offset:0 sc1
  buffer_load_dwordx4 v[100:103], v5, s[4:7], s49 offen offset:16 sc1
  buffer_load_dwordx4 v[104:107], v5, s[4:7], s49 offen offset:2048 sc1
  buffer_load_dwordx4 v[108:111], v5, s[4:7], s49 offen offset:2064 sc1
  s_waitcnt vmcnt(15)
  v_mfma_f32_16x16x32_bf16 v[136:139], v[16:19], v[48:51], 0
  v_mfma_f32_16x16x32_bf16 v[140:143], v[20:23], v[48:51], 0
  s_waitcnt vmcnt(11)
  v_mfma_f32_16x16x32_bf16 v[144:147], v[16:19], v[64:67], 0
  v_mfma_f32_16x16x32_bf16 v[148:151], v[20:23], v[64:67], 0
  v_mfma_f32_16x16x32_bf16 v[136:139], v[24:27], v[52:55], v[136:139]
  v_mfma_f32_16x16x32_bf16 v[140:143], v[28:31], v[52:55], v[140:143]
  s_waitcnt vmcnt(10)
  v_mfma_f32_16x16x32_bf16 v[144:147], v[24:27], v[68:71], v[144:147]
  v_mfma_f32_16x16x32_bf16 v[148:151], v[28:31], v[68:71], v[148:151]
  v_mfma_f32_16x16x32_bf16 v[136:139], v[32:35], v[56:59], v[136:139]
  v_mfma_f32_16x16x32_bf16 v[140:143], v[36:39], v[56:59], v[140:143]
  s_waitcnt vmcnt(9)
  v_mfma_f32_16x16x32_bf16 v[144:147], v[32:35], v[72:75], v[144:147]
  v_mfma_f32_16x16x32_bf16 v[148:151], v[36:39], v[72:75], v[148:151]
  v_mfma_f32_16x16x32_bf16 v[136:139], v[40:43], v[60:63], v[136:139]
  v_mfma_f32_16x16x32_bf16 v[140:143], v[44:47], v[60:63], v[140:143]
  s_waitcnt vmcnt(8)
  v_mfma_f32_16x16x32_bf16 v[144:147], v[40:43], v[76:79], v[144:147]
  v_mfma_f32_16x16x32_bf16 v[148:151], v[44:47], v[76:79], v[148:151]
  s_nop 3
  v_cndmask_b32 v136, v7, v136, s[16:17]
  v_cndmask_b32 v137, v7, v137, s[18:19]
  v_cndmask_b32 v138, v7, v138, s[20:21]
  v_cndmask_b32 v139, v7, v139, s[22:23]
  v_cndmask_b32 v140, v7, v140, s[24:25]
  v_cndmask_b32 v141, v7, v141, s[26:27]
  v_cndmask_b32 v142, v7, v142, s[28:29]
  v_cndmask_b32 v143, v7, v143, s[30:31]
  v_max3_f32 v160, v136, v137, v138
  v_max3_f32 v160, v160, v139, v140
  v_max3_f32 v160, v160, v141, v142
  v_max_f32_e64 v160, v160, v143
  v_cndmask_b32 v144, v7, v144, s[32:33]
  v_cndmask_b32 v145, v7, v145, s[34:35]
  v_cndmask_b32 v146, v7, v146, s[36:37]
  v_cndmask_b32 v147, v7, v147, s[38:39]
  v_cndmask_b32 v148, v7, v148, s[40:41]
  v_cndmask_b32 v149, v7, v149, s[42:43]
  v_cndmask_b32 v150, v7, v150, s[44:45]
  v_cndmask_b32 v151, v7, v151, s[46:47]
  v_max3_f32 v162, v144, v145, v146
  v_max3_f32 v162, v162, v147, v148
  v_max3_f32 v162, v162, v149, v150
  v_max_f32 v162, v162, v151
  s_and_b32 s68, s15, 7
  s_lshl_b32 s68, s68, 12
  s_add_u32 s52, s57, s68
L_s2_pm:
  s_sub_u32 s66, s66, 1
  s_cbranch_scc1 L_abort
  buffer_load_dwordx4 v[124:127], v3, s[4:7], s52 offen offset:3072 sc1
  s_waitcnt vmcnt(0)
  v_max3_i32 v2, v124, v125, v126
  v_max_i32 v2, v2, v127
  v_cmp_eq_u32 vcc, s58, v2
  s_cbranch_vccnz L_s2_pm
L_s2_pk:
  s_sub_u32 s66, s66, 1
  s_cbranch_scc1 L_abort
  buffer_load_dwordx4 v[112:115], v3, s[4:7], s52 offen offset:0 sc1
  buffer_load_dwordx4 v[116:119], v3, s[4:7], s52 offen offset:1024 sc1
  buffer_load_dwordx4 v[120:123], v3, s[4:7], s52 offen offset:2048 sc1
  buffer_load_dwordx2 v[128:129], v4, s[4:7], s52 offen offset:512 sc1
  buffer_load_dwordx2 v[130:131], v4, s[4:7], s52 offen offset:1536 sc1
  buffer_load_dwordx2 v[132:133], v4, s[4:7], s52 offen offset:2560 sc1
  buffer_load_dwordx2 v[134:135], v4, s[4:7], s52 offen offset:3584 sc1
  s_waitcnt vmcnt(4)
  v_mfma_f32_16x16x32_bf16 v[152:155], v[124:127], v[60:63], 0
  v_max3_i32 v2, v112, v113, v114
  v_mfma_f32_16x16x32_bf16 v[156:159], v[124:127], v[76:79], 0
  v_max3_i32 v2, v2, v115, v116
  v_mfma_f32_16x16x32_bf16 v[152:155], v[112:115], v[48:51], v[152:155]
  v_max3_i32 v2, v2, v117, v118
  v_mfma_f32_16x16x32_bf16 v[156:159], v[112:115], v[64:67], v[156:159]
  v_max3_i32 v2, v2, v119, v120
  v_mfma_f32_16x16x32_bf16 v[152:155], v[116:119], v[52:55], v[152:155]
  v_max3_i32 v2, v2, v121, v122
  v_mfma_f32_16x16x32_bf16 v[156:159], v[116:119], v[68:71], v[156:159]
  v_max_i32 v2, v2, v123
  v_mfma_f32_16x16x32_bf16 v[152:155], v[120:123], v[56:59], v[152:155]
  v_cmp_eq_u32_e64 vcc, s58, v2
  v_mfma_f32_16x16x32_bf16 v[156:159], v[120:123], v[72:75], v[156:159]
  s_cbranch_vccnz L_s2_pk
  s_nop 4
  v_max3_f32 v160, v160, v152, v153
  s_nop 0
  v_max3_f32 v162, v162, v156, v157
  v_mov_b32_e64 v161, v160
  v_mov_b32 v163, v162
  s_nop 0
  v_permlane32_swap_b32 v160, v161
  v_permlane32_swap_b32 v162, v163
  v_max_f32 v160, v160, v161
  v_max_f32 v162, v162, v163
  v_mov_b32 v161, v160
  v_mov_b32 v163, v162
  s_nop 0
  v_permlane16_swap_b32 v160, v161
  v_permlane16_swap_b32 v162, v163
  v_max_f32 v160, v160, v161
  v_max_f32 v162, v162, v163
  v_mul_f32 v161, s56, v160
  v_mul_f32 v163, s56, v162
  s_add_u32 s54, s53, 4096
  v_fma_f32 v136, v136, s56, -v161
  v_fma_f32 v137, v137, s56, -v161
  v_fma_f32 v138, v138, s56, -v161
  v_fma_f32 v139, v139, s56, -v161
  v_fma_f32 v140, v140, s56, -v161
  v_fma_f32 v141, v141, s56, -v161
  v_fma_f32 v142, v142, s56, -v161
  v_fma_f32 v143, v143, s56, -v161
  v_fma_f32 v152, v152, s56, -v161
  v_fma_f32 v153, v153, s56, -v161
  v_exp_f32 v136, v136
  v_exp_f32 v137, v137
  v_exp_f32 v138, v138
  v_exp_f32 v139, v139
  v_exp_f32 v140, v140
  v_exp_f32 v141, v141
  v_exp_f32 v142, v142
  v_exp_f32 v143, v143
  v_exp_f32 v152, v152
  v_exp_f32 v153, v153
  v_cvt_pk_bf16_f32 v164, v136, v137
  v_cvt_pk_bf16_f32 v165, v138, v139
  v_cvt_pk_bf16_f32 v166, v140, v141
  v_cvt_pk_bf16_f32 v167, v142, v143
  v_cvt_pk_bf16_f32 v172, v152, v153
  v_cvt_pk_bf16_f32 v175, v152, v153
  s_waitcnt vmcnt(0)
L_s2_pv:
  v_max3_i32 v2, v128, v129, v130
  v_max3_i32 v2, v2, v131, v132
  v_max3_i32 v2, v2, v133, v134
  v_max_i32 v2, v2, v135
  v_cmp_eq_u32 vcc, s58, v2
  s_cbranch_vccnz L_s2_rv
  buffer_store_dwordx4 v[252:255], v1, s[4:7], s52 offen offset:0 sc1
  buffer_store_dwordx4 v[252:255], v1, s[4:7], s52 offen offset:1024 sc1
  buffer_store_dwordx4 v[252:255], v1, s[4:7], s52 offen offset:2048 sc1
  buffer_store_dwordx4 v[252:255], v1, s[4:7], s52 offen offset:3072 sc1
  v_mfma_f32_16x16x32_bf16 v[244:247], v[8:11], v[164:167], 0
  v_fma_f32 v144, v144, s56, -v163
  v_fma_f32 v145, v145, s56, -v163
  v_mfma_f32_16x16x32_bf16 v[180:183], v[80:83], v[164:167], 0
  v_fma_f32 v146, v146, s56, -v163
  v_fma_f32 v147, v147, s56, -v163
  v_mfma_f32_16x16x32_bf16 v[184:187], v[84:87], v[164:167], 0
  v_fma_f32 v148, v148, s56, -v163
  v_fma_f32 v149, v149, s56, -v163
  v_mfma_f32_16x16x32_bf16 v[188:191], v[88:91], v[164:167], 0
  v_fma_f32 v150, v150, s56, -v163
  v_fma_f32 v151, v151, s56, -v163
  v_mfma_f32_16x16x32_bf16 v[192:195], v[92:95], v[164:167], 0
  v_fma_f32 v156, v156, s56, -v163
  v_fma_f32 v157, v157, s56, -v163
  v_mfma_f32_16x16x32_bf16 v[196:199], v[96:99], v[164:167], 0
  v_exp_f32 v144, v144
  v_exp_f32 v145, v145
  v_mfma_f32_16x16x32_bf16 v[200:203], v[100:103], v[164:167], 0
  v_exp_f32 v146, v146
  v_exp_f32 v147, v147
  v_mfma_f32_16x16x32_bf16 v[204:207], v[104:107], v[164:167], 0
  v_exp_f32 v148, v148
  v_exp_f32 v149, v149
  v_mfma_f32_16x16x32_bf16 v[208:211], v[108:111], v[164:167], 0
  v_exp_f32 v150, v150
  v_exp_f32 v151, v151
  v_mfma_f32_16x16x16_bf16 v[244:247], v[8:9], v[172:173], v[244:247]
  v_exp_f32 v156, v156
  v_exp_f32 v157, v157
  v_mfma_f32_16x16x16_bf16 v[180:183], v[128:129], v[172:173], v[180:183]
  v_cvt_pk_bf16_f32 v168, v144, v145
  v_cvt_pk_bf16_f32 v169, v146, v147
  v_mfma_f32_16x16x16_bf16 v[184:187], v[128:129], v[174:175], v[184:187]
  v_cvt_pk_bf16_f32 v170, v148, v149
  v_cvt_pk_bf16_f32 v171, v150, v151
  v_mfma_f32_16x16x16_bf16 v[188:191], v[130:131], v[172:173], v[188:191]
  v_cvt_pk_bf16_f32 v176, v156, v157
  v_cvt_pk_bf16_f32 v179, v156, v157
  v_mfma_f32_16x16x16_bf16 v[192:195], v[130:131], v[174:175], v[192:195]
  v_mfma_f32_16x16x16_bf16 v[196:199], v[132:133], v[172:173], v[196:199]
  v_mfma_f32_16x16x16_bf16 v[200:203], v[132:133], v[174:175], v[200:203]
  v_mfma_f32_16x16x16_bf16 v[204:207], v[134:135], v[172:173], v[204:207]
  v_mfma_f32_16x16x16_bf16 v[208:211], v[134:135], v[174:175], v[208:211]
  v_mfma_f32_16x16x32_bf16 v[248:251], v[8:11], v[168:171], 0
  v_rcp_f32_e64 v244, v244
  s_nop 0
  v_mul_f32 v180, v180, v244
  v_mfma_f32_16x16x32_bf16 v[212:215], v[80:83], v[168:171], 0
  v_mul_f32 v181, v181, v244
  v_mul_f32 v182, v182, v244
  v_mfma_f32_16x16x32_bf16 v[216:219], v[84:87], v[168:171], 0
  v_mul_f32 v183, v183, v244
  v_mul_f32 v184, v184, v244
  v_mfma_f32_16x16x32_bf16 v[220:223], v[88:91], v[168:171], 0
  v_mul_f32 v185, v185, v244
  v_mul_f32 v186, v186, v244
  v_mfma_f32_16x16x32_bf16 v[224:227], v[92:95], v[168:171], 0
  v_mul_f32_e64 v187, v187, v244
  v_cvt_pk_bf16_f32 v16, v180, v184
  v_mfma_f32_16x16x32_bf16 v[228:231], v[96:99], v[168:171], 0
  v_cvt_pk_bf16_f32 v17, v181, v185
  v_cvt_pk_bf16_f32 v18, v182, v186
  v_mfma_f32_16x16x32_bf16 v[232:235], v[100:103], v[168:171], 0
  v_cvt_pk_bf16_f32 v19, v183, v187
  buffer_store_dwordx4 v[16:19], v6, s[4:7], s53 offen offset:0 sc1
  v_mfma_f32_16x16x32_bf16 v[236:239], v[104:107], v[168:171], 0
  v_mul_f32 v188, v188, v244
  v_mul_f32 v189, v189, v244
  v_mfma_f32_16x16x32_bf16 v[240:243], v[108:111], v[168:171], 0
  v_mul_f32 v190, v190, v244
  v_mul_f32 v191, v191, v244
  v_mfma_f32_16x16x16_bf16 v[248:251], v[8:9], v[176:177], v[248:251]
  v_mul_f32 v192, v192, v244
  v_mul_f32 v193, v193, v244
  v_mfma_f32_16x16x16_bf16 v[212:215], v[128:129], v[176:177], v[212:215]
  v_mul_f32 v194, v194, v244
  v_mul_f32 v195, v195, v244
  v_mfma_f32_16x16x16_bf16 v[216:219], v[128:129], v[178:179], v[216:219]
  v_cvt_pk_bf16_f32 v20, v188, v192
  v_cvt_pk_bf16_f32 v21, v189, v193
  v_mfma_f32_16x16x16_bf16 v[220:223], v[130:131], v[176:177], v[220:223]
  v_cvt_pk_bf16_f32 v22, v190, v194
  v_cvt_pk_bf16_f32 v23, v191, v195
  v_mfma_f32_16x16x16_bf16 v[224:227], v[130:131], v[178:179], v[224:227]
  buffer_store_dwordx4 v[20:23], v6, s[4:7], s53 offen offset:2048 sc1
  v_mul_f32_e64 v196, v196, v244
  v_mfma_f32_16x16x16_bf16 v[228:231], v[132:133], v[176:177], v[228:231]
  v_mul_f32 v197, v197, v244
  v_mul_f32 v198, v198, v244
  v_mfma_f32_16x16x16_bf16 v[232:235], v[132:133], v[178:179], v[232:235]
  v_mul_f32 v199, v199, v244
  v_mul_f32 v200, v200, v244
  v_mfma_f32_16x16x16_bf16 v[236:239], v[134:135], v[176:177], v[236:239]
  v_mul_f32 v201, v201, v244
  v_mul_f32 v202, v202, v244
  v_mfma_f32_16x16x16_bf16 v[240:243], v[134:135], v[178:179], v[240:243]
  v_mul_f32_e64 v203, v203, v244
  v_cvt_pk_bf16_f32 v24, v196, v200
  v_cvt_pk_bf16_f32 v25, v197, v201
  v_cvt_pk_bf16_f32 v26, v198, v202
  v_cvt_pk_bf16_f32 v27, v199, v203
  buffer_store_dwordx4 v[24:27], v6, s[4:7], s54 offen offset:0 sc1
  v_mul_f32 v204, v204, v244
  v_mul_f32 v205, v205, v244
  v_mul_f32 v206, v206, v244
  v_mul_f32 v207, v207, v244
  v_mul_f32 v208, v208, v244
  v_mul_f32 v209, v209, v244
  v_mul_f32 v210, v210, v244
  v_mul_f32 v211, v211, v244
  v_cvt_pk_bf16_f32 v28, v204, v208
  v_cvt_pk_bf16_f32 v29, v205, v209
  v_cvt_pk_bf16_f32 v30, v206, v210
  v_cvt_pk_bf16_f32 v31, v207, v211
  buffer_store_dwordx4 v[28:31], v6, s[4:7], s54 offen offset:2048 sc1
  v_rcp_f32 v248, v248
  s_nop 0
  v_mul_f32 v212, v212, v248
  v_mul_f32 v213, v213, v248
  v_mul_f32 v214, v214, v248
  v_mul_f32 v215, v215, v248
  v_mul_f32 v216, v216, v248
  v_mul_f32 v217, v217, v248
  v_mul_f32 v218, v218, v248
  v_mul_f32 v219, v219, v248
  v_cvt_pk_bf16_f32 v32, v212, v216
  v_cvt_pk_bf16_f32 v33, v213, v217
  v_cvt_pk_bf16_f32 v34, v214, v218
  v_cvt_pk_bf16_f32 v35, v215, v219
  buffer_store_dwordx4 v[32:35], v6, s[4:7], s53 offen offset:256 sc1
  v_mul_f32 v220, v220, v248
  v_mul_f32 v221, v221, v248
  v_mul_f32 v222, v222, v248
  v_mul_f32 v223, v223, v248
  v_mul_f32 v224, v224, v248
  v_mul_f32 v225, v225, v248
  v_mul_f32 v226, v226, v248
  v_mul_f32 v227, v227, v248
  v_cvt_pk_bf16_f32 v36, v220, v224
  v_cvt_pk_bf16_f32 v37, v221, v225
  v_cvt_pk_bf16_f32 v38, v222, v226
  v_cvt_pk_bf16_f32 v39, v223, v227
  buffer_store_dwordx4 v[36:39], v6, s[4:7], s53 offen offset:2304 sc1
  v_mul_f32 v228, v228, v248
  v_mul_f32 v229, v229, v248
  v_mul_f32 v230, v230, v248
  v_mul_f32 v231, v231, v248
  v_mul_f32 v232, v232, v248
  v_mul_f32 v233, v233, v248
  v_mul_f32 v234, v234, v248
  v_mul_f32 v235, v235, v248
  v_cvt_pk_bf16_f32 v40, v228, v232
  v_cvt_pk_bf16_f32 v41, v229, v233
  v_cvt_pk_bf16_f32 v42, v230, v234
  v_cvt_pk_bf16_f32 v43, v231, v235
  buffer_store_dwordx4 v[40:43], v6, s[4:7], s54 offen offset:256 sc1
  v_mul_f32 v236, v236, v248
  v_mul_f32 v237, v237, v248
  v_mul_f32 v238, v238, v248
  v_mul_f32 v239, v239, v248
  v_mul_f32 v240, v240, v248
  v_mul_f32 v241, v241, v248
  v_mul_f32 v242, v242, v248
  v_mul_f32 v243, v243, v248
  v_cvt_pk_bf16_f32 v44, v236, v240
  v_cvt_pk_bf16_f32 v45, v237, v241
  v_cvt_pk_bf16_f32 v46, v238, v242
  v_cvt_pk_bf16_f32 v47, v239, v243
  buffer_store_dwordx4 v[44:47], v6, s[4:7], s54 offen offset:2304 sc1
  s_waitcnt vmcnt(0)
  s_mov_b64 exec, 1
  buffer_store_dword v8, off, s[4:7], s55 sc1
  s_mov_b64 exec, -1
  s_add_u32 s48, s48, 1572864
  s_add_u32 s55, s55, 2048
  s_add_u32 s53, s53, 524288
  s_add_u32 s50, s50, 32
  s_add_u32 s15, s15, 2
  s_cmp_lt_u32 s15, 64
  s_cbranch_scc1 L_s2_top
  s_branch L_end
L_s2_rv:
  s_sub_u32 s66, s66, 1
  s_cbranch_scc1 L_abort
  buffer_load_dwordx2 v[128:129], v4, s[4:7], s52 offen offset:512 sc1
  buffer_load_dwordx2 v[130:131], v4, s[4:7], s52 offen offset:1536 sc1
  buffer_load_dwordx2 v[132:133], v4, s[4:7], s52 offen offset:2560 sc1
  buffer_load_dwordx2 v[134:135], v4, s[4:7], s52 offen offset:3584 sc1
  s_waitcnt vmcnt(0)
  s_branch L_s2_pv
L_red:
  s_load_dwordx2 s[28:29], s[0:1], 0
  s_mov_b32 s30, 2097152
  s_mov_b32 s31, 0x20000
  s_load_dwordx2 s[32:33], s[0:1], 88
  s_mov_b32 s34, 2097152
  s_mov_b32 s35, 0x20000
  v_lshlrev_b32 v1, 4, v0
  v_lshlrev_b32 v2, 3, v0
  v_lshlrev_b32 v3, 2, v0
  v_lshlrev_b32 v4, 5, v0
  v_mov_b32 v7, 1
  s_and_b32 s67, s13, 3
  s_lshl_b32 s67, s67, 2
  s_add_u32 s67, s67, s14
  s_lshl_b32 s17, s67, 1
  s_mov_b32 s25, 0x3727c5ac
  s_mov_b32 s26, 0x3b000000
  s_mov_b32 s15, 0
  s_lshr_b32 s67, s13, 2
  s_lshl_b32 s67, s67, 5
  s_add_u32 s67, s67, s17
  s_lshl_b32 s19, s67, 10
  s_add_u32 s21, s19, 2097152
  s_lshl_b32 s67, s67, 5
  s_add_u32 s22, s67, 131072
  s_waitcnt lgkmcnt(0)
  s_cmp_lg_u32 s12, 0
  s_cbranch_scc1 L_red_go
  buffer_load_dwordx4 v[128:131], v1, s[28:31], s19 offen offset:0
  buffer_load_dwordx4 v[132:135], v1, s[28:31], s19 offen offset:1024
  s_add_u32 s19, s19, 65536
  buffer_load_dwordx4 v[136:139], v1, s[28:31], s19 offen offset:0
  buffer_load_dwordx4 v[140:143], v1, s[28:31], s19 offen offset:1024
  s_add_u32 s19, s19, 65536
  buffer_load_dwordx4 v[144:147], v1, s[28:31], s19 offen offset:0
  buffer_load_dwordx4 v[148:151], v1, s[28:31], s19 offen offset:1024
  s_add_u32 s19, s19, 65536
  buffer_load_dwordx4 v[152:155], v1, s[28:31], s19 offen offset:0
  buffer_load_dwordx4 v[156:159], v1, s[28:31], s19 offen offset:1024
  s_add_u32 s19, s19, 65536
  buffer_load_dwordx4 v[160:163], v1, s[28:31], s19 offen offset:0
  buffer_load_dwordx4 v[164:167], v1, s[28:31], s19 offen offset:1024
  s_add_u32 s19, s19, 65536
  buffer_load_dwordx4 v[168:171], v1, s[28:31], s19 offen offset:0
  buffer_load_dwordx4 v[172:175], v1, s[28:31], s19 offen offset:1024
  s_add_u32 s19, s19, 65536
  buffer_load_dwordx4 v[176:179], v1, s[28:31], s19 offen offset:0
  buffer_load_dwordx4 v[180:183], v1, s[28:31], s19 offen offset:1024
  s_add_u32 s19, s19, 65536
  buffer_load_dwordx4 v[184:187], v1, s[28:31], s19 offen offset:0
  buffer_load_dwordx4 v[188:191], v1, s[28:31], s19 offen offset:1024
  s_add_u32 s19, s19, 65536
  buffer_load_dwordx4 v[192:195], v1, s[28:31], s19 offen offset:0
  buffer_load_dwordx4 v[196:199], v1, s[28:31], s19 offen offset:1024
  s_add_u32 s19, s19, 65536
  buffer_load_dwordx4 v[200:203], v1, s[28:31], s19 offen offset:0
  buffer_load_dwordx4 v[204:207], v1, s[28:31], s19 offen offset:1024
  s_add_u32 s19, s19, 65536
  buffer_load_dwordx4 v[208:211], v1, s[28:31], s19 offen offset:0
  buffer_load_dwordx4 v[212:215], v1, s[28:31], s19 offen offset:1024
  s_add_u32 s19, s19, 65536
  buffer_load_dwordx4 v[216:219], v1, s[28:31], s19 offen offset:0
  buffer_load_dwordx4 v[220:223], v1, s[28:31], s19 offen offset:1024
  s_add_u32 s19, s19, 65536
  buffer_load_dwordx4 v[224:227], v1, s[28:31], s19 offen offset:0
  buffer_load_dwordx4 v[228:231], v1, s[28:31], s19 offen offset:1024
  s_add_u32 s19, s19, 65536
  buffer_load_dwordx4 v[232:235], v1, s[28:31], s19 offen offset:0
  buffer_load_dwordx4 v[236:239], v1, s[28:31], s19 offen offset:1024
  s_add_u32 s19, s19, 65536
  buffer_load_dwordx4 v[240:243], v1, s[28:31], s19 offen offset:0
  buffer_load_dwordx4 v[244:247], v1, s[28:31], s19 offen offset:1024
  s_add_u32 s19, s19, 65536
  buffer_load_dwordx4 v[248:251], v1, s[28:31], s19 offen offset:0
  buffer_load_dwordx4 v[252:255], v1, s[28:31], s19 offen offset:1024
  s_add_u32 s19, s19, 65536
  s_waitcnt vmcnt(0)
L_red_go:
  v_mbcnt_lo_u32_b32 v102, -1, 0
  v_and_b32 v100, 1, v102
  v_lshlrev_b32 v100, 7, v100
  v_bfe_u32 v102, v102, 1, 2
  v_lshl_add_u32 v100, v102, 2, v100
  v_add_u32 v100, s2, v100
L_go_13:
  s_sub_u32 s66, s66, 1
  s_cbranch_scc1 L_abort
  global_load_dword v101, v100, s[62:63] sc1
  s_waitcnt vmcnt(0)
  v_and_b32 v102, 0xff, v101
  v_cmp_eq_u32 vcc, 32, v102
  v_bfe_u32 v102, v101, 8, 8
  v_lshrrev_b32 v103, 16, v101
  s_and_b32 s67, vcc_lo, 0xff
  s_cmp_eq_u32 s67, 0xff
  s_cbranch_scc1 L_go_13_ok
  v_and_b32 v102, 0xff, v101
  v_cmp_lt_u32 vcc, 32, v102
  s_cbranch_vccnz L_abort
  s_sleep 8
  s_branch L_go_13
L_go_13_ok:
  v_mul_u32_u24 v102, v102, v102
  v_lshlrev_b32 v103, 5, v103
  v_cmp_eq_u32 vcc, v102, v103
  s_nop 3
  s_and_b32 s67, vcc_lo, 0xff
  s_cmp_lg_u32 s67, 0xff
  s_cbranch_scc1 L_regroup
  s_cmp_lg_u32 s12, 0
  s_cbranch_scc1 L_red_main
L_red_ln0:
  v_lshlrev_b32 v8, 16, v128
  v_lshlrev_b32 v32, 16, v132
  v_and_b32 v9, 0xffff0000, v128
  v_and_b32 v33, 0xffff0000, v132
  v_lshlrev_b32 v10, 16, v129
  v_lshlrev_b32 v34, 16, v133
  v_and_b32 v11, 0xffff0000, v129
  v_and_b32 v35, 0xffff0000, v133
  v_lshlrev_b32 v12, 16, v130
  v_lshlrev_b32 v36, 16, v134
  v_and_b32 v13, 0xffff0000, v130
  v_and_b32 v37, 0xffff0000, v134
  v_lshlrev_b32 v14, 16, v131
  v_lshlrev_b32 v38, 16, v135
  v_and_b32 v15, 0xffff0000, v131
  v_and_b32 v39, 0xffff0000, v135
  v_pk_add_f32 v[18:19], v[8:9], v[10:11]
  v_pk_add_f32 v[42:43], v[32:33], v[34:35]
  v_pk_add_f32 v[20:21], v[12:13], v[14:15]
  v_pk_add_f32 v[44:45], v[36:37], v[38:39]
  v_pk_add_f32 v[18:19], v[18:19], v[20:21]
  v_pk_add_f32 v[42:43], v[42:43], v[44:45]
  v_add_f32 v16, v18, v19
  v_add_f32 v40, v42, v43
  s_nop 0
  v_add_f32_dpp v16, v16, v16 row_ror:1 row_mask:0xf bank_mask:0xf
  v_add_f32_dpp v40, v40, v40 row_ror:1 row_mask:0xf bank_mask:0xf
  s_nop 0
  v_add_f32_dpp v16, v16, v16 row_ror:2 row_mask:0xf bank_mask:0xf
  v_add_f32_dpp v40, v40, v40 row_ror:2 row_mask:0xf bank_mask:0xf
  s_nop 0
  v_add_f32_dpp v16, v16, v16 row_ror:4 row_mask:0xf bank_mask:0xf
  v_add_f32_dpp v40, v40, v40 row_ror:4 row_mask:0xf bank_mask:0xf
  s_nop 0
  v_add_f32_dpp v16, v16, v16 row_ror:8 row_mask:0xf bank_mask:0xf
  v_add_f32_dpp v40, v40, v40 row_ror:8 row_mask:0xf bank_mask:0xf
  v_mov_b32 v18, v16
  v_mov_b32 v42, v40
  s_nop 0
  v_permlane16_swap_b32 v16, v18
  v_permlane16_swap_b32 v40, v42
  v_add_f32 v16, v16, v18
  v_add_f32 v40, v40, v42
  v_mov_b32 v18, v16
  v_mov_b32 v42, v40
  s_nop 0
  v_permlane32_swap_b32 v16, v18
  v_permlane32_swap_b32 v40, v42
  v_add_f32 v16, v16, v18
  v_add_f32 v40, v40, v42
  v_mul_f32 v16, s26, v16
  v_mul_f32 v40, s26, v40
  v_pk_add_f32 v[64:65], v[8:9], v[16:17] op_sel_hi:[1,0] neg_lo:[0,1] neg_hi:[0,1]
  v_pk_add_f32 v[96:97], v[32:33], v[40:41] op_sel_hi:[1,0] neg_lo:[0,1] neg_hi:[0,1]
  v_pk_add_f32 v[66:67], v[10:11], v[16:17] op_sel_hi:[1,0] neg_lo:[0,1] neg_hi:[0,1]
  v_pk_add_f32 v[98:99], v[34:35], v[40:41] op_sel_hi:[1,0] neg_lo:[0,1] neg_hi:[0,1]
  v_pk_add_f32 v[68:69], v[12:13], v[16:17] op_sel_hi:[1,0] neg_lo:[0,1] neg_hi:[0,1]
  v_pk_add_f32 v[100:101], v[36:37], v[40:41] op_sel_hi:[1,0] neg_lo:[0,1] neg_hi:[0,1]
  v_pk_add_f32 v[70:71], v[14:15], v[16:17] op_sel_hi:[1,0] neg_lo:[0,1] neg_hi:[0,1]
  v_pk_add_f32 v[102:103], v[38:39], v[40:41] op_sel_hi:[1,0] neg_lo:[0,1] neg_hi:[0,1]
  v_pk_mul_f32 v[18:19], v[64:65], v[64:65]
  v_pk_mul_f32 v[42:43], v[96:97], v[96:97]
  v_pk_fma_f32 v[18:19], v[66:67], v[66:67], v[18:19]
  v_pk_fma_f32 v[42:43], v[98:99], v[98:99], v[42:43]
  v_pk_fma_f32 v[18:19], v[68:69], v[68:69], v[18:19]
  v_pk_fma_f32 v[42:43], v[100:101], v[100:101], v[42:43]
  v_pk_fma_f32 v[18:19], v[70:71], v[70:71], v[18:19]
  v_pk_fma_f32 v[42:43], v[102:103], v[102:103], v[42:43]
  v_add_f32 v17, v18, v19
  v_add_f32 v41, v42, v43
  v_cvt_pk_bf16_f32 v16, v16, v16
  v_cvt_pk_bf16_f32 v40, v40, v40
  v_lshlrev_b32 v16, 16, v16
  v_lshlrev_b32 v40, 16, v40
  v_add_f32_dpp v17, v17, v17 row_ror:1 row_mask:0xf bank_mask:0xf
  v_add_f32_dpp v41, v41, v41 row_ror:1 row_mask:0xf bank_mask:0xf
  s_nop 0
  v_add_f32_dpp v17, v17, v17 row_ror:2 row_mask:0xf bank_mask:0xf
  v_add_f32_dpp v41, v41, v41 row_ror:2 row_mask:0xf bank_mask:0xf
  s_nop 0
  v_add_f32_dpp v17, v17, v17 row_ror:4 row_mask:0xf bank_mask:0xf
  v_add_f32_dpp v41, v41, v41 row_ror:4 row_mask:0xf bank_mask:0xf
  s_nop 0
  v_add_f32_dpp v17, v17, v17 row_ror:8 row_mask:0xf bank_mask:0xf
  v_add_f32_dpp v41, v41, v41 row_ror:8 row_mask:0xf bank_mask:0xf
  v_mov_b32 v18, v17
  v_mov_b32 v42, v41
  s_nop 0
  v_permlane16_swap_b32 v17, v18
  v_permlane16_swap_b32 v41, v42
  v_add_f32 v17, v17, v18
  v_add_f32 v41, v41, v42
  v_mov_b32 v18, v17
  v_mov_b32 v42, v41
  s_nop 0
  v_permlane32_swap_b32 v17, v18
  v_permlane32_swap_b32 v41, v42
  v_add_f32 v17, v17, v18
  v_add_f32 v41, v41, v42
  v_mul_f32 v17, s26, v17
  v_mul_f32 v41, s26, v41
  v_cvt_pk_bf16_f32 v17, v17, v17
  v_cvt_pk_bf16_f32 v41, v41, v41
  v_lshlrev_b32 v17, 16, v17
  v_lshlrev_b32 v41, 16, v41
  v_add_f32 v17, s25, v17
  v_add_f32 v41, s25, v41
  v_cvt_pk_bf16_f32 v17, v17, v17
  v_cvt_pk_bf16_f32 v41, v41, v41
  v_lshlrev_b32 v17, 16, v17
  v_lshlrev_b32 v41, 16, v41
  v_sqrt_f32 v17, v17
  v_sqrt_f32 v41, v41
  v_pk_add_f32 v[8:9], v[8:9], v[16:17] op_sel_hi:[1,0] neg_lo:[0,1] neg_hi:[0,1]
  v_pk_add_f32 v[32:33], v[32:33], v[40:41] op_sel_hi:[1,0] neg_lo:[0,1] neg_hi:[0,1]
  v_pk_add_f32 v[10:11], v[10:11], v[16:17] op_sel_hi:[1,0] neg_lo:[0,1] neg_hi:[0,1]
  v_pk_add_f32 v[34:35], v[34:35], v[40:41] op_sel_hi:[1,0] neg_lo:[0,1] neg_hi:[0,1]
  v_pk_add_f32 v[12:13], v[12:13], v[16:17] op_sel_hi:[1,0] neg_lo:[0,1] neg_hi:[0,1]
  v_pk_add_f32 v[36:37], v[36:37], v[40:41] op_sel_hi:[1,0] neg_lo:[0,1] neg_hi:[0,1]
  v_pk_add_f32 v[14:15], v[14:15], v[16:17] op_sel_hi:[1,0] neg_lo:[0,1] neg_hi:[0,1]
  v_pk_add_f32 v[38:39], v[38:39], v[40:41] op_sel_hi:[1,0] neg_lo:[0,1] neg_hi:[0,1]
  v_cvt_pk_bf16_f32 v17, v17, v17
  v_cvt_pk_bf16_f32 v41, v41, v41
  v_lshlrev_b32 v17, 16, v17
  v_lshlrev_b32 v41, 16, v41
  v_rcp_f32 v18, v17
  v_rcp_f32 v42, v41
  v_cvt_pk_bf16_f32 v20, v8, v9
  v_cvt_pk_bf16_f32 v44, v32, v33
  v_cvt_pk_bf16_f32 v21, v10, v11
  v_cvt_pk_bf16_f32 v45, v34, v35
  v_cvt_pk_bf16_f32 v22, v12, v13
  v_cvt_pk_bf16_f32 v46, v36, v37
  v_cvt_pk_bf16_f32 v23, v14, v15
  v_cvt_pk_bf16_f32 v47, v38, v39
  v_lshlrev_b32 v8, 16, v20
  v_lshlrev_b32 v32, 16, v44
  v_and_b32 v9, 0xffff0000, v20
  v_and_b32 v33, 0xffff0000, v44
  v_lshlrev_b32 v10, 16, v21
  v_lshlrev_b32 v34, 16, v45
  v_and_b32 v11, 0xffff0000, v21
  v_and_b32 v35, 0xffff0000, v45
  v_lshlrev_b32 v12, 16, v22
  v_lshlrev_b32 v36, 16, v46
  v_and_b32 v13, 0xffff0000, v22
  v_and_b32 v37, 0xffff0000, v46
  v_lshlrev_b32 v14, 16, v23
  v_lshlrev_b32 v38, 16, v47
  v_and_b32 v15, 0xffff0000, v23
  v_and_b32 v39, 0xffff0000, v47
  v_pk_mul_f32 v[8:9], v[8:9], v[18:19] op_sel_hi:[1,0]
  v_pk_mul_f32 v[32:33], v[32:33], v[42:43] op_sel_hi:[1,0]
  v_pk_mul_f32 v[10:11], v[10:11], v[18:19] op_sel_hi:[1,0]
  v_pk_mul_f32 v[34:35], v[34:35], v[42:43] op_sel_hi:[1,0]
  v_pk_mul_f32 v[12:13], v[12:13], v[18:19] op_sel_hi:[1,0]
  v_pk_mul_f32 v[36:37], v[36:37], v[42:43] op_sel_hi:[1,0]
  v_pk_mul_f32 v[14:15], v[14:15], v[18:19] op_sel_hi:[1,0]
  v_pk_mul_f32 v[38:39], v[38:39], v[42:43] op_sel_hi:[1,0]
  v_cvt_pk_bf16_f32 v20, v8, v9
  v_cvt_pk_bf16_f32 v44, v32, v33
  v_cvt_pk_bf16_f32 v21, v10, v11
  v_cvt_pk_bf16_f32 v45, v34, v35
  v_cvt_pk_bf16_f32 v22, v12, v13
  v_cvt_pk_bf16_f32 v46, v36, v37
  v_cvt_pk_bf16_f32 v23, v14, v15
  v_cvt_pk_bf16_f32 v47, v38, v39
  buffer_store_dwordx4 v[20:23], v1, s[4:7], s21 offen offset:0 sc1
  buffer_store_dwordx4 v[44:47], v1, s[4:7], s21 offen offset:1024 sc1
  s_add_u32 s21, s21, 65536
  v_lshlrev_b32 v8, 16, v136
  v_lshlrev_b32 v32, 16, v140
  v_and_b32 v9, 0xffff0000, v136
  v_and_b32 v33, 0xffff0000, v140
  v_lshlrev_b32 v10, 16, v137
  v_lshlrev_b32 v34, 16, v141
  v_and_b32 v11, 0xffff0000, v137
  v_and_b32 v35, 0xffff0000, v141
  v_lshlrev_b32 v12, 16, v138
  v_lshlrev_b32 v36, 16, v142
  v_and_b32 v13, 0xffff0000, v138
  v_and_b32 v37, 0xffff0000, v142
  v_lshlrev_b32 v14, 16, v139
  v_lshlrev_b32 v38, 16, v143
  v_and_b32 v15, 0xffff0000, v139
  v_and_b32 v39, 0xffff0000, v143
  v_pk_add_f32 v[18:19], v[8:9], v[10:11]
  v_pk_add_f32 v[42:43], v[32:33], v[34:35]
  v_pk_add_f32 v[20:21], v[12:13], v[14:15]
  v_pk_add_f32 v[44:45], v[36:37], v[38:39]
  v_pk_add_f32 v[18:19], v[18:19], v[20:21]
  v_pk_add_f32 v[42:43], v[42:43], v[44:45]
  v_add_f32 v16, v18, v19
  v_add_f32 v40, v42, v43
  s_nop 0
  v_add_f32_dpp v16, v16, v16 row_ror:1 row_mask:0xf bank_mask:0xf
  v_add_f32_dpp v40, v40, v40 row_ror:1 row_mask:0xf bank_mask:0xf
  s_nop 0
  v_add_f32_dpp v16, v16, v16 row_ror:2 row_mask:0xf bank_mask:0xf
  v_add_f32_dpp v40, v40, v40 row_ror:2 row_mask:0xf bank_mask:0xf
  s_nop 0
  v_add_f32_dpp v16, v16, v16 row_ror:4 row_mask:0xf bank_mask:0xf
  v_add_f32_dpp v40, v40, v40 row_ror:4 row_mask:0xf bank_mask:0xf
  s_nop 0
  v_add_f32_dpp v16, v16, v16 row_ror:8 row_mask:0xf bank_mask:0xf
  v_add_f32_dpp v40, v40, v40 row_ror:8 row_mask:0xf bank_mask:0xf
  v_mov_b32 v18, v16
  v_mov_b32 v42, v40
  s_nop 0
  v_permlane16_swap_b32 v16, v18
  v_permlane16_swap_b32 v40, v42
  v_add_f32 v16, v16, v18
  v_add_f32 v40, v40, v42
  v_mov_b32 v18, v16
  v_mov_b32 v42, v40
  s_nop 0
  v_permlane32_swap_b32 v16, v18
  v_permlane32_swap_b32 v40, v42
  v_add_f32 v16, v16, v18
  v_add_f32 v40, v40, v42
  v_mul_f32 v16, s26, v16
  v_mul_f32 v40, s26, v40
  v_pk_add_f32 v[64:65], v[8:9], v[16:17] op_sel_hi:[1,0] neg_lo:[0,1] neg_hi:[0,1]
  v_pk_add_f32 v[96:97], v[32:33], v[40:41] op_sel_hi:[1,0] neg_lo:[0,1] neg_hi:[0,1]
  v_pk_add_f32 v[66:67], v[10:11], v[16:17] op_sel_hi:[1,0] neg_lo:[0,1] neg_hi:[0,1]
  v_pk_add_f32 v[98:99], v[34:35], v[40:41] op_sel_hi:[1,0] neg_lo:[0,1] neg_hi:[0,1]
  v_pk_add_f32 v[68:69], v[12:13], v[16:17] op_sel_hi:[1,0] neg_lo:[0,1] neg_hi:[0,1]
  v_pk_add_f32 v[100:101], v[36:37], v[40:41] op_sel_hi:[1,0] neg_lo:[0,1] neg_hi:[0,1]
  v_pk_add_f32 v[70:71], v[14:15], v[16:17] op_sel_hi:[1,0] neg_lo:[0,1] neg_hi:[0,1]
  v_pk_add_f32 v[102:103], v[38:39], v[40:41] op_sel_hi:[1,0] neg_lo:[0,1] neg_hi:[0,1]
  v_pk_mul_f32 v[18:19], v[64:65], v[64:65]
  v_pk_mul_f32 v[42:43], v[96:97], v[96:97]
  v_pk_fma_f32 v[18:19], v[66:67], v[66:67], v[18:19]
  v_pk_fma_f32 v[42:43], v[98:99], v[98:99], v[42:43]
  v_pk_fma_f32 v[18:19], v[68:69], v[68:69], v[18:19]
  v_pk_fma_f32 v[42:43], v[100:101], v[100:101], v[42:43]
  v_pk_fma_f32 v[18:19], v[70:71], v[70:71], v[18:19]
  v_pk_fma_f32 v[42:43], v[102:103], v[102:103], v[42:43]
  v_add_f32 v17, v18, v19
  v_add_f32 v41, v42, v43
  v_cvt_pk_bf16_f32 v16, v16, v16
  v_cvt_pk_bf16_f32 v40, v40, v40
  v_lshlrev_b32 v16, 16, v16
  v_lshlrev_b32 v40, 16, v40
  v_add_f32_dpp v17, v17, v17 row_ror:1 row_mask:0xf bank_mask:0xf
  v_add_f32_dpp v41, v41, v41 row_ror:1 row_mask:0xf bank_mask:0xf
  s_nop 0
  v_add_f32_dpp v17, v17, v17 row_ror:2 row_mask:0xf bank_mask:0xf
  v_add_f32_dpp v41, v41, v41 row_ror:2 row_mask:0xf bank_mask:0xf
  s_nop 0
  v_add_f32_dpp v17, v17, v17 row_ror:4 row_mask:0xf bank_mask:0xf
  v_add_f32_dpp v41, v41, v41 row_ror:4 row_mask:0xf bank_mask:0xf
  s_nop 0
  v_add_f32_dpp v17, v17, v17 row_ror:8 row_mask:0xf bank_mask:0xf
  v_add_f32_dpp v41, v41, v41 row_ror:8 row_mask:0xf bank_mask:0xf
  v_mov_b32 v18, v17
  v_mov_b32 v42, v41
  s_nop 0
  v_permlane16_swap_b32 v17, v18
  v_permlane16_swap_b32 v41, v42
  v_add_f32 v17, v17, v18
  v_add_f32 v41, v41, v42
  v_mov_b32 v18, v17
  v_mov_b32 v42, v41
  s_nop 0
  v_permlane32_swap_b32 v17, v18
  v_permlane32_swap_b32 v41, v42
  v_add_f32 v17, v17, v18
  v_add_f32 v41, v41, v42
  v_mul_f32 v17, s26, v17
  v_mul_f32 v41, s26, v41
  v_cvt_pk_bf16_f32 v17, v17, v17
  v_cvt_pk_bf16_f32 v41, v41, v41
  v_lshlrev_b32 v17, 16, v17
  v_lshlrev_b32 v41, 16, v41
  v_add_f32 v17, s25, v17
  v_add_f32 v41, s25, v41
  v_cvt_pk_bf16_f32 v17, v17, v17
  v_cvt_pk_bf16_f32 v41, v41, v41
  v_lshlrev_b32 v17, 16, v17
  v_lshlrev_b32 v41, 16, v41
  v_sqrt_f32 v17, v17
  v_sqrt_f32 v41, v41
  v_pk_add_f32 v[8:9], v[8:9], v[16:17] op_sel_hi:[1,0] neg_lo:[0,1] neg_hi:[0,1]
  v_pk_add_f32 v[32:33], v[32:33], v[40:41] op_sel_hi:[1,0] neg_lo:[0,1] neg_hi:[0,1]
  v_pk_add_f32 v[10:11], v[10:11], v[16:17] op_sel_hi:[1,0] neg_lo:[0,1] neg_hi:[0,1]
  v_pk_add_f32 v[34:35], v[34:35], v[40:41] op_sel_hi:[1,0] neg_lo:[0,1] neg_hi:[0,1]
  v_pk_add_f32 v[12:13], v[12:13], v[16:17] op_sel_hi:[1,0] neg_lo:[0,1] neg_hi:[0,1]
  v_pk_add_f32 v[36:37], v[36:37], v[40:41] op_sel_hi:[1,0] neg_lo:[0,1] neg_hi:[0,1]
  v_pk_add_f32 v[14:15], v[14:15], v[16:17] op_sel_hi:[1,0] neg_lo:[0,1] neg_hi:[0,1]
  v_pk_add_f32 v[38:39], v[38:39], v[40:41] op_sel_hi:[1,0] neg_lo:[0,1] neg_hi:[0,1]
  v_cvt_pk_bf16_f32 v17, v17, v17
  v_cvt_pk_bf16_f32 v41, v41, v41
  v_lshlrev_b32 v17, 16, v17
  v_lshlrev_b32 v41, 16, v41
  v_rcp_f32 v18, v17
  v_rcp_f32 v42, v41
  v_cvt_pk_bf16_f32 v20, v8, v9
  v_cvt_pk_bf16_f32 v44, v32, v33
  v_cvt_pk_bf16_f32 v21, v10, v11
  v_cvt_pk_bf16_f32 v45, v34, v35
  v_cvt_pk_bf16_f32 v22, v12, v13
  v_cvt_pk_bf16_f32 v46, v36, v37
  v_cvt_pk_bf16_f32 v23, v14, v15
  v_cvt_pk_bf16_f32 v47, v38, v39
  v_lshlrev_b32 v8, 16, v20
  v_lshlrev_b32 v32, 16, v44
  v_and_b32 v9, 0xffff0000, v20
  v_and_b32 v33, 0xffff0000, v44
  v_lshlrev_b32 v10, 16, v21
  v_lshlrev_b32 v34, 16, v45
  v_and_b32 v11, 0xffff0000, v21
  v_and_b32 v35, 0xffff0000, v45
  v_lshlrev_b32 v12, 16, v22
  v_lshlrev_b32 v36, 16, v46
  v_and_b32 v13, 0xffff0000, v22
  v_and_b32 v37, 0xffff0000, v46
  v_lshlrev_b32 v14, 16, v23
  v_lshlrev_b32 v38, 16, v47
  v_and_b32 v15, 0xffff0000, v23
  v_and_b32 v39, 0xffff0000, v47
  v_pk_mul_f32 v[8:9], v[8:9], v[18:19] op_sel_hi:[1,0]
  v_pk_mul_f32 v[32:33], v[32:33], v[42:43] op_sel_hi:[1,0]
  v_pk_mul_f32 v[10:11], v[10:11], v[18:19] op_sel_hi:[1,0]
  v_pk_mul_f32 v[34:35], v[34:35], v[42:43] op_sel_hi:[1,0]
  v_pk_mul_f32 v[12:13], v[12:13], v[18:19] op_sel_hi:[1,0]
  v_pk_mul_f32 v[36:37], v[36:37], v[42:43] op_sel_hi:[1,0]
  v_pk_mul_f32 v[14:15], v[14:15], v[18:19] op_sel_hi:[1,0]
  v_pk_mul_f32 v[38:39], v[38:39], v[42:43] op_sel_hi:[1,0]
  v_cvt_pk_bf16_f32 v20, v8, v9
  v_cvt_pk_bf16_f32 v44, v32, v33
  v_cvt_pk_bf16_f32 v21, v10, v11
  v_cvt_pk_bf16_f32 v45, v34, v35
  v_cvt_pk_bf16_f32 v22, v12, v13
  v_cvt_pk_bf16_f32 v46, v36, v37
  v_cvt_pk_bf16_f32 v23, v14, v15
  v_cvt_pk_bf16_f32 v47, v38, v39
  s_waitcnt vmcnt(0)
  s_mov_b64 exec, 3
  buffer_store_dword v7, v4, s[4:7], s22 offen sc1
  s_mov_b64 exec, -1
  s_add_u32 s22, s22, 2048
  buffer_store_dwordx4 v[20:23], v1, s[4:7], s21 offen offset:0 sc1
  buffer_store_dwordx4 v[44:47], v1, s[4:7], s21 offen offset:1024 sc1
  s_add_u32 s21, s21, 65536
  v_lshlrev_b32 v8, 16, v144
  v_lshlrev_b32 v32, 16, v148
  v_and_b32 v9, 0xffff0000, v144
  v_and_b32 v33, 0xffff0000, v148
  v_lshlrev_b32 v10, 16, v145
  v_lshlrev_b32 v34, 16, v149
  v_and_b32 v11, 0xffff0000, v145
  v_and_b32 v35, 0xffff0000, v149
  v_lshlrev_b32 v12, 16, v146
  v_lshlrev_b32 v36, 16, v150
  v_and_b32 v13, 0xffff0000, v146
  v_and_b32 v37, 0xffff0000, v150
  v_lshlrev_b32 v14, 16, v147
  v_lshlrev_b32 v38, 16, v151
  v_and_b32 v15, 0xffff0000, v147
  v_and_b32 v39, 0xffff0000, v151
  v_pk_add_f32 v[18:19], v[8:9], v[10:11]
  v_pk_add_f32 v[42:43], v[32:33], v[34:35]
  v_pk_add_f32 v[20:21], v[12:13], v[14:15]
  v_pk_add_f32 v[44:45], v[36:37], v[38:39]
  v_pk_add_f32 v[18:19], v[18:19], v[20:21]
  v_pk_add_f32 v[42:43], v[42:43], v[44:45]
  v_add_f32 v16, v18, v19
  v_add_f32 v40, v42, v43
  s_nop 0
  v_add_f32_dpp v16, v16, v16 row_ror:1 row_mask:0xf bank_mask:0xf
  v_add_f32_dpp v40, v40, v40 row_ror:1 row_mask:0xf bank_mask:0xf
  s_nop 0
  v_add_f32_dpp v16, v16, v16 row_ror:2 row_mask:0xf bank_mask:0xf
  v_add_f32_dpp v40, v40, v40 row_ror:2 row_mask:0xf bank_mask:0xf
  s_nop 0
  v_add_f32_dpp v16, v16, v16 row_ror:4 row_mask:0xf bank_mask:0xf
  v_add_f32_dpp v40, v40, v40 row_ror:4 row_mask:0xf bank_mask:0xf
  s_nop 0
  v_add_f32_dpp v16, v16, v16 row_ror:8 row_mask:0xf bank_mask:0xf
  v_add_f32_dpp v40, v40, v40 row_ror:8 row_mask:0xf bank_mask:0xf
  v_mov_b32 v18, v16
  v_mov_b32 v42, v40
  s_nop 0
  v_permlane16_swap_b32 v16, v18
  v_permlane16_swap_b32 v40, v42
  v_add_f32 v16, v16, v18
  v_add_f32 v40, v40, v42
  v_mov_b32 v18, v16
  v_mov_b32 v42, v40
  s_nop 0
  v_permlane32_swap_b32 v16, v18
  v_permlane32_swap_b32 v40, v42
  v_add_f32 v16, v16, v18
  v_add_f32 v40, v40, v42
  v_mul_f32 v16, s26, v16
  v_mul_f32 v40, s26, v40
  v_pk_add_f32 v[64:65], v[8:9], v[16:17] op_sel_hi:[1,0] neg_lo:[0,1] neg_hi:[0,1]
  v_pk_add_f32 v[96:97], v[32:33], v[40:41] op_sel_hi:[1,0] neg_lo:[0,1] neg_hi:[0,1]
  v_pk_add_f32 v[66:67], v[10:11], v[16:17] op_sel_hi:[1,0] neg_lo:[0,1] neg_hi:[0,1]
  v_pk_add_f32 v[98:99], v[34:35], v[40:41] op_sel_hi:[1,0] neg_lo:[0,1] neg_hi:[0,1]
  v_pk_add_f32 v[68:69], v[12:13], v[16:17] op_sel_hi:[1,0] neg_lo:[0,1] neg_hi:[0,1]
  v_pk_add_f32 v[100:101], v[36:37], v[40:41] op_sel_hi:[1,0] neg_lo:[0,1] neg_hi:[0,1]
  v_pk_add_f32 v[70:71], v[14:15], v[16:17] op_sel_hi:[1,0] neg_lo:[0,1] neg_hi:[0,1]
  v_pk_add_f32 v[102:103], v[38:39], v[40:41] op_sel_hi:[1,0] neg_lo:[0,1] neg_hi:[0,1]
  v_pk_mul_f32 v[18:19], v[64:65], v[64:65]
  v_pk_mul_f32 v[42:43], v[96:97], v[96:97]
  v_pk_fma_f32 v[18:19], v[66:67], v[66:67], v[18:19]
  v_pk_fma_f32 v[42:43], v[98:99], v[98:99], v[42:43]
  v_pk_fma_f32 v[18:19], v[68:69], v[68:69], v[18:19]
  v_pk_fma_f32 v[42:43], v[100:101], v[100:101], v[42:43]
  v_pk_fma_f32 v[18:19], v[70:71], v[70:71], v[18:19]
  v_pk_fma_f32 v[42:43], v[102:103], v[102:103], v[42:43]
  v_add_f32 v17, v18, v19
  v_add_f32 v41, v42, v43
  v_cvt_pk_bf16_f32 v16, v16, v16
  v_cvt_pk_bf16_f32 v40, v40, v40
  v_lshlrev_b32 v16, 16, v16
  v_lshlrev_b32 v40, 16, v40
  v_add_f32_dpp v17, v17, v17 row_ror:1 row_mask:0xf bank_mask:0xf
  v_add_f32_dpp v41, v41, v41 row_ror:1 row_mask:0xf bank_mask:0xf
  s_nop 0
  v_add_f32_dpp v17, v17, v17 row_ror:2 row_mask:0xf bank_mask:0xf
  v_add_f32_dpp v41, v41, v41 row_ror:2 row_mask:0xf bank_mask:0xf
  s_nop 0
  v_add_f32_dpp v17, v17, v17 row_ror:4 row_mask:0xf bank_mask:0xf
  v_add_f32_dpp v41, v41, v41 row_ror:4 row_mask:0xf bank_mask:0xf
  s_nop 0
  v_add_f32_dpp v17, v17, v17 row_ror:8 row_mask:0xf bank_mask:0xf
  v_add_f32_dpp v41, v41, v41 row_ror:8 row_mask:0xf bank_mask:0xf
  v_mov_b32 v18, v17
  v_mov_b32 v42, v41
  s_nop 0
  v_permlane16_swap_b32 v17, v18
  v_permlane16_swap_b32 v41, v42
  v_add_f32 v17, v17, v18
  v_add_f32 v41, v41, v42
  v_mov_b32 v18, v17
  v_mov_b32 v42, v41
  s_nop 0
  v_permlane32_swap_b32 v17, v18
  v_permlane32_swap_b32 v41, v42
  v_add_f32 v17, v17, v18
  v_add_f32 v41, v41, v42
  v_mul_f32 v17, s26, v17
  v_mul_f32 v41, s26, v41
  v_cvt_pk_bf16_f32 v17, v17, v17
  v_cvt_pk_bf16_f32 v41, v41, v41
  v_lshlrev_b32 v17, 16, v17
  v_lshlrev_b32 v41, 16, v41
  v_add_f32 v17, s25, v17
  v_add_f32 v41, s25, v41
  v_cvt_pk_bf16_f32 v17, v17, v17
  v_cvt_pk_bf16_f32 v41, v41, v41
  v_lshlrev_b32 v17, 16, v17
  v_lshlrev_b32 v41, 16, v41
  v_sqrt_f32 v17, v17
  v_sqrt_f32 v41, v41
  v_pk_add_f32 v[8:9], v[8:9], v[16:17] op_sel_hi:[1,0] neg_lo:[0,1] neg_hi:[0,1]
  v_pk_add_f32 v[32:33], v[32:33], v[40:41] op_sel_hi:[1,0] neg_lo:[0,1] neg_hi:[0,1]
  v_pk_add_f32 v[10:11], v[10:11], v[16:17] op_sel_hi:[1,0] neg_lo:[0,1] neg_hi:[0,1]
  v_pk_add_f32 v[34:35], v[34:35], v[40:41] op_sel_hi:[1,0] neg_lo:[0,1] neg_hi:[0,1]
  v_pk_add_f32 v[12:13], v[12:13], v[16:17] op_sel_hi:[1,0] neg_lo:[0,1] neg_hi:[0,1]
  v_pk_add_f32 v[36:37], v[36:37], v[40:41] op_sel_hi:[1,0] neg_lo:[0,1] neg_hi:[0,1]
  v_pk_add_f32 v[14:15], v[14:15], v[16:17] op_sel_hi:[1,0] neg_lo:[0,1] neg_hi:[0,1]
  v_pk_add_f32 v[38:39], v[38:39], v[40:41] op_sel_hi:[1,0] neg_lo:[0,1] neg_hi:[0,1]
  v_cvt_pk_bf16_f32 v17, v17, v17
  v_cvt_pk_bf16_f32 v41, v41, v41
  v_lshlrev_b32 v17, 16, v17
  v_lshlrev_b32 v41, 16, v41
  v_rcp_f32 v18, v17
  v_rcp_f32 v42, v41
  v_cvt_pk_bf16_f32 v20, v8, v9
  v_cvt_pk_bf16_f32 v44, v32, v33
  v_cvt_pk_bf16_f32 v21, v10, v11
  v_cvt_pk_bf16_f32 v45, v34, v35
  v_cvt_pk_bf16_f32 v22, v12, v13
  v_cvt_pk_bf16_f32 v46, v36, v37
  v_cvt_pk_bf16_f32 v23, v14, v15
  v_cvt_pk_bf16_f32 v47, v38, v39
  v_lshlrev_b32 v8, 16, v20
  v_lshlrev_b32 v32, 16, v44
  v_and_b32 v9, 0xffff0000, v20
  v_and_b32 v33, 0xffff0000, v44
  v_lshlrev_b32 v10, 16, v21
  v_lshlrev_b32 v34, 16, v45
  v_and_b32 v11, 0xffff0000, v21
  v_and_b32 v35, 0xffff0000, v45
  v_lshlrev_b32 v12, 16, v22
  v_lshlrev_b32 v36, 16, v46
  v_and_b32 v13, 0xffff0000, v22
  v_and_b32 v37, 0xffff0000, v46
  v_lshlrev_b32 v14, 16, v23
  v_lshlrev_b32 v38, 16, v47
  v_and_b32 v15, 0xffff0000, v23
  v_and_b32 v39, 0xffff0000, v47
  v_pk_mul_f32 v[8:9], v[8:9], v[18:19] op_sel_hi:[1,0]
  v_pk_mul_f32 v[32:33], v[32:33], v[42:43] op_sel_hi:[1,0]
  v_pk_mul_f32 v[10:11], v[10:11], v[18:19] op_sel_hi:[1,0]
  v_pk_mul_f32 v[34:35], v[34:35], v[42:43] op_sel_hi:[1,0]
  v_pk_mul_f32 v[12:13], v[12:13], v[18:19] op_sel_hi:[1,0]
  v_pk_mul_f32 v[36:37], v[36:37], v[42:43] op_sel_hi:[1,0]
  v_pk_mul_f32 v[14:15], v[14:15], v[18:19] op_sel_hi:[1,0]
  v_pk_mul_f32 v[38:39], v[38:39], v[42:43] op_sel_hi:[1,0]
  v_cvt_pk_bf16_f32 v20, v8, v9
  v_cvt_pk_bf16_f32 v44, v32, v33
  v_cvt_pk_bf16_f32 v21, v10, v11
  v_cvt_pk_bf16_f32 v45, v34, v35
  v_cvt_pk_bf16_f32 v22, v12, v13
  v_cvt_pk_bf16_f32 v46, v36, v37
  v_cvt_pk_bf16_f32 v23, v14, v15
  v_cvt_pk_bf16_f32 v47, v38, v39
  s_waitcnt vmcnt(0)
  s_mov_b64 exec, 3
  buffer_store_dword v7, v4, s[4:7], s22 offen sc1
  s_mov_b64 exec, -1
  s_add_u32 s22, s22, 2048
  buffer_store_dwordx4 v[20:23], v1, s[4:7], s21 offen offset:0 sc1
  buffer_store_dwordx4 v[44:47], v1, s[4:7], s21 offen offset:1024 sc1
  s_add_u32 s21, s21, 65536
  v_lshlrev_b32 v8, 16, v152
  v_lshlrev_b32 v32, 16, v156
  v_and_b32 v9, 0xffff0000, v152
  v_and_b32 v33, 0xffff0000, v156
  v_lshlrev_b32 v10, 16, v153
  v_lshlrev_b32 v34, 16, v157
  v_and_b32 v11, 0xffff0000, v153
  v_and_b32 v35, 0xffff0000, v157
  v_lshlrev_b32 v12, 16, v154
  v_lshlrev_b32 v36, 16, v158
  v_and_b32 v13, 0xffff0000, v154
  v_and_b32 v37, 0xffff0000, v158
  v_lshlrev_b32 v14, 16, v155
  v_lshlrev_b32 v38, 16, v159
  v_and_b32 v15, 0xffff0000, v155
  v_and_b32 v39, 0xffff0000, v159
  v_pk_add_f32 v[18:19], v[8:9], v[10:11]
  v_pk_add_f32 v[42:43], v[32:33], v[34:35]
  v_pk_add_f32 v[20:21], v[12:13], v[14:15]
  v_pk_add_f32 v[44:45], v[36:37], v[38:39]
  v_pk_add_f32 v[18:19], v[18:19], v[20:21]
  v_pk_add_f32 v[42:43], v[42:43], v[44:45]
  v_add_f32 v16, v18, v19
  v_add_f32 v40, v42, v43
  s_nop 0
  v_add_f32_dpp v16, v16, v16 row_ror:1 row_mask:0xf bank_mask:0xf
  v_add_f32_dpp v40, v40, v40 row_ror:1 row_mask:0xf bank_mask:0xf
  s_nop 0
  v_add_f32_dpp v16, v16, v16 row_ror:2 row_mask:0xf bank_mask:0xf
  v_add_f32_dpp v40, v40, v40 row_ror:2 row_mask:0xf bank_mask:0xf
  s_nop 0
  v_add_f32_dpp v16, v16, v16 row_ror:4 row_mask:0xf bank_mask:0xf
  v_add_f32_dpp v40, v40, v40 row_ror:4 row_mask:0xf bank_mask:0xf
  s_nop 0
  v_add_f32_dpp v16, v16, v16 row_ror:8 row_mask:0xf bank_mask:0xf
  v_add_f32_dpp v40, v40, v40 row_ror:8 row_mask:0xf bank_mask:0xf
  v_mov_b32 v18, v16
  v_mov_b32 v42, v40
  s_nop 0
  v_permlane16_swap_b32 v16, v18
  v_permlane16_swap_b32 v40, v42
  v_add_f32 v16, v16, v18
  v_add_f32 v40, v40, v42
  v_mov_b32 v18, v16
  v_mov_b32 v42, v40
  s_nop 0
  v_permlane32_swap_b32 v16, v18
  v_permlane32_swap_b32 v40, v42
  v_add_f32 v16, v16, v18
  v_add_f32 v40, v40, v42
  v_mul_f32 v16, s26, v16
  v_mul_f32 v40, s26, v40
  v_pk_add_f32 v[64:65], v[8:9], v[16:17] op_sel_hi:[1,0] neg_lo:[0,1] neg_hi:[0,1]
  v_pk_add_f32 v[96:97], v[32:33], v[40:41] op_sel_hi:[1,0] neg_lo:[0,1] neg_hi:[0,1]
  v_pk_add_f32 v[66:67], v[10:11], v[16:17] op_sel_hi:[1,0] neg_lo:[0,1] neg_hi:[0,1]
  v_pk_add_f32 v[98:99], v[34:35], v[40:41] op_sel_hi:[1,0] neg_lo:[0,1] neg_hi:[0,1]
  v_pk_add_f32 v[68:69], v[12:13], v[16:17] op_sel_hi:[1,0] neg_lo:[0,1] neg_hi:[0,1]
  v_pk_add_f32 v[100:101], v[36:37], v[40:41] op_sel_hi:[1,0] neg_lo:[0,1] neg_hi:[0,1]
  v_pk_add_f32 v[70:71], v[14:15], v[16:17] op_sel_hi:[1,0] neg_lo:[0,1] neg_hi:[0,1]
  v_pk_add_f32 v[102:103], v[38:39], v[40:41] op_sel_hi:[1,0] neg_lo:[0,1] neg_hi:[0,1]
  v_pk_mul_f32 v[18:19], v[64:65], v[64:65]
  v_pk_mul_f32 v[42:43], v[96:97], v[96:97]
  v_pk_fma_f32 v[18:19], v[66:67], v[66:67], v[18:19]
  v_pk_fma_f32 v[42:43], v[98:99], v[98:99], v[42:43]
  v_pk_fma_f32 v[18:19], v[68:69], v[68:69], v[18:19]
  v_pk_fma_f32 v[42:43], v[100:101], v[100:101], v[42:43]
  v_pk_fma_f32 v[18:19], v[70:71], v[70:71], v[18:19]
  v_pk_fma_f32 v[42:43], v[102:103], v[102:103], v[42:43]
  v_add_f32 v17, v18, v19
  v_add_f32 v41, v42, v43
  v_cvt_pk_bf16_f32 v16, v16, v16
  v_cvt_pk_bf16_f32 v40, v40, v40
  v_lshlrev_b32 v16, 16, v16
  v_lshlrev_b32 v40, 16, v40
  v_add_f32_dpp v17, v17, v17 row_ror:1 row_mask:0xf bank_mask:0xf
  v_add_f32_dpp v41, v41, v41 row_ror:1 row_mask:0xf bank_mask:0xf
  s_nop 0
  v_add_f32_dpp v17, v17, v17 row_ror:2 row_mask:0xf bank_mask:0xf
  v_add_f32_dpp v41, v41, v41 row_ror:2 row_mask:0xf bank_mask:0xf
  s_nop 0
  v_add_f32_dpp v17, v17, v17 row_ror:4 row_mask:0xf bank_mask:0xf
  v_add_f32_dpp v41, v41, v41 row_ror:4 row_mask:0xf bank_mask:0xf
  s_nop 0
  v_add_f32_dpp v17, v17, v17 row_ror:8 row_mask:0xf bank_mask:0xf
  v_add_f32_dpp v41, v41, v41 row_ror:8 row_mask:0xf bank_mask:0xf
  v_mov_b32 v18, v17
  v_mov_b32 v42, v41
  s_nop 0
  v_permlane16_swap_b32 v17, v18
  v_permlane16_swap_b32 v41, v42
  v_add_f32 v17, v17, v18
  v_add_f32 v41, v41, v42
  v_mov_b32 v18, v17
  v_mov_b32 v42, v41
  s_nop 0
  v_permlane32_swap_b32 v17, v18
  v_permlane32_swap_b32 v41, v42
  v_add_f32 v17, v17, v18
  v_add_f32 v41, v41, v42
  v_mul_f32 v17, s26, v17
  v_mul_f32 v41, s26, v41
  v_cvt_pk_bf16_f32 v17, v17, v17
  v_cvt_pk_bf16_f32 v41, v41, v41
  v_lshlrev_b32 v17, 16, v17
  v_lshlrev_b32 v41, 16, v41
  v_add_f32 v17, s25, v17
  v_add_f32 v41, s25, v41
  v_cvt_pk_bf16_f32 v17, v17, v17
  v_cvt_pk_bf16_f32 v41, v41, v41
  v_lshlrev_b32 v17, 16, v17
  v_lshlrev_b32 v41, 16, v41
  v_sqrt_f32 v17, v17
  v_sqrt_f32 v41, v41
  v_pk_add_f32 v[8:9], v[8:9], v[16:17] op_sel_hi:[1,0] neg_lo:[0,1] neg_hi:[0,1]
  v_pk_add_f32 v[32:33], v[32:33], v[40:41] op_sel_hi:[1,0] neg_lo:[0,1] neg_hi:[0,1]
  v_pk_add_f32 v[10:11], v[10:11], v[16:17] op_sel_hi:[1,0] neg_lo:[0,1] neg_hi:[0,1]
  v_pk_add_f32 v[34:35], v[34:35], v[40:41] op_sel_hi:[1,0] neg_lo:[0,1] neg_hi:[0,1]
  v_pk_add_f32 v[12:13], v[12:13], v[16:17] op_sel_hi:[1,0] neg_lo:[0,1] neg_hi:[0,1]
  v_pk_add_f32 v[36:37], v[36:37], v[40:41] op_sel_hi:[1,0] neg_lo:[0,1] neg_hi:[0,1]
  v_pk_add_f32 v[14:15], v[14:15], v[16:17] op_sel_hi:[1,0] neg_lo:[0,1] neg_hi:[0,1]
  v_pk_add_f32 v[38:39], v[38:39], v[40:41] op_sel_hi:[1,0] neg_lo:[0,1] neg_hi:[0,1]
  v_cvt_pk_bf16_f32 v17, v17, v17
  v_cvt_pk_bf16_f32 v41, v41, v41
  v_lshlrev_b32 v17, 16, v17
  v_lshlrev_b32 v41, 16, v41
  v_rcp_f32 v18, v17
  v_rcp_f32 v42, v41
  v_cvt_pk_bf16_f32 v20, v8, v9
  v_cvt_pk_bf16_f32 v44, v32, v33
  v_cvt_pk_bf16_f32 v21, v10, v11
  v_cvt_pk_bf16_f32 v45, v34, v35
  v_cvt_pk_bf16_f32 v22, v12, v13
  v_cvt_pk_bf16_f32 v46, v36, v37
  v_cvt_pk_bf16_f32 v23, v14, v15
  v_cvt_pk_bf16_f32 v47, v38, v39
  v_lshlrev_b32 v8, 16, v20
  v_lshlrev_b32 v32, 16, v44
  v_and_b32 v9, 0xffff0000, v20
  v_and_b32 v33, 0xffff0000, v44
  v_lshlrev_b32 v10, 16, v21
  v_lshlrev_b32 v34, 16, v45
  v_and_b32 v11, 0xffff0000, v21
  v_and_b32 v35, 0xffff0000, v45
  v_lshlrev_b32 v12, 16, v22
  v_lshlrev_b32 v36, 16, v46
  v_and_b32 v13, 0xffff0000, v22
  v_and_b32 v37, 0xffff0000, v46
  v_lshlrev_b32 v14, 16, v23
  v_lshlrev_b32 v38, 16, v47
  v_and_b32 v15, 0xffff0000, v23
  v_and_b32 v39, 0xffff0000, v47
  v_pk_mul_f32 v[8:9], v[8:9], v[18:19] op_sel_hi:[1,0]
  v_pk_mul_f32 v[32:33], v[32:33], v[42:43] op_sel_hi:[1,0]
  v_pk_mul_f32 v[10:11], v[10:11], v[18:19] op_sel_hi:[1,0]
  v_pk_mul_f32 v[34:35], v[34:35], v[42:43] op_sel_hi:[1,0]
  v_pk_mul_f32 v[12:13], v[12:13], v[18:19] op_sel_hi:[1,0]
  v_pk_mul_f32 v[36:37], v[36:37], v[42:43] op_sel_hi:[1,0]
  v_pk_mul_f32 v[14:15], v[14:15], v[18:19] op_sel_hi:[1,0]
  v_pk_mul_f32 v[38:39], v[38:39], v[42:43] op_sel_hi:[1,0]
  v_cvt_pk_bf16_f32 v20, v8, v9
  v_cvt_pk_bf16_f32 v44, v32, v33
  v_cvt_pk_bf16_f32 v21, v10, v11
  v_cvt_pk_bf16_f32 v45, v34, v35
  v_cvt_pk_bf16_f32 v22, v12, v13
  v_cvt_pk_bf16_f32 v46, v36, v37
  v_cvt_pk_bf16_f32 v23, v14, v15
  v_cvt_pk_bf16_f32 v47, v38, v39
  s_waitcnt vmcnt(0)
  s_mov_b64 exec, 3
  buffer_store_dword v7, v4, s[4:7], s22 offen sc1
  s_mov_b64 exec, -1
  s_add_u32 s22, s22, 2048
  buffer_store_dwordx4 v[20:23], v1, s[4:7], s21 offen offset:0 sc1
  buffer_store_dwordx4 v[44:47], v1, s[4:7], s21 offen offset:1024 sc1
  s_add_u32 s21, s21, 65536
  v_lshlrev_b32 v8, 16, v160
  v_lshlrev_b32 v32, 16, v164
  v_and_b32 v9, 0xffff0000, v160
  v_and_b32 v33, 0xffff0000, v164
  v_lshlrev_b32 v10, 16, v161
  v_lshlrev_b32 v34, 16, v165
  v_and_b32 v11, 0xffff0000, v161
  v_and_b32 v35, 0xffff0000, v165
  v_lshlrev_b32 v12, 16, v162
  v_lshlrev_b32 v36, 16, v166
  v_and_b32 v13, 0xffff0000, v162
  v_and_b32 v37, 0xffff0000, v166
  v_lshlrev_b32 v14, 16, v163
  v_lshlrev_b32 v38, 16, v167
  v_and_b32 v15, 0xffff0000, v163
  v_and_b32 v39, 0xffff0000, v167
  v_pk_add_f32 v[18:19], v[8:9], v[10:11]
  v_pk_add_f32 v[42:43], v[32:33], v[34:35]
  v_pk_add_f32 v[20:21], v[12:13], v[14:15]
  v_pk_add_f32 v[44:45], v[36:37], v[38:39]
  v_pk_add_f32 v[18:19], v[18:19], v[20:21]
  v_pk_add_f32 v[42:43], v[42:43], v[44:45]
  v_add_f32 v16, v18, v19
  v_add_f32 v40, v42, v43
  s_nop 0
  v_add_f32_dpp v16, v16, v16 row_ror:1 row_mask:0xf bank_mask:0xf
  v_add_f32_dpp v40, v40, v40 row_ror:1 row_mask:0xf bank_mask:0xf
  s_nop 0
  v_add_f32_dpp v16, v16, v16 row_ror:2 row_mask:0xf bank_mask:0xf
  v_add_f32_dpp v40, v40, v40 row_ror:2 row_mask:0xf bank_mask:0xf
  s_nop 0
  v_add_f32_dpp v16, v16, v16 row_ror:4 row_mask:0xf bank_mask:0xf
  v_add_f32_dpp v40, v40, v40 row_ror:4 row_mask:0xf bank_mask:0xf
  s_nop 0
  v_add_f32_dpp v16, v16, v16 row_ror:8 row_mask:0xf bank_mask:0xf
  v_add_f32_dpp v40, v40, v40 row_ror:8 row_mask:0xf bank_mask:0xf
  v_mov_b32 v18, v16
  v_mov_b32 v42, v40
  s_nop 0
  v_permlane16_swap_b32 v16, v18
  v_permlane16_swap_b32 v40, v42
  v_add_f32 v16, v16, v18
  v_add_f32 v40, v40, v42
  v_mov_b32 v18, v16
  v_mov_b32 v42, v40
  s_nop 0
  v_permlane32_swap_b32 v16, v18
  v_permlane32_swap_b32 v40, v42
  v_add_f32 v16, v16, v18
  v_add_f32 v40, v40, v42
  v_mul_f32 v16, s26, v16
  v_mul_f32 v40, s26, v40
  v_pk_add_f32 v[64:65], v[8:9], v[16:17] op_sel_hi:[1,0] neg_lo:[0,1] neg_hi:[0,1]
  v_pk_add_f32 v[96:97], v[32:33], v[40:41] op_sel_hi:[1,0] neg_lo:[0,1] neg_hi:[0,1]
  v_pk_add_f32 v[66:67], v[10:11], v[16:17] op_sel_hi:[1,0] neg_lo:[0,1] neg_hi:[0,1]
  v_pk_add_f32 v[98:99], v[34:35], v[40:41] op_sel_hi:[1,0] neg_lo:[0,1] neg_hi:[0,1]
  v_pk_add_f32 v[68:69], v[12:13], v[16:17] op_sel_hi:[1,0] neg_lo:[0,1] neg_hi:[0,1]
  v_pk_add_f32 v[100:101], v[36:37], v[40:41] op_sel_hi:[1,0] neg_lo:[0,1] neg_hi:[0,1]
  v_pk_add_f32 v[70:71], v[14:15], v[16:17] op_sel_hi:[1,0] neg_lo:[0,1] neg_hi:[0,1]
  v_pk_add_f32 v[102:103], v[38:39], v[40:41] op_sel_hi:[1,0] neg_lo:[0,1] neg_hi:[0,1]
  v_pk_mul_f32 v[18:19], v[64:65], v[64:65]
  v_pk_mul_f32 v[42:43], v[96:97], v[96:97]
  v_pk_fma_f32 v[18:19], v[66:67], v[66:67], v[18:19]
  v_pk_fma_f32 v[42:43], v[98:99], v[98:99], v[42:43]
  v_pk_fma_f32 v[18:19], v[68:69], v[68:69], v[18:19]
  v_pk_fma_f32 v[42:43], v[100:101], v[100:101], v[42:43]
  v_pk_fma_f32 v[18:19], v[70:71], v[70:71], v[18:19]
  v_pk_fma_f32 v[42:43], v[102:103], v[102:103], v[42:43]
  v_add_f32 v17, v18, v19
  v_add_f32 v41, v42, v43
  v_cvt_pk_bf16_f32 v16, v16, v16
  v_cvt_pk_bf16_f32 v40, v40, v40
  v_lshlrev_b32 v16, 16, v16
  v_lshlrev_b32 v40, 16, v40
  v_add_f32_dpp v17, v17, v17 row_ror:1 row_mask:0xf bank_mask:0xf
  v_add_f32_dpp v41, v41, v41 row_ror:1 row_mask:0xf bank_mask:0xf
  s_nop 0
  v_add_f32_dpp v17, v17, v17 row_ror:2 row_mask:0xf bank_mask:0xf
  v_add_f32_dpp v41, v41, v41 row_ror:2 row_mask:0xf bank_mask:0xf
  s_nop 0
  v_add_f32_dpp v17, v17, v17 row_ror:4 row_mask:0xf bank_mask:0xf
  v_add_f32_dpp v41, v41, v41 row_ror:4 row_mask:0xf bank_mask:0xf
  s_nop 0
  v_add_f32_dpp v17, v17, v17 row_ror:8 row_mask:0xf bank_mask:0xf
  v_add_f32_dpp v41, v41, v41 row_ror:8 row_mask:0xf bank_mask:0xf
  v_mov_b32 v18, v17
  v_mov_b32 v42, v41
  s_nop 0
  v_permlane16_swap_b32 v17, v18
  v_permlane16_swap_b32 v41, v42
  v_add_f32 v17, v17, v18
  v_add_f32 v41, v41, v42
  v_mov_b32 v18, v17
  v_mov_b32 v42, v41
  s_nop 0
  v_permlane32_swap_b32 v17, v18
  v_permlane32_swap_b32 v41, v42
  v_add_f32 v17, v17, v18
  v_add_f32 v41, v41, v42
  v_mul_f32 v17, s26, v17
  v_mul_f32 v41, s26, v41
  v_cvt_pk_bf16_f32 v17, v17, v17
  v_cvt_pk_bf16_f32 v41, v41, v41
  v_lshlrev_b32 v17, 16, v17
  v_lshlrev_b32 v41, 16, v41
  v_add_f32 v17, s25, v17
  v_add_f32 v41, s25, v41
  v_cvt_pk_bf16_f32 v17, v17, v17
  v_cvt_pk_bf16_f32 v41, v41, v41
  v_lshlrev_b32 v17, 16, v17
  v_lshlrev_b32 v41, 16, v41
  v_sqrt_f32 v17, v17
  v_sqrt_f32 v41, v41
  v_pk_add_f32 v[8:9], v[8:9], v[16:17] op_sel_hi:[1,0] neg_lo:[0,1] neg_hi:[0,1]
  v_pk_add_f32 v[32:33], v[32:33], v[40:41] op_sel_hi:[1,0] neg_lo:[0,1] neg_hi:[0,1]
  v_pk_add_f32 v[10:11], v[10:11], v[16:17] op_sel_hi:[1,0] neg_lo:[0,1] neg_hi:[0,1]
  v_pk_add_f32 v[34:35], v[34:35], v[40:41] op_sel_hi:[1,0] neg_lo:[0,1] neg_hi:[0,1]
  v_pk_add_f32 v[12:13], v[12:13], v[16:17] op_sel_hi:[1,0] neg_lo:[0,1] neg_hi:[0,1]
  v_pk_add_f32 v[36:37], v[36:37], v[40:41] op_sel_hi:[1,0] neg_lo:[0,1] neg_hi:[0,1]
  v_pk_add_f32 v[14:15], v[14:15], v[16:17] op_sel_hi:[1,0] neg_lo:[0,1] neg_hi:[0,1]
  v_pk_add_f32 v[38:39], v[38:39], v[40:41] op_sel_hi:[1,0] neg_lo:[0,1] neg_hi:[0,1]
  v_cvt_pk_bf16_f32 v17, v17, v17
  v_cvt_pk_bf16_f32 v41, v41, v41
  v_lshlrev_b32 v17, 16, v17
  v_lshlrev_b32 v41, 16, v41
  v_rcp_f32 v18, v17
  v_rcp_f32 v42, v41
  v_cvt_pk_bf16_f32 v20, v8, v9
  v_cvt_pk_bf16_f32 v44, v32, v33
  v_cvt_pk_bf16_f32 v21, v10, v11
  v_cvt_pk_bf16_f32 v45, v34, v35
  v_cvt_pk_bf16_f32 v22, v12, v13
  v_cvt_pk_bf16_f32 v46, v36, v37
  v_cvt_pk_bf16_f32 v23, v14, v15
  v_cvt_pk_bf16_f32 v47, v38, v39
  v_lshlrev_b32 v8, 16, v20
  v_lshlrev_b32 v32, 16, v44
  v_and_b32 v9, 0xffff0000, v20
  v_and_b32 v33, 0xffff0000, v44
  v_lshlrev_b32 v10, 16, v21
  v_lshlrev_b32 v34, 16, v45
  v_and_b32 v11, 0xffff0000, v21
  v_and_b32 v35, 0xffff0000, v45
  v_lshlrev_b32 v12, 16, v22
  v_lshlrev_b32 v36, 16, v46
  v_and_b32 v13, 0xffff0000, v22
  v_and_b32 v37, 0xffff0000, v46
  v_lshlrev_b32 v14, 16, v23
  v_lshlrev_b32 v38, 16, v47
  v_and_b32 v15, 0xffff0000, v23
  v_and_b32 v39, 0xffff0000, v47
  v_pk_mul_f32 v[8:9], v[8:9], v[18:19] op_sel_hi:[1,0]
  v_pk_mul_f32 v[32:33], v[32:33], v[42:43] op_sel_hi:[1,0]
  v_pk_mul_f32 v[10:11], v[10:11], v[18:19] op_sel_hi:[1,0]
  v_pk_mul_f32 v[34:35], v[34:35], v[42:43] op_sel_hi:[1,0]
  v_pk_mul_f32 v[12:13], v[12:13], v[18:19] op_sel_hi:[1,0]
  v_pk_mul_f32 v[36:37], v[36:37], v[42:43] op_sel_hi:[1,0]
  v_pk_mul_f32 v[14:15], v[14:15], v[18:19] op_sel_hi:[1,0]
  v_pk_mul_f32 v[38:39], v[38:39], v[42:43] op_sel_hi:[1,0]
  v_cvt_pk_bf16_f32 v20, v8, v9
  v_cvt_pk_bf16_f32 v44, v32, v33
  v_cvt_pk_bf16_f32 v21, v10, v11
  v_cvt_pk_bf16_f32 v45, v34, v35
  v_cvt_pk_bf16_f32 v22, v12, v13
  v_cvt_pk_bf16_f32 v46, v36, v37
  v_cvt_pk_bf16_f32 v23, v14, v15
  v_cvt_pk_bf16_f32 v47, v38, v39
  s_waitcnt vmcnt(0)
  s_mov_b64 exec, 3
  buffer_store_dword v7, v4, s[4:7], s22 offen sc1
  s_mov_b64 exec, -1
  s_add_u32 s22, s22, 2048
  buffer_store_dwordx4 v[20:23], v1, s[4:7], s21 offen offset:0 sc1
  buffer_store_dwordx4 v[44:47], v1, s[4:7], s21 offen offset:1024 sc1
  s_add_u32 s21, s21, 65536
  v_lshlrev_b32 v8, 16, v168
  v_lshlrev_b32 v32, 16, v172
  v_and_b32 v9, 0xffff0000, v168
  v_and_b32 v33, 0xffff0000, v172
  v_lshlrev_b32 v10, 16, v169
  v_lshlrev_b32 v34, 16, v173
  v_and_b32 v11, 0xffff0000, v169
  v_and_b32 v35, 0xffff0000, v173
  v_lshlrev_b32 v12, 16, v170
  v_lshlrev_b32 v36, 16, v174
  v_and_b32 v13, 0xffff0000, v170
  v_and_b32 v37, 0xffff0000, v174
  v_lshlrev_b32 v14, 16, v171
  v_lshlrev_b32 v38, 16, v175
  v_and_b32 v15, 0xffff0000, v171
  v_and_b32 v39, 0xffff0000, v175
  v_pk_add_f32 v[18:19], v[8:9], v[10:11]
  v_pk_add_f32 v[42:43], v[32:33], v[34:35]
  v_pk_add_f32 v[20:21], v[12:13], v[14:15]
  v_pk_add_f32 v[44:45], v[36:37], v[38:39]
  v_pk_add_f32 v[18:19], v[18:19], v[20:21]
  v_pk_add_f32 v[42:43], v[42:43], v[44:45]
  v_add_f32 v16, v18, v19
  v_add_f32 v40, v42, v43
  s_nop 0
  v_add_f32_dpp v16, v16, v16 row_ror:1 row_mask:0xf bank_mask:0xf
  v_add_f32_dpp v40, v40, v40 row_ror:1 row_mask:0xf bank_mask:0xf
  s_nop 0
  v_add_f32_dpp v16, v16, v16 row_ror:2 row_mask:0xf bank_mask:0xf
  v_add_f32_dpp v40, v40, v40 row_ror:2 row_mask:0xf bank_mask:0xf
  s_nop 0
  v_add_f32_dpp v16, v16, v16 row_ror:4 row_mask:0xf bank_mask:0xf
  v_add_f32_dpp v40, v40, v40 row_ror:4 row_mask:0xf bank_mask:0xf
  s_nop 0
  v_add_f32_dpp v16, v16, v16 row_ror:8 row_mask:0xf bank_mask:0xf
  v_add_f32_dpp v40, v40, v40 row_ror:8 row_mask:0xf bank_mask:0xf
  v_mov_b32 v18, v16
  v_mov_b32 v42, v40
  s_nop 0
  v_permlane16_swap_b32 v16, v18
  v_permlane16_swap_b32 v40, v42
  v_add_f32 v16, v16, v18
  v_add_f32 v40, v40, v42
  v_mov_b32 v18, v16
  v_mov_b32 v42, v40
  s_nop 0
  v_permlane32_swap_b32 v16, v18
  v_permlane32_swap_b32 v40, v42
  v_add_f32 v16, v16, v18
  v_add_f32 v40, v40, v42
  v_mul_f32 v16, s26, v16
  v_mul_f32 v40, s26, v40
  v_pk_add_f32 v[64:65], v[8:9], v[16:17] op_sel_hi:[1,0] neg_lo:[0,1] neg_hi:[0,1]
  v_pk_add_f32 v[96:97], v[32:33], v[40:41] op_sel_hi:[1,0] neg_lo:[0,1] neg_hi:[0,1]
  v_pk_add_f32 v[66:67], v[10:11], v[16:17] op_sel_hi:[1,0] neg_lo:[0,1] neg_hi:[0,1]
  v_pk_add_f32 v[98:99], v[34:35], v[40:41] op_sel_hi:[1,0] neg_lo:[0,1] neg_hi:[0,1]
  v_pk_add_f32 v[68:69], v[12:13], v[16:17] op_sel_hi:[1,0] neg_lo:[0,1] neg_hi:[0,1]
  v_pk_add_f32 v[100:101], v[36:37], v[40:41] op_sel_hi:[1,0] neg_lo:[0,1] neg_hi:[0,1]
  v_pk_add_f32 v[70:71], v[14:15], v[16:17] op_sel_hi:[1,0] neg_lo:[0,1] neg_hi:[0,1]
  v_pk_add_f32 v[102:103], v[38:39], v[40:41] op_sel_hi:[1,0] neg_lo:[0,1] neg_hi:[0,1]
  v_pk_mul_f32 v[18:19], v[64:65], v[64:65]
  v_pk_mul_f32 v[42:43], v[96:97], v[96:97]
  v_pk_fma_f32 v[18:19], v[66:67], v[66:67], v[18:19]
  v_pk_fma_f32 v[42:43], v[98:99], v[98:99], v[42:43]
  v_pk_fma_f32 v[18:19], v[68:69], v[68:69], v[18:19]
  v_pk_fma_f32 v[42:43], v[100:101], v[100:101], v[42:43]
  v_pk_fma_f32 v[18:19], v[70:71], v[70:71], v[18:19]
  v_pk_fma_f32 v[42:43], v[102:103], v[102:103], v[42:43]
  v_add_f32 v17, v18, v19
  v_add_f32 v41, v42, v43
  v_cvt_pk_bf16_f32 v16, v16, v16
  v_cvt_pk_bf16_f32 v40, v40, v40
  v_lshlrev_b32 v16, 16, v16
  v_lshlrev_b32 v40, 16, v40
  v_add_f32_dpp v17, v17, v17 row_ror:1 row_mask:0xf bank_mask:0xf
  v_add_f32_dpp v41, v41, v41 row_ror:1 row_mask:0xf bank_mask:0xf
  s_nop 0
  v_add_f32_dpp v17, v17, v17 row_ror:2 row_mask:0xf bank_mask:0xf
  v_add_f32_dpp v41, v41, v41 row_ror:2 row_mask:0xf bank_mask:0xf
  s_nop 0
  v_add_f32_dpp v17, v17, v17 row_ror:4 row_mask:0xf bank_mask:0xf
  v_add_f32_dpp v41, v41, v41 row_ror:4 row_mask:0xf bank_mask:0xf
  s_nop 0
  v_add_f32_dpp v17, v17, v17 row_ror:8 row_mask:0xf bank_mask:0xf
  v_add_f32_dpp v41, v41, v41 row_ror:8 row_mask:0xf bank_mask:0xf
  v_mov_b32 v18, v17
  v_mov_b32 v42, v41
  s_nop 0
  v_permlane16_swap_b32 v17, v18
  v_permlane16_swap_b32 v41, v42
  v_add_f32 v17, v17, v18
  v_add_f32 v41, v41, v42
  v_mov_b32 v18, v17
  v_mov_b32 v42, v41
  s_nop 0
  v_permlane32_swap_b32 v17, v18
  v_permlane32_swap_b32 v41, v42
  v_add_f32 v17, v17, v18
  v_add_f32 v41, v41, v42
  v_mul_f32 v17, s26, v17
  v_mul_f32 v41, s26, v41
  v_cvt_pk_bf16_f32 v17, v17, v17
  v_cvt_pk_bf16_f32 v41, v41, v41
  v_lshlrev_b32 v17, 16, v17
  v_lshlrev_b32 v41, 16, v41
  v_add_f32 v17, s25, v17
  v_add_f32 v41, s25, v41
  v_cvt_pk_bf16_f32 v17, v17, v17
  v_cvt_pk_bf16_f32 v41, v41, v41
  v_lshlrev_b32 v17, 16, v17
  v_lshlrev_b32 v41, 16, v41
  v_sqrt_f32 v17, v17
  v_sqrt_f32 v41, v41
  v_pk_add_f32 v[8:9], v[8:9], v[16:17] op_sel_hi:[1,0] neg_lo:[0,1] neg_hi:[0,1]
  v_pk_add_f32 v[32:33], v[32:33], v[40:41] op_sel_hi:[1,0] neg_lo:[0,1] neg_hi:[0,1]
  v_pk_add_f32 v[10:11], v[10:11], v[16:17] op_sel_hi:[1,0] neg_lo:[0,1] neg_hi:[0,1]
  v_pk_add_f32 v[34:35], v[34:35], v[40:41] op_sel_hi:[1,0] neg_lo:[0,1] neg_hi:[0,1]
  v_pk_add_f32 v[12:13], v[12:13], v[16:17] op_sel_hi:[1,0] neg_lo:[0,1] neg_hi:[0,1]
  v_pk_add_f32 v[36:37], v[36:37], v[40:41] op_sel_hi:[1,0] neg_lo:[0,1] neg_hi:[0,1]
  v_pk_add_f32 v[14:15], v[14:15], v[16:17] op_sel_hi:[1,0] neg_lo:[0,1] neg_hi:[0,1]
  v_pk_add_f32 v[38:39], v[38:39], v[40:41] op_sel_hi:[1,0] neg_lo:[0,1] neg_hi:[0,1]
  v_cvt_pk_bf16_f32 v17, v17, v17
  v_cvt_pk_bf16_f32 v41, v41, v41
  v_lshlrev_b32 v17, 16, v17
  v_lshlrev_b32 v41, 16, v41
  v_rcp_f32 v18, v17
  v_rcp_f32 v42, v41
  v_cvt_pk_bf16_f32 v20, v8, v9
  v_cvt_pk_bf16_f32 v44, v32, v33
  v_cvt_pk_bf16_f32 v21, v10, v11
  v_cvt_pk_bf16_f32 v45, v34, v35
  v_cvt_pk_bf16_f32 v22, v12, v13
  v_cvt_pk_bf16_f32 v46, v36, v37
  v_cvt_pk_bf16_f32 v23, v14, v15
  v_cvt_pk_bf16_f32 v47, v38, v39
  v_lshlrev_b32 v8, 16, v20
  v_lshlrev_b32 v32, 16, v44
  v_and_b32 v9, 0xffff0000, v20
  v_and_b32 v33, 0xffff0000, v44
  v_lshlrev_b32 v10, 16, v21
  v_lshlrev_b32 v34, 16, v45
  v_and_b32 v11, 0xffff0000, v21
  v_and_b32 v35, 0xffff0000, v45
  v_lshlrev_b32 v12, 16, v22
  v_lshlrev_b32 v36, 16, v46
  v_and_b32 v13, 0xffff0000, v22
  v_and_b32 v37, 0xffff0000, v46
  v_lshlrev_b32 v14, 16, v23
  v_lshlrev_b32 v38, 16, v47
  v_and_b32 v15, 0xffff0000, v23
  v_and_b32 v39, 0xffff0000, v47
  v_pk_mul_f32 v[8:9], v[8:9], v[18:19] op_sel_hi:[1,0]
  v_pk_mul_f32 v[32:33], v[32:33], v[42:43] op_sel_hi:[1,0]
  v_pk_mul_f32 v[10:11], v[10:11], v[18:19] op_sel_hi:[1,0]
  v_pk_mul_f32 v[34:35], v[34:35], v[42:43] op_sel_hi:[1,0]
  v_pk_mul_f32 v[12:13], v[12:13], v[18:19] op_sel_hi:[1,0]
  v_pk_mul_f32 v[36:37], v[36:37], v[42:43] op_sel_hi:[1,0]
  v_pk_mul_f32 v[14:15], v[14:15], v[18:19] op_sel_hi:[1,0]
  v_pk_mul_f32 v[38:39], v[38:39], v[42:43] op_sel_hi:[1,0]
  v_cvt_pk_bf16_f32 v20, v8, v9
  v_cvt_pk_bf16_f32 v44, v32, v33
  v_cvt_pk_bf16_f32 v21, v10, v11
  v_cvt_pk_bf16_f32 v45, v34, v35
  v_cvt_pk_bf16_f32 v22, v12, v13
  v_cvt_pk_bf16_f32 v46, v36, v37
  v_cvt_pk_bf16_f32 v23, v14, v15
  v_cvt_pk_bf16_f32 v47, v38, v39
  s_waitcnt vmcnt(0)
  s_mov_b64 exec, 3
  buffer_store_dword v7, v4, s[4:7], s22 offen sc1
  s_mov_b64 exec, -1
  s_add_u32 s22, s22, 2048
  buffer_store_dwordx4 v[20:23], v1, s[4:7], s21 offen offset:0 sc1
  buffer_store_dwordx4 v[44:47], v1, s[4:7], s21 offen offset:1024 sc1
  s_add_u32 s21, s21, 65536
  v_lshlrev_b32 v8, 16, v176
  v_lshlrev_b32 v32, 16, v180
  v_and_b32 v9, 0xffff0000, v176
  v_and_b32 v33, 0xffff0000, v180
  v_lshlrev_b32 v10, 16, v177
  v_lshlrev_b32 v34, 16, v181
  v_and_b32 v11, 0xffff0000, v177
  v_and_b32 v35, 0xffff0000, v181
  v_lshlrev_b32 v12, 16, v178
  v_lshlrev_b32 v36, 16, v182
  v_and_b32 v13, 0xffff0000, v178
  v_and_b32 v37, 0xffff0000, v182
  v_lshlrev_b32 v14, 16, v179
  v_lshlrev_b32 v38, 16, v183
  v_and_b32 v15, 0xffff0000, v179
  v_and_b32 v39, 0xffff0000, v183
  v_pk_add_f32 v[18:19], v[8:9], v[10:11]
  v_pk_add_f32 v[42:43], v[32:33], v[34:35]
  v_pk_add_f32 v[20:21], v[12:13], v[14:15]
  v_pk_add_f32 v[44:45], v[36:37], v[38:39]
  v_pk_add_f32 v[18:19], v[18:19], v[20:21]
  v_pk_add_f32 v[42:43], v[42:43], v[44:45]
  v_add_f32 v16, v18, v19
  v_add_f32 v40, v42, v43
  s_nop 0
  v_add_f32_dpp v16, v16, v16 row_ror:1 row_mask:0xf bank_mask:0xf
  v_add_f32_dpp v40, v40, v40 row_ror:1 row_mask:0xf bank_mask:0xf
  s_nop 0
  v_add_f32_dpp v16, v16, v16 row_ror:2 row_mask:0xf bank_mask:0xf
  v_add_f32_dpp v40, v40, v40 row_ror:2 row_mask:0xf bank_mask:0xf
  s_nop 0
  v_add_f32_dpp v16, v16, v16 row_ror:4 row_mask:0xf bank_mask:0xf
  v_add_f32_dpp v40, v40, v40 row_ror:4 row_mask:0xf bank_mask:0xf
  s_nop 0
  v_add_f32_dpp v16, v16, v16 row_ror:8 row_mask:0xf bank_mask:0xf
  v_add_f32_dpp v40, v40, v40 row_ror:8 row_mask:0xf bank_mask:0xf
  v_mov_b32 v18, v16
  v_mov_b32 v42, v40
  s_nop 0
  v_permlane16_swap_b32 v16, v18
  v_permlane16_swap_b32 v40, v42
  v_add_f32 v16, v16, v18
  v_add_f32 v40, v40, v42
  v_mov_b32 v18, v16
  v_mov_b32 v42, v40
  s_nop 0
  v_permlane32_swap_b32 v16, v18
  v_permlane32_swap_b32 v40, v42
  v_add_f32 v16, v16, v18
  v_add_f32 v40, v40, v42
  v_mul_f32 v16, s26, v16
  v_mul_f32 v40, s26, v40
  v_pk_add_f32 v[64:65], v[8:9], v[16:17] op_sel_hi:[1,0] neg_lo:[0,1] neg_hi:[0,1]
  v_pk_add_f32 v[96:97], v[32:33], v[40:41] op_sel_hi:[1,0] neg_lo:[0,1] neg_hi:[0,1]
  v_pk_add_f32 v[66:67], v[10:11], v[16:17] op_sel_hi:[1,0] neg_lo:[0,1] neg_hi:[0,1]
  v_pk_add_f32 v[98:99], v[34:35], v[40:41] op_sel_hi:[1,0] neg_lo:[0,1] neg_hi:[0,1]
  v_pk_add_f32 v[68:69], v[12:13], v[16:17] op_sel_hi:[1,0] neg_lo:[0,1] neg_hi:[0,1]
  v_pk_add_f32 v[100:101], v[36:37], v[40:41] op_sel_hi:[1,0] neg_lo:[0,1] neg_hi:[0,1]
  v_pk_add_f32 v[70:71], v[14:15], v[16:17] op_sel_hi:[1,0] neg_lo:[0,1] neg_hi:[0,1]
  v_pk_add_f32 v[102:103], v[38:39], v[40:41] op_sel_hi:[1,0] neg_lo:[0,1] neg_hi:[0,1]
  v_pk_mul_f32 v[18:19], v[64:65], v[64:65]
  v_pk_mul_f32 v[42:43], v[96:97], v[96:97]
  v_pk_fma_f32 v[18:19], v[66:67], v[66:67], v[18:19]
  v_pk_fma_f32 v[42:43], v[98:99], v[98:99], v[42:43]
  v_pk_fma_f32 v[18:19], v[68:69], v[68:69], v[18:19]
  v_pk_fma_f32 v[42:43], v[100:101], v[100:101], v[42:43]
  v_pk_fma_f32 v[18:19], v[70:71], v[70:71], v[18:19]
  v_pk_fma_f32 v[42:43], v[102:103], v[102:103], v[42:43]
  v_add_f32 v17, v18, v19
  v_add_f32 v41, v42, v43
  v_cvt_pk_bf16_f32 v16, v16, v16
  v_cvt_pk_bf16_f32 v40, v40, v40
  v_lshlrev_b32 v16, 16, v16
  v_lshlrev_b32 v40, 16, v40
  v_add_f32_dpp v17, v17, v17 row_ror:1 row_mask:0xf bank_mask:0xf
  v_add_f32_dpp v41, v41, v41 row_ror:1 row_mask:0xf bank_mask:0xf
  s_nop 0
  v_add_f32_dpp v17, v17, v17 row_ror:2 row_mask:0xf bank_mask:0xf
  v_add_f32_dpp v41, v41, v41 row_ror:2 row_mask:0xf bank_mask:0xf
  s_nop 0
  v_add_f32_dpp v17, v17, v17 row_ror:4 row_mask:0xf bank_mask:0xf
  v_add_f32_dpp v41, v41, v41 row_ror:4 row_mask:0xf bank_mask:0xf
  s_nop 0
  v_add_f32_dpp v17, v17, v17 row_ror:8 row_mask:0xf bank_mask:0xf
  v_add_f32_dpp v41, v41, v41 row_ror:8 row_mask:0xf bank_mask:0xf
  v_mov_b32 v18, v17
  v_mov_b32 v42, v41
  s_nop 0
  v_permlane16_swap_b32 v17, v18
  v_permlane16_swap_b32 v41, v42
  v_add_f32 v17, v17, v18
  v_add_f32 v41, v41, v42
  v_mov_b32 v18, v17
  v_mov_b32 v42, v41
  s_nop 0
  v_permlane32_swap_b32 v17, v18
  v_permlane32_swap_b32 v41, v42
  v_add_f32 v17, v17, v18
  v_add_f32 v41, v41, v42
  v_mul_f32 v17, s26, v17
  v_mul_f32 v41, s26, v41
  v_cvt_pk_bf16_f32 v17, v17, v17
  v_cvt_pk_bf16_f32 v41, v41, v41
  v_lshlrev_b32 v17, 16, v17
  v_lshlrev_b32 v41, 16, v41
  v_add_f32 v17, s25, v17
  v_add_f32 v41, s25, v41
  v_cvt_pk_bf16_f32 v17, v17, v17
  v_cvt_pk_bf16_f32 v41, v41, v41
  v_lshlrev_b32 v17, 16, v17
  v_lshlrev_b32 v41, 16, v41
  v_sqrt_f32 v17, v17
  v_sqrt_f32 v41, v41
  v_pk_add_f32 v[8:9], v[8:9], v[16:17] op_sel_hi:[1,0] neg_lo:[0,1] neg_hi:[0,1]
  v_pk_add_f32 v[32:33], v[32:33], v[40:41] op_sel_hi:[1,0] neg_lo:[0,1] neg_hi:[0,1]
  v_pk_add_f32 v[10:11], v[10:11], v[16:17] op_sel_hi:[1,0] neg_lo:[0,1] neg_hi:[0,1]
  v_pk_add_f32 v[34:35], v[34:35], v[40:41] op_sel_hi:[1,0] neg_lo:[0,1] neg_hi:[0,1]
  v_pk_add_f32 v[12:13], v[12:13], v[16:17] op_sel_hi:[1,0] neg_lo:[0,1] neg_hi:[0,1]
  v_pk_add_f32 v[36:37], v[36:37], v[40:41] op_sel_hi:[1,0] neg_lo:[0,1] neg_hi:[0,1]
  v_pk_add_f32 v[14:15], v[14:15], v[16:17] op_sel_hi:[1,0] neg_lo:[0,1] neg_hi:[0,1]
  v_pk_add_f32 v[38:39], v[38:39], v[40:41] op_sel_hi:[1,0] neg_lo:[0,1] neg_hi:[0,1]
  v_cvt_pk_bf16_f32 v17, v17, v17
  v_cvt_pk_bf16_f32 v41, v41, v41
  v_lshlrev_b32 v17, 16, v17
  v_lshlrev_b32 v41, 16, v41
  v_rcp_f32 v18, v17
  v_rcp_f32 v42, v41
  v_cvt_pk_bf16_f32 v20, v8, v9
  v_cvt_pk_bf16_f32 v44, v32, v33
  v_cvt_pk_bf16_f32 v21, v10, v11
  v_cvt_pk_bf16_f32 v45, v34, v35
  v_cvt_pk_bf16_f32 v22, v12, v13
  v_cvt_pk_bf16_f32 v46, v36, v37
  v_cvt_pk_bf16_f32 v23, v14, v15
  v_cvt_pk_bf16_f32 v47, v38, v39
  v_lshlrev_b32 v8, 16, v20
  v_lshlrev_b32 v32, 16, v44
  v_and_b32 v9, 0xffff0000, v20
  v_and_b32 v33, 0xffff0000, v44
  v_lshlrev_b32 v10, 16, v21
  v_lshlrev_b32 v34, 16, v45
  v_and_b32 v11, 0xffff0000, v21
  v_and_b32 v35, 0xffff0000, v45
  v_lshlrev_b32 v12, 16, v22
  v_lshlrev_b32 v36, 16, v46
  v_and_b32 v13, 0xffff0000, v22
  v_and_b32 v37, 0xffff0000, v46
  v_lshlrev_b32 v14, 16, v23
  v_lshlrev_b32 v38, 16, v47
  v_and_b32 v15, 0xffff0000, v23
  v_and_b32 v39, 0xffff0000, v47
  v_pk_mul_f32 v[8:9], v[8:9], v[18:19] op_sel_hi:[1,0]
  v_pk_mul_f32 v[32:33], v[32:33], v[42:43] op_sel_hi:[1,0]
  v_pk_mul_f32 v[10:11], v[10:11], v[18:19] op_sel_hi:[1,0]
  v_pk_mul_f32 v[34:35], v[34:35], v[42:43] op_sel_hi:[1,0]
  v_pk_mul_f32 v[12:13], v[12:13], v[18:19] op_sel_hi:[1,0]
  v_pk_mul_f32 v[36:37], v[36:37], v[42:43] op_sel_hi:[1,0]
  v_pk_mul_f32 v[14:15], v[14:15], v[18:19] op_sel_hi:[1,0]
  v_pk_mul_f32 v[38:39], v[38:39], v[42:43] op_sel_hi:[1,0]
  v_cvt_pk_bf16_f32 v20, v8, v9
  v_cvt_pk_bf16_f32 v44, v32, v33
  v_cvt_pk_bf16_f32 v21, v10, v11
  v_cvt_pk_bf16_f32 v45, v34, v35
  v_cvt_pk_bf16_f32 v22, v12, v13
  v_cvt_pk_bf16_f32 v46, v36, v37
  v_cvt_pk_bf16_f32 v23, v14, v15
  v_cvt_pk_bf16_f32 v47, v38, v39
  s_waitcnt vmcnt(0)
  s_mov_b64 exec, 3
  buffer_store_dword v7, v4, s[4:7], s22 offen sc1
  s_mov_b64 exec, -1
  s_add_u32 s22, s22, 2048
  buffer_store_dwordx4 v[20:23], v1, s[4:7], s21 offen offset:0 sc1
  buffer_store_dwordx4 v[44:47], v1, s[4:7], s21 offen offset:1024 sc1
  s_add_u32 s21, s21, 65536
  v_lshlrev_b32 v8, 16, v184
  v_lshlrev_b32 v32, 16, v188
  v_and_b32 v9, 0xffff0000, v184
  v_and_b32 v33, 0xffff0000, v188
  v_lshlrev_b32 v10, 16, v185
  v_lshlrev_b32 v34, 16, v189
  v_and_b32 v11, 0xffff0000, v185
  v_and_b32 v35, 0xffff0000, v189
  v_lshlrev_b32 v12, 16, v186
  v_lshlrev_b32 v36, 16, v190
  v_and_b32 v13, 0xffff0000, v186
  v_and_b32 v37, 0xffff0000, v190
  v_lshlrev_b32 v14, 16, v187
  v_lshlrev_b32 v38, 16, v191
  v_and_b32 v15, 0xffff0000, v187
  v_and_b32 v39, 0xffff0000, v191
  v_pk_add_f32 v[18:19], v[8:9], v[10:11]
  v_pk_add_f32 v[42:43], v[32:33], v[34:35]
  v_pk_add_f32 v[20:21], v[12:13], v[14:15]
  v_pk_add_f32 v[44:45], v[36:37], v[38:39]
  v_pk_add_f32 v[18:19], v[18:19], v[20:21]
  v_pk_add_f32 v[42:43], v[42:43], v[44:45]
  v_add_f32 v16, v18, v19
  v_add_f32 v40, v42, v43
  s_nop 0
  v_add_f32_dpp v16, v16, v16 row_ror:1 row_mask:0xf bank_mask:0xf
  v_add_f32_dpp v40, v40, v40 row_ror:1 row_mask:0xf bank_mask:0xf
  s_nop 0
  v_add_f32_dpp v16, v16, v16 row_ror:2 row_mask:0xf bank_mask:0xf
  v_add_f32_dpp v40, v40, v40 row_ror:2 row_mask:0xf bank_mask:0xf
  s_nop 0
  v_add_f32_dpp v16, v16, v16 row_ror:4 row_mask:0xf bank_mask:0xf
  v_add_f32_dpp v40, v40, v40 row_ror:4 row_mask:0xf bank_mask:0xf
  s_nop 0
  v_add_f32_dpp v16, v16, v16 row_ror:8 row_mask:0xf bank_mask:0xf
  v_add_f32_dpp v40, v40, v40 row_ror:8 row_mask:0xf bank_mask:0xf
  v_mov_b32 v18, v16
  v_mov_b32 v42, v40
  s_nop 0
  v_permlane16_swap_b32 v16, v18
  v_permlane16_swap_b32 v40, v42
  v_add_f32 v16, v16, v18
  v_add_f32 v40, v40, v42
  v_mov_b32 v18, v16
  v_mov_b32 v42, v40
  s_nop 0
  v_permlane32_swap_b32 v16, v18
  v_permlane32_swap_b32 v40, v42
  v_add_f32 v16, v16, v18
  v_add_f32 v40, v40, v42
  v_mul_f32 v16, s26, v16
  v_mul_f32 v40, s26, v40
  v_pk_add_f32 v[64:65], v[8:9], v[16:17] op_sel_hi:[1,0] neg_lo:[0,1] neg_hi:[0,1]
  v_pk_add_f32 v[96:97], v[32:33], v[40:41] op_sel_hi:[1,0] neg_lo:[0,1] neg_hi:[0,1]
  v_pk_add_f32 v[66:67], v[10:11], v[16:17] op_sel_hi:[1,0] neg_lo:[0,1] neg_hi:[0,1]
  v_pk_add_f32 v[98:99], v[34:35], v[40:41] op_sel_hi:[1,0] neg_lo:[0,1] neg_hi:[0,1]
  v_pk_add_f32 v[68:69], v[12:13], v[16:17] op_sel_hi:[1,0] neg_lo:[0,1] neg_hi:[0,1]
  v_pk_add_f32 v[100:101], v[36:37], v[40:41] op_sel_hi:[1,0] neg_lo:[0,1] neg_hi:[0,1]
  v_pk_add_f32 v[70:71], v[14:15], v[16:17] op_sel_hi:[1,0] neg_lo:[0,1] neg_hi:[0,1]
  v_pk_add_f32 v[102:103], v[38:39], v[40:41] op_sel_hi:[1,0] neg_lo:[0,1] neg_hi:[0,1]
  v_pk_mul_f32 v[18:19], v[64:65], v[64:65]
  v_pk_mul_f32 v[42:43], v[96:97], v[96:97]
  v_pk_fma_f32 v[18:19], v[66:67], v[66:67], v[18:19]
  v_pk_fma_f32 v[42:43], v[98:99], v[98:99], v[42:43]
  v_pk_fma_f32 v[18:19], v[68:69], v[68:69], v[18:19]
  v_pk_fma_f32 v[42:43], v[100:101], v[100:101], v[42:43]
  v_pk_fma_f32 v[18:19], v[70:71], v[70:71], v[18:19]
  v_pk_fma_f32 v[42:43], v[102:103], v[102:103], v[42:43]
  v_add_f32 v17, v18, v19
  v_add_f32 v41, v42, v43
  v_cvt_pk_bf16_f32 v16, v16, v16
  v_cvt_pk_bf16_f32 v40, v40, v40
  v_lshlrev_b32 v16, 16, v16
  v_lshlrev_b32 v40, 16, v40
  v_add_f32_dpp v17, v17, v17 row_ror:1 row_mask:0xf bank_mask:0xf
  v_add_f32_dpp v41, v41, v41 row_ror:1 row_mask:0xf bank_mask:0xf
  s_nop 0
  v_add_f32_dpp v17, v17, v17 row_ror:2 row_mask:0xf bank_mask:0xf
  v_add_f32_dpp v41, v41, v41 row_ror:2 row_mask:0xf bank_mask:0xf
  s_nop 0
  v_add_f32_dpp v17, v17, v17 row_ror:4 row_mask:0xf bank_mask:0xf
  v_add_f32_dpp v41, v41, v41 row_ror:4 row_mask:0xf bank_mask:0xf
  s_nop 0
  v_add_f32_dpp v17, v17, v17 row_ror:8 row_mask:0xf bank_mask:0xf
  v_add_f32_dpp v41, v41, v41 row_ror:8 row_mask:0xf bank_mask:0xf
  v_mov_b32 v18, v17
  v_mov_b32 v42, v41
  s_nop 0
  v_permlane16_swap_b32 v17, v18
  v_permlane16_swap_b32 v41, v42
  v_add_f32 v17, v17, v18
  v_add_f32 v41, v41, v42
  v_mov_b32 v18, v17
  v_mov_b32 v42, v41
  s_nop 0
  v_permlane32_swap_b32 v17, v18
  v_permlane32_swap_b32 v41, v42
  v_add_f32 v17, v17, v18
  v_add_f32 v41, v41, v42
  v_mul_f32 v17, s26, v17
  v_mul_f32 v41, s26, v41
  v_cvt_pk_bf16_f32 v17, v17, v17
  v_cvt_pk_bf16_f32 v41, v41, v41
  v_lshlrev_b32 v17, 16, v17
  v_lshlrev_b32 v41, 16, v41
  v_add_f32 v17, s25, v17
  v_add_f32 v41, s25, v41
  v_cvt_pk_bf16_f32 v17, v17, v17
  v_cvt_pk_bf16_f32 v41, v41, v41
  v_lshlrev_b32 v17, 16, v17
  v_lshlrev_b32 v41, 16, v41
  v_sqrt_f32 v17, v17
  v_sqrt_f32 v41, v41
  v_pk_add_f32 v[8:9], v[8:9], v[16:17] op_sel_hi:[1,0] neg_lo:[0,1] neg_hi:[0,1]
  v_pk_add_f32 v[32:33], v[32:33], v[40:41] op_sel_hi:[1,0] neg_lo:[0,1] neg_hi:[0,1]
  v_pk_add_f32 v[10:11], v[10:11], v[16:17] op_sel_hi:[1,0] neg_lo:[0,1] neg_hi:[0,1]
  v_pk_add_f32 v[34:35], v[34:35], v[40:41] op_sel_hi:[1,0] neg_lo:[0,1] neg_hi:[0,1]
  v_pk_add_f32 v[12:13], v[12:13], v[16:17] op_sel_hi:[1,0] neg_lo:[0,1] neg_hi:[0,1]
  v_pk_add_f32 v[36:37], v[36:37], v[40:41] op_sel_hi:[1,0] neg_lo:[0,1] neg_hi:[0,1]
  v_pk_add_f32 v[14:15], v[14:15], v[16:17] op_sel_hi:[1,0] neg_lo:[0,1] neg_hi:[0,1]
  v_pk_add_f32 v[38:39], v[38:39], v[40:41] op_sel_hi:[1,0] neg_lo:[0,1] neg_hi:[0,1]
  v_cvt_pk_bf16_f32 v17, v17, v17
  v_cvt_pk_bf16_f32 v41, v41, v41
  v_lshlrev_b32 v17, 16, v17
  v_lshlrev_b32 v41, 16, v41
  v_rcp_f32 v18, v17
  v_rcp_f32 v42, v41
  v_cvt_pk_bf16_f32 v20, v8, v9
  v_cvt_pk_bf16_f32 v44, v32, v33
  v_cvt_pk_bf16_f32 v21, v10, v11
  v_cvt_pk_bf16_f32 v45, v34, v35
  v_cvt_pk_bf16_f32 v22, v12, v13
  v_cvt_pk_bf16_f32 v46, v36, v37
  v_cvt_pk_bf16_f32 v23, v14, v15
  v_cvt_pk_bf16_f32 v47, v38, v39
  v_lshlrev_b32 v8, 16, v20
  v_lshlrev_b32 v32, 16, v44
  v_and_b32 v9, 0xffff0000, v20
  v_and_b32 v33, 0xffff0000, v44
  v_lshlrev_b32 v10, 16, v21
  v_lshlrev_b32 v34, 16, v45
  v_and_b32 v11, 0xffff0000, v21
  v_and_b32 v35, 0xffff0000, v45
  v_lshlrev_b32 v12, 16, v22
  v_lshlrev_b32 v36, 16, v46
  v_and_b32 v13, 0xffff0000, v22
  v_and_b32 v37, 0xffff0000, v46
  v_lshlrev_b32 v14, 16, v23
  v_lshlrev_b32 v38, 16, v47
  v_and_b32 v15, 0xffff0000, v23
  v_and_b32 v39, 0xffff0000, v47
  v_pk_mul_f32 v[8:9], v[8:9], v[18:19] op_sel_hi:[1,0]
  v_pk_mul_f32 v[32:33], v[32:33], v[42:43] op_sel_hi:[1,0]
  v_pk_mul_f32 v[10:11], v[10:11], v[18:19] op_sel_hi:[1,0]
  v_pk_mul_f32 v[34:35], v[34:35], v[42:43] op_sel_hi:[1,0]
  v_pk_mul_f32 v[12:13], v[12:13], v[18:19] op_sel_hi:[1,0]
  v_pk_mul_f32 v[36:37], v[36:37], v[42:43] op_sel_hi:[1,0]
  v_pk_mul_f32 v[14:15], v[14:15], v[18:19] op_sel_hi:[1,0]
  v_pk_mul_f32 v[38:39], v[38:39], v[42:43] op_sel_hi:[1,0]
  v_cvt_pk_bf16_f32 v20, v8, v9
  v_cvt_pk_bf16_f32 v44, v32, v33
  v_cvt_pk_bf16_f32 v21, v10, v11
  v_cvt_pk_bf16_f32 v45, v34, v35
  v_cvt_pk_bf16_f32 v22, v12, v13
  v_cvt_pk_bf16_f32 v46, v36, v37
  v_cvt_pk_bf16_f32 v23, v14, v15
  v_cvt_pk_bf16_f32 v47, v38, v39
  s_waitcnt vmcnt(0)
  s_mov_b64 exec, 3
  buffer_store_dword v7, v4, s[4:7], s22 offen sc1
  s_mov_b64 exec, -1
  s_add_u32 s22, s22, 2048
  buffer_store_dwordx4 v[20:23], v1, s[4:7], s21 offen offset:0 sc1
  buffer_store_dwordx4 v[44:47], v1, s[4:7], s21 offen offset:1024 sc1
  s_add_u32 s21, s21, 65536
  v_lshlrev_b32 v8, 16, v192
  v_lshlrev_b32 v32, 16, v196
  v_and_b32 v9, 0xffff0000, v192
  v_and_b32 v33, 0xffff0000, v196
  v_lshlrev_b32 v10, 16, v193
  v_lshlrev_b32 v34, 16, v197
  v_and_b32 v11, 0xffff0000, v193
  v_and_b32 v35, 0xffff0000, v197
  v_lshlrev_b32 v12, 16, v194
  v_lshlrev_b32 v36, 16, v198
  v_and_b32 v13, 0xffff0000, v194
  v_and_b32 v37, 0xffff0000, v198
  v_lshlrev_b32 v14, 16, v195
  v_lshlrev_b32 v38, 16, v199
  v_and_b32 v15, 0xffff0000, v195
  v_and_b32 v39, 0xffff0000, v199
  v_pk_add_f32 v[18:19], v[8:9], v[10:11]
  v_pk_add_f32 v[42:43], v[32:33], v[34:35]
  v_pk_add_f32 v[20:21], v[12:13], v[14:15]
  v_pk_add_f32 v[44:45], v[36:37], v[38:39]
  v_pk_add_f32 v[18:19], v[18:19], v[20:21]
  v_pk_add_f32 v[42:43], v[42:43], v[44:45]
  v_add_f32 v16, v18, v19
  v_add_f32 v40, v42, v43
  s_nop 0
  v_add_f32_dpp v16, v16, v16 row_ror:1 row_mask:0xf bank_mask:0xf
  v_add_f32_dpp v40, v40, v40 row_ror:1 row_mask:0xf bank_mask:0xf
  s_nop 0
  v_add_f32_dpp v16, v16, v16 row_ror:2 row_mask:0xf bank_mask:0xf
  v_add_f32_dpp v40, v40, v40 row_ror:2 row_mask:0xf bank_mask:0xf
  s_nop 0
  v_add_f32_dpp v16, v16, v16 row_ror:4 row_mask:0xf bank_mask:0xf
  v_add_f32_dpp v40, v40, v40 row_ror:4 row_mask:0xf bank_mask:0xf
  s_nop 0
  v_add_f32_dpp v16, v16, v16 row_ror:8 row_mask:0xf bank_mask:0xf
  v_add_f32_dpp v40, v40, v40 row_ror:8 row_mask:0xf bank_mask:0xf
  v_mov_b32 v18, v16
  v_mov_b32 v42, v40
  s_nop 0
  v_permlane16_swap_b32 v16, v18
  v_permlane16_swap_b32 v40, v42
  v_add_f32 v16, v16, v18
  v_add_f32 v40, v40, v42
  v_mov_b32 v18, v16
  v_mov_b32 v42, v40
  s_nop 0
  v_permlane32_swap_b32 v16, v18
  v_permlane32_swap_b32 v40, v42
  v_add_f32 v16, v16, v18
  v_add_f32 v40, v40, v42
  v_mul_f32 v16, s26, v16
  v_mul_f32 v40, s26, v40
  v_pk_add_f32 v[64:65], v[8:9], v[16:17] op_sel_hi:[1,0] neg_lo:[0,1] neg_hi:[0,1]
  v_pk_add_f32 v[96:97], v[32:33], v[40:41] op_sel_hi:[1,0] neg_lo:[0,1] neg_hi:[0,1]
  v_pk_add_f32 v[66:67], v[10:11], v[16:17] op_sel_hi:[1,0] neg_lo:[0,1] neg_hi:[0,1]
  v_pk_add_f32 v[98:99], v[34:35], v[40:41] op_sel_hi:[1,0] neg_lo:[0,1] neg_hi:[0,1]
  v_pk_add_f32 v[68:69], v[12:13], v[16:17] op_sel_hi:[1,0] neg_lo:[0,1] neg_hi:[0,1]
  v_pk_add_f32 v[100:101], v[36:37], v[40:41] op_sel_hi:[1,0] neg_lo:[0,1] neg_hi:[0,1]
  v_pk_add_f32 v[70:71], v[14:15], v[16:17] op_sel_hi:[1,0] neg_lo:[0,1] neg_hi:[0,1]
  v_pk_add_f32 v[102:103], v[38:39], v[40:41] op_sel_hi:[1,0] neg_lo:[0,1] neg_hi:[0,1]
  v_pk_mul_f32 v[18:19], v[64:65], v[64:65]
  v_pk_mul_f32 v[42:43], v[96:97], v[96:97]
  v_pk_fma_f32 v[18:19], v[66:67], v[66:67], v[18:19]
  v_pk_fma_f32 v[42:43], v[98:99], v[98:99], v[42:43]
  v_pk_fma_f32 v[18:19], v[68:69], v[68:69], v[18:19]
  v_pk_fma_f32 v[42:43], v[100:101], v[100:101], v[42:43]
  v_pk_fma_f32 v[18:19], v[70:71], v[70:71], v[18:19]
  v_pk_fma_f32 v[42:43], v[102:103], v[102:103], v[42:43]
  v_add_f32 v17, v18, v19
  v_add_f32 v41, v42, v43
  v_cvt_pk_bf16_f32 v16, v16, v16
  v_cvt_pk_bf16_f32 v40, v40, v40
  v_lshlrev_b32 v16, 16, v16
  v_lshlrev_b32 v40, 16, v40
  v_add_f32_dpp v17, v17, v17 row_ror:1 row_mask:0xf bank_mask:0xf
  v_add_f32_dpp v41, v41, v41 row_ror:1 row_mask:0xf bank_mask:0xf
  s_nop 0
  v_add_f32_dpp v17, v17, v17 row_ror:2 row_mask:0xf bank_mask:0xf
  v_add_f32_dpp v41, v41, v41 row_ror:2 row_mask:0xf bank_mask:0xf
  s_nop 0
  v_add_f32_dpp v17, v17, v17 row_ror:4 row_mask:0xf bank_mask:0xf
  v_add_f32_dpp v41, v41, v41 row_ror:4 row_mask:0xf bank_mask:0xf
  s_nop 0
  v_add_f32_dpp v17, v17, v17 row_ror:8 row_mask:0xf bank_mask:0xf
  v_add_f32_dpp v41, v41, v41 row_ror:8 row_mask:0xf bank_mask:0xf
  v_mov_b32 v18, v17
  v_mov_b32 v42, v41
  s_nop 0
  v_permlane16_swap_b32 v17, v18
  v_permlane16_swap_b32 v41, v42
  v_add_f32 v17, v17, v18
  v_add_f32 v41, v41, v42
  v_mov_b32 v18, v17
  v_mov_b32 v42, v41
  s_nop 0
  v_permlane32_swap_b32 v17, v18
  v_permlane32_swap_b32 v41, v42
  v_add_f32 v17, v17, v18
  v_add_f32 v41, v41, v42
  v_mul_f32 v17, s26, v17
  v_mul_f32 v41, s26, v41
  v_cvt_pk_bf16_f32 v17, v17, v17
  v_cvt_pk_bf16_f32 v41, v41, v41
  v_lshlrev_b32 v17, 16, v17
  v_lshlrev_b32 v41, 16, v41
  v_add_f32 v17, s25, v17
  v_add_f32 v41, s25, v41
  v_cvt_pk_bf16_f32 v17, v17, v17
  v_cvt_pk_bf16_f32 v41, v41, v41
  v_lshlrev_b32 v17, 16, v17
  v_lshlrev_b32 v41, 16, v41
  v_sqrt_f32 v17, v17
  v_sqrt_f32 v41, v41
  v_pk_add_f32 v[8:9], v[8:9], v[16:17] op_sel_hi:[1,0] neg_lo:[0,1] neg_hi:[0,1]
  v_pk_add_f32 v[32:33], v[32:33], v[40:41] op_sel_hi:[1,0] neg_lo:[0,1] neg_hi:[0,1]
  v_pk_add_f32 v[10:11], v[10:11], v[16:17] op_sel_hi:[1,0] neg_lo:[0,1] neg_hi:[0,1]
  v_pk_add_f32 v[34:35], v[34:35], v[40:41] op_sel_hi:[1,0] neg_lo:[0,1] neg_hi:[0,1]
  v_pk_add_f32 v[12:13], v[12:13], v[16:17] op_sel_hi:[1,0] neg_lo:[0,1] neg_hi:[0,1]
  v_pk_add_f32 v[36:37], v[36:37], v[40:41] op_sel_hi:[1,0] neg_lo:[0,1] neg_hi:[0,1]
  v_pk_add_f32 v[14:15], v[14:15], v[16:17] op_sel_hi:[1,0] neg_lo:[0,1] neg_hi:[0,1]
  v_pk_add_f32 v[38:39], v[38:39], v[40:41] op_sel_hi:[1,0] neg_lo:[0,1] neg_hi:[0,1]
  v_cvt_pk_bf16_f32 v17, v17, v17
  v_cvt_pk_bf16_f32 v41, v41, v41
  v_lshlrev_b32 v17, 16, v17
  v_lshlrev_b32 v41, 16, v41
  v_rcp_f32 v18, v17
  v_rcp_f32 v42, v41
  v_cvt_pk_bf16_f32 v20, v8, v9
  v_cvt_pk_bf16_f32 v44, v32, v33
  v_cvt_pk_bf16_f32 v21, v10, v11
  v_cvt_pk_bf16_f32 v45, v34, v35
  v_cvt_pk_bf16_f32 v22, v12, v13
  v_cvt_pk_bf16_f32 v46, v36, v37
  v_cvt_pk_bf16_f32 v23, v14, v15
  v_cvt_pk_bf16_f32 v47, v38, v39
  v_lshlrev_b32 v8, 16, v20
  v_lshlrev_b32 v32, 16, v44
  v_and_b32 v9, 0xffff0000, v20
  v_and_b32 v33, 0xffff0000, v44
  v_lshlrev_b32 v10, 16, v21
  v_lshlrev_b32 v34, 16, v45
  v_and_b32 v11, 0xffff0000, v21
  v_and_b32 v35, 0xffff0000, v45
  v_lshlrev_b32 v12, 16, v22
  v_lshlrev_b32 v36, 16, v46
  v_and_b32 v13, 0xffff0000, v22
  v_and_b32 v37, 0xffff0000, v46
  v_lshlrev_b32 v14, 16, v23
  v_lshlrev_b32 v38, 16, v47
  v_and_b32 v15, 0xffff0000, v23
  v_and_b32 v39, 0xffff0000, v47
  v_pk_mul_f32 v[8:9], v[8:9], v[18:19] op_sel_hi:[1,0]
  v_pk_mul_f32 v[32:33], v[32:33], v[42:43] op_sel_hi:[1,0]
  v_pk_mul_f32 v[10:11], v[10:11], v[18:19] op_sel_hi:[1,0]
  v_pk_mul_f32 v[34:35], v[34:35], v[42:43] op_sel_hi:[1,0]
  v_pk_mul_f32 v[12:13], v[12:13], v[18:19] op_sel_hi:[1,0]
  v_pk_mul_f32 v[36:37], v[36:37], v[42:43] op_sel_hi:[1,0]
  v_pk_mul_f32 v[14:15], v[14:15], v[18:19] op_sel_hi:[1,0]
  v_pk_mul_f32 v[38:39], v[38:39], v[42:43] op_sel_hi:[1,0]
  v_cvt_pk_bf16_f32 v20, v8, v9
  v_cvt_pk_bf16_f32 v44, v32, v33
  v_cvt_pk_bf16_f32 v21, v10, v11
  v_cvt_pk_bf16_f32 v45, v34, v35
  v_cvt_pk_bf16_f32 v22, v12, v13
  v_cvt_pk_bf16_f32 v46, v36, v37
  v_cvt_pk_bf16_f32 v23, v14, v15
  v_cvt_pk_bf16_f32 v47, v38, v39
  s_waitcnt vmcnt(0)
  s_mov_b64 exec, 3
  buffer_store_dword v7, v4, s[4:7], s22 offen sc1
  s_mov_b64 exec, -1
  s_add_u32 s22, s22, 2048
  buffer_store_dwordx4 v[20:23], v1, s[4:7], s21 offen offset:0 sc1
  buffer_store_dwordx4 v[44:47], v1, s[4:7], s21 offen offset:1024 sc1
  s_add_u32 s21, s21, 65536
  v_lshlrev_b32 v8, 16, v200
  v_lshlrev_b32 v32, 16, v204
  v_and_b32 v9, 0xffff0000, v200
  v_and_b32 v33, 0xffff0000, v204
  v_lshlrev_b32 v10, 16, v201
  v_lshlrev_b32 v34, 16, v205
  v_and_b32 v11, 0xffff0000, v201
  v_and_b32 v35, 0xffff0000, v205
  v_lshlrev_b32 v12, 16, v202
  v_lshlrev_b32 v36, 16, v206
  v_and_b32 v13, 0xffff0000, v202
  v_and_b32 v37, 0xffff0000, v206
  v_lshlrev_b32 v14, 16, v203
  v_lshlrev_b32 v38, 16, v207
  v_and_b32 v15, 0xffff0000, v203
  v_and_b32 v39, 0xffff0000, v207
  v_pk_add_f32 v[18:19], v[8:9], v[10:11]
  v_pk_add_f32 v[42:43], v[32:33], v[34:35]
  v_pk_add_f32 v[20:21], v[12:13], v[14:15]
  v_pk_add_f32 v[44:45], v[36:37], v[38:39]
  v_pk_add_f32 v[18:19], v[18:19], v[20:21]
  v_pk_add_f32 v[42:43], v[42:43], v[44:45]
  v_add_f32 v16, v18, v19
  v_add_f32 v40, v42, v43
  s_nop 0
  v_add_f32_dpp v16, v16, v16 row_ror:1 row_mask:0xf bank_mask:0xf
  v_add_f32_dpp v40, v40, v40 row_ror:1 row_mask:0xf bank_mask:0xf
  s_nop 0
  v_add_f32_dpp v16, v16, v16 row_ror:2 row_mask:0xf bank_mask:0xf
  v_add_f32_dpp v40, v40, v40 row_ror:2 row_mask:0xf bank_mask:0xf
  s_nop 0
  v_add_f32_dpp v16, v16, v16 row_ror:4 row_mask:0xf bank_mask:0xf
  v_add_f32_dpp v40, v40, v40 row_ror:4 row_mask:0xf bank_mask:0xf
  s_nop 0
  v_add_f32_dpp v16, v16, v16 row_ror:8 row_mask:0xf bank_mask:0xf
  v_add_f32_dpp v40, v40, v40 row_ror:8 row_mask:0xf bank_mask:0xf
  v_mov_b32 v18, v16
  v_mov_b32 v42, v40
  s_nop 0
  v_permlane16_swap_b32 v16, v18
  v_permlane16_swap_b32 v40, v42
  v_add_f32 v16, v16, v18
  v_add_f32 v40, v40, v42
  v_mov_b32 v18, v16
  v_mov_b32 v42, v40
  s_nop 0
  v_permlane32_swap_b32 v16, v18
  v_permlane32_swap_b32 v40, v42
  v_add_f32 v16, v16, v18
  v_add_f32 v40, v40, v42
  v_mul_f32 v16, s26, v16
  v_mul_f32 v40, s26, v40
  v_pk_add_f32 v[64:65], v[8:9], v[16:17] op_sel_hi:[1,0] neg_lo:[0,1] neg_hi:[0,1]
  v_pk_add_f32 v[96:97], v[32:33], v[40:41] op_sel_hi:[1,0] neg_lo:[0,1] neg_hi:[0,1]
  v_pk_add_f32 v[66:67], v[10:11], v[16:17] op_sel_hi:[1,0] neg_lo:[0,1] neg_hi:[0,1]
  v_pk_add_f32 v[98:99], v[34:35], v[40:41] op_sel_hi:[1,0] neg_lo:[0,1] neg_hi:[0,1]
  v_pk_add_f32 v[68:69], v[12:13], v[16:17] op_sel_hi:[1,0] neg_lo:[0,1] neg_hi:[0,1]
  v_pk_add_f32 v[100:101], v[36:37], v[40:41] op_sel_hi:[1,0] neg_lo:[0,1] neg_hi:[0,1]
  v_pk_add_f32 v[70:71], v[14:15], v[16:17] op_sel_hi:[1,0] neg_lo:[0,1] neg_hi:[0,1]
  v_pk_add_f32 v[102:103], v[38:39], v[40:41] op_sel_hi:[1,0] neg_lo:[0,1] neg_hi:[0,1]
  v_pk_mul_f32 v[18:19], v[64:65], v[64:65]
  v_pk_mul_f32 v[42:43], v[96:97], v[96:97]
  v_pk_fma_f32 v[18:19], v[66:67], v[66:67], v[18:19]
  v_pk_fma_f32 v[42:43], v[98:99], v[98:99], v[42:43]
  v_pk_fma_f32 v[18:19], v[68:69], v[68:69], v[18:19]
  v_pk_fma_f32 v[42:43], v[100:101], v[100:101], v[42:43]
  v_pk_fma_f32 v[18:19], v[70:71], v[70:71], v[18:19]
  v_pk_fma_f32 v[42:43], v[102:103], v[102:103], v[42:43]
  v_add_f32 v17, v18, v19
  v_add_f32 v41, v42, v43
  v_cvt_pk_bf16_f32 v16, v16, v16
  v_cvt_pk_bf16_f32 v40, v40, v40
  v_lshlrev_b32 v16, 16, v16
  v_lshlrev_b32 v40, 16, v40
  v_add_f32_dpp v17, v17, v17 row_ror:1 row_mask:0xf bank_mask:0xf
  v_add_f32_dpp v41, v41, v41 row_ror:1 row_mask:0xf bank_mask:0xf
  s_nop 0
  v_add_f32_dpp v17, v17, v17 row_ror:2 row_mask:0xf bank_mask:0xf
  v_add_f32_dpp v41, v41, v41 row_ror:2 row_mask:0xf bank_mask:0xf
  s_nop 0
  v_add_f32_dpp v17, v17, v17 row_ror:4 row_mask:0xf bank_mask:0xf
  v_add_f32_dpp v41, v41, v41 row_ror:4 row_mask:0xf bank_mask:0xf
  s_nop 0
  v_add_f32_dpp v17, v17, v17 row_ror:8 row_mask:0xf bank_mask:0xf
  v_add_f32_dpp v41, v41, v41 row_ror:8 row_mask:0xf bank_mask:0xf
  v_mov_b32 v18, v17
  v_mov_b32 v42, v41
  s_nop 0
  v_permlane16_swap_b32 v17, v18
  v_permlane16_swap_b32 v41, v42
  v_add_f32 v17, v17, v18
  v_add_f32 v41, v41, v42
  v_mov_b32 v18, v17
  v_mov_b32 v42, v41
  s_nop 0
  v_permlane32_swap_b32 v17, v18
  v_permlane32_swap_b32 v41, v42
  v_add_f32 v17, v17, v18
  v_add_f32 v41, v41, v42
  v_mul_f32 v17, s26, v17
  v_mul_f32 v41, s26, v41
  v_cvt_pk_bf16_f32 v17, v17, v17
  v_cvt_pk_bf16_f32 v41, v41, v41
  v_lshlrev_b32 v17, 16, v17
  v_lshlrev_b32 v41, 16, v41
  v_add_f32 v17, s25, v17
  v_add_f32 v41, s25, v41
  v_cvt_pk_bf16_f32 v17, v17, v17
  v_cvt_pk_bf16_f32 v41, v41, v41
  v_lshlrev_b32 v17, 16, v17
  v_lshlrev_b32 v41, 16, v41
  v_sqrt_f32 v17, v17
  v_sqrt_f32 v41, v41
  v_pk_add_f32 v[8:9], v[8:9], v[16:17] op_sel_hi:[1,0] neg_lo:[0,1] neg_hi:[0,1]
  v_pk_add_f32 v[32:33], v[32:33], v[40:41] op_sel_hi:[1,0] neg_lo:[0,1] neg_hi:[0,1]
  v_pk_add_f32 v[10:11], v[10:11], v[16:17] op_sel_hi:[1,0] neg_lo:[0,1] neg_hi:[0,1]
  v_pk_add_f32 v[34:35], v[34:35], v[40:41] op_sel_hi:[1,0] neg_lo:[0,1] neg_hi:[0,1]
  v_pk_add_f32 v[12:13], v[12:13], v[16:17] op_sel_hi:[1,0] neg_lo:[0,1] neg_hi:[0,1]
  v_pk_add_f32 v[36:37], v[36:37], v[40:41] op_sel_hi:[1,0] neg_lo:[0,1] neg_hi:[0,1]
  v_pk_add_f32 v[14:15], v[14:15], v[16:17] op_sel_hi:[1,0] neg_lo:[0,1] neg_hi:[0,1]
  v_pk_add_f32 v[38:39], v[38:39], v[40:41] op_sel_hi:[1,0] neg_lo:[0,1] neg_hi:[0,1]
  v_cvt_pk_bf16_f32 v17, v17, v17
  v_cvt_pk_bf16_f32 v41, v41, v41
  v_lshlrev_b32 v17, 16, v17
  v_lshlrev_b32 v41, 16, v41
  v_rcp_f32 v18, v17
  v_rcp_f32 v42, v41
  v_cvt_pk_bf16_f32 v20, v8, v9
  v_cvt_pk_bf16_f32 v44, v32, v33
  v_cvt_pk_bf16_f32 v21, v10, v11
  v_cvt_pk_bf16_f32 v45, v34, v35
  v_cvt_pk_bf16_f32 v22, v12, v13
  v_cvt_pk_bf16_f32 v46, v36, v37
  v_cvt_pk_bf16_f32 v23, v14, v15
  v_cvt_pk_bf16_f32 v47, v38, v39
  v_lshlrev_b32 v8, 16, v20
  v_lshlrev_b32 v32, 16, v44
  v_and_b32 v9, 0xffff0000, v20
  v_and_b32 v33, 0xffff0000, v44
  v_lshlrev_b32 v10, 16, v21
  v_lshlrev_b32 v34, 16, v45
  v_and_b32 v11, 0xffff0000, v21
  v_and_b32 v35, 0xffff0000, v45
  v_lshlrev_b32 v12, 16, v22
  v_lshlrev_b32 v36, 16, v46
  v_and_b32 v13, 0xffff0000, v22
  v_and_b32 v37, 0xffff0000, v46
  v_lshlrev_b32 v14, 16, v23
  v_lshlrev_b32 v38, 16, v47
  v_and_b32 v15, 0xffff0000, v23
  v_and_b32 v39, 0xffff0000, v47
  v_pk_mul_f32 v[8:9], v[8:9], v[18:19] op_sel_hi:[1,0]
  v_pk_mul_f32 v[32:33], v[32:33], v[42:43] op_sel_hi:[1,0]
  v_pk_mul_f32 v[10:11], v[10:11], v[18:19] op_sel_hi:[1,0]
  v_pk_mul_f32 v[34:35], v[34:35], v[42:43] op_sel_hi:[1,0]
  v_pk_mul_f32 v[12:13], v[12:13], v[18:19] op_sel_hi:[1,0]
  v_pk_mul_f32 v[36:37], v[36:37], v[42:43] op_sel_hi:[1,0]
  v_pk_mul_f32 v[14:15], v[14:15], v[18:19] op_sel_hi:[1,0]
  v_pk_mul_f32 v[38:39], v[38:39], v[42:43] op_sel_hi:[1,0]
  v_cvt_pk_bf16_f32 v20, v8, v9
  v_cvt_pk_bf16_f32 v44, v32, v33
  v_cvt_pk_bf16_f32 v21, v10, v11
  v_cvt_pk_bf16_f32 v45, v34, v35
  v_cvt_pk_bf16_f32 v22, v12, v13
  v_cvt_pk_bf16_f32 v46, v36, v37
  v_cvt_pk_bf16_f32 v23, v14, v15
  v_cvt_pk_bf16_f32 v47, v38, v39
  s_waitcnt vmcnt(0)
  s_mov_b64 exec, 3
  buffer_store_dword v7, v4, s[4:7], s22 offen sc1
  s_mov_b64 exec, -1
  s_add_u32 s22, s22, 2048
  buffer_store_dwordx4 v[20:23], v1, s[4:7], s21 offen offset:0 sc1
  buffer_store_dwordx4 v[44:47], v1, s[4:7], s21 offen offset:1024 sc1
  s_add_u32 s21, s21, 65536
  v_lshlrev_b32 v8, 16, v208
  v_lshlrev_b32 v32, 16, v212
  v_and_b32 v9, 0xffff0000, v208
  v_and_b32 v33, 0xffff0000, v212
  v_lshlrev_b32 v10, 16, v209
  v_lshlrev_b32 v34, 16, v213
  v_and_b32 v11, 0xffff0000, v209
  v_and_b32 v35, 0xffff0000, v213
  v_lshlrev_b32 v12, 16, v210
  v_lshlrev_b32 v36, 16, v214
  v_and_b32 v13, 0xffff0000, v210
  v_and_b32 v37, 0xffff0000, v214
  v_lshlrev_b32 v14, 16, v211
  v_lshlrev_b32 v38, 16, v215
  v_and_b32 v15, 0xffff0000, v211
  v_and_b32 v39, 0xffff0000, v215
  v_pk_add_f32 v[18:19], v[8:9], v[10:11]
  v_pk_add_f32 v[42:43], v[32:33], v[34:35]
  v_pk_add_f32 v[20:21], v[12:13], v[14:15]
  v_pk_add_f32 v[44:45], v[36:37], v[38:39]
  v_pk_add_f32 v[18:19], v[18:19], v[20:21]
  v_pk_add_f32 v[42:43], v[42:43], v[44:45]
  v_add_f32 v16, v18, v19
  v_add_f32 v40, v42, v43
  s_nop 0
  v_add_f32_dpp v16, v16, v16 row_ror:1 row_mask:0xf bank_mask:0xf
  v_add_f32_dpp v40, v40, v40 row_ror:1 row_mask:0xf bank_mask:0xf
  s_nop 0
  v_add_f32_dpp v16, v16, v16 row_ror:2 row_mask:0xf bank_mask:0xf
  v_add_f32_dpp v40, v40, v40 row_ror:2 row_mask:0xf bank_mask:0xf
  s_nop 0
  v_add_f32_dpp v16, v16, v16 row_ror:4 row_mask:0xf bank_mask:0xf
  v_add_f32_dpp v40, v40, v40 row_ror:4 row_mask:0xf bank_mask:0xf
  s_nop 0
  v_add_f32_dpp v16, v16, v16 row_ror:8 row_mask:0xf bank_mask:0xf
  v_add_f32_dpp v40, v40, v40 row_ror:8 row_mask:0xf bank_mask:0xf
  v_mov_b32 v18, v16
  v_mov_b32 v42, v40
  s_nop 0
  v_permlane16_swap_b32 v16, v18
  v_permlane16_swap_b32 v40, v42
  v_add_f32 v16, v16, v18
  v_add_f32 v40, v40, v42
  v_mov_b32 v18, v16
  v_mov_b32 v42, v40
  s_nop 0
  v_permlane32_swap_b32 v16, v18
  v_permlane32_swap_b32 v40, v42
  v_add_f32 v16, v16, v18
  v_add_f32 v40, v40, v42
  v_mul_f32 v16, s26, v16
  v_mul_f32 v40, s26, v40
  v_pk_add_f32 v[64:65], v[8:9], v[16:17] op_sel_hi:[1,0] neg_lo:[0,1] neg_hi:[0,1]
  v_pk_add_f32 v[96:97], v[32:33], v[40:41] op_sel_hi:[1,0] neg_lo:[0,1] neg_hi:[0,1]
  v_pk_add_f32 v[66:67], v[10:11], v[16:17] op_sel_hi:[1,0] neg_lo:[0,1] neg_hi:[0,1]
  v_pk_add_f32 v[98:99], v[34:35], v[40:41] op_sel_hi:[1,0] neg_lo:[0,1] neg_hi:[0,1]
  v_pk_add_f32 v[68:69], v[12:13], v[16:17] op_sel_hi:[1,0] neg_lo:[0,1] neg_hi:[0,1]
  v_pk_add_f32 v[100:101], v[36:37], v[40:41] op_sel_hi:[1,0] neg_lo:[0,1] neg_hi:[0,1]
  v_pk_add_f32 v[70:71], v[14:15], v[16:17] op_sel_hi:[1,0] neg_lo:[0,1] neg_hi:[0,1]
  v_pk_add_f32 v[102:103], v[38:39], v[40:41] op_sel_hi:[1,0] neg_lo:[0,1] neg_hi:[0,1]
  v_pk_mul_f32 v[18:19], v[64:65], v[64:65]
  v_pk_mul_f32 v[42:43], v[96:97], v[96:97]
  v_pk_fma_f32 v[18:19], v[66:67], v[66:67], v[18:19]
  v_pk_fma_f32 v[42:43], v[98:99], v[98:99], v[42:43]
  v_pk_fma_f32 v[18:19], v[68:69], v[68:69], v[18:19]
  v_pk_fma_f32 v[42:43], v[100:101], v[100:101], v[42:43]
  v_pk_fma_f32 v[18:19], v[70:71], v[70:71], v[18:19]
  v_pk_fma_f32 v[42:43], v[102:103], v[102:103], v[42:43]
  v_add_f32 v17, v18, v19
  v_add_f32 v41, v42, v43
  v_cvt_pk_bf16_f32 v16, v16, v16
  v_cvt_pk_bf16_f32 v40, v40, v40
  v_lshlrev_b32 v16, 16, v16
  v_lshlrev_b32 v40, 16, v40
  v_add_f32_dpp v17, v17, v17 row_ror:1 row_mask:0xf bank_mask:0xf
  v_add_f32_dpp v41, v41, v41 row_ror:1 row_mask:0xf bank_mask:0xf
  s_nop 0
  v_add_f32_dpp v17, v17, v17 row_ror:2 row_mask:0xf bank_mask:0xf
  v_add_f32_dpp v41, v41, v41 row_ror:2 row_mask:0xf bank_mask:0xf
  s_nop 0
  v_add_f32_dpp v17, v17, v17 row_ror:4 row_mask:0xf bank_mask:0xf
  v_add_f32_dpp v41, v41, v41 row_ror:4 row_mask:0xf bank_mask:0xf
  s_nop 0
  v_add_f32_dpp v17, v17, v17 row_ror:8 row_mask:0xf bank_mask:0xf
  v_add_f32_dpp v41, v41, v41 row_ror:8 row_mask:0xf bank_mask:0xf
  v_mov_b32 v18, v17
  v_mov_b32 v42, v41
  s_nop 0
  v_permlane16_swap_b32 v17, v18
  v_permlane16_swap_b32 v41, v42
  v_add_f32 v17, v17, v18
  v_add_f32 v41, v41, v42
  v_mov_b32 v18, v17
  v_mov_b32 v42, v41
  s_nop 0
  v_permlane32_swap_b32 v17, v18
  v_permlane32_swap_b32 v41, v42
  v_add_f32 v17, v17, v18
  v_add_f32 v41, v41, v42
  v_mul_f32 v17, s26, v17
  v_mul_f32 v41, s26, v41
  v_cvt_pk_bf16_f32 v17, v17, v17
  v_cvt_pk_bf16_f32 v41, v41, v41
  v_lshlrev_b32 v17, 16, v17
  v_lshlrev_b32 v41, 16, v41
  v_add_f32 v17, s25, v17
  v_add_f32 v41, s25, v41
  v_cvt_pk_bf16_f32 v17, v17, v17
  v_cvt_pk_bf16_f32 v41, v41, v41
  v_lshlrev_b32 v17, 16, v17
  v_lshlrev_b32 v41, 16, v41
  v_sqrt_f32 v17, v17
  v_sqrt_f32 v41, v41
  v_pk_add_f32 v[8:9], v[8:9], v[16:17] op_sel_hi:[1,0] neg_lo:[0,1] neg_hi:[0,1]
  v_pk_add_f32 v[32:33], v[32:33], v[40:41] op_sel_hi:[1,0] neg_lo:[0,1] neg_hi:[0,1]
  v_pk_add_f32 v[10:11], v[10:11], v[16:17] op_sel_hi:[1,0] neg_lo:[0,1] neg_hi:[0,1]
  v_pk_add_f32 v[34:35], v[34:35], v[40:41] op_sel_hi:[1,0] neg_lo:[0,1] neg_hi:[0,1]
  v_pk_add_f32 v[12:13], v[12:13], v[16:17] op_sel_hi:[1,0] neg_lo:[0,1] neg_hi:[0,1]
  v_pk_add_f32 v[36:37], v[36:37], v[40:41] op_sel_hi:[1,0] neg_lo:[0,1] neg_hi:[0,1]
  v_pk_add_f32 v[14:15], v[14:15], v[16:17] op_sel_hi:[1,0] neg_lo:[0,1] neg_hi:[0,1]
  v_pk_add_f32 v[38:39], v[38:39], v[40:41] op_sel_hi:[1,0] neg_lo:[0,1] neg_hi:[0,1]
  v_cvt_pk_bf16_f32 v17, v17, v17
  v_cvt_pk_bf16_f32 v41, v41, v41
  v_lshlrev_b32 v17, 16, v17
  v_lshlrev_b32 v41, 16, v41
  v_rcp_f32 v18, v17
  v_rcp_f32 v42, v41
  v_cvt_pk_bf16_f32 v20, v8, v9
  v_cvt_pk_bf16_f32 v44, v32, v33
  v_cvt_pk_bf16_f32 v21, v10, v11
  v_cvt_pk_bf16_f32 v45, v34, v35
  v_cvt_pk_bf16_f32 v22, v12, v13
  v_cvt_pk_bf16_f32 v46, v36, v37
  v_cvt_pk_bf16_f32 v23, v14, v15
  v_cvt_pk_bf16_f32 v47, v38, v39
  v_lshlrev_b32 v8, 16, v20
  v_lshlrev_b32 v32, 16, v44
  v_and_b32 v9, 0xffff0000, v20
  v_and_b32 v33, 0xffff0000, v44
  v_lshlrev_b32 v10, 16, v21
  v_lshlrev_b32 v34, 16, v45
  v_and_b32 v11, 0xffff0000, v21
  v_and_b32 v35, 0xffff0000, v45
  v_lshlrev_b32 v12, 16, v22
  v_lshlrev_b32 v36, 16, v46
  v_and_b32 v13, 0xffff0000, v22
  v_and_b32 v37, 0xffff0000, v46
  v_lshlrev_b32 v14, 16, v23
  v_lshlrev_b32 v38, 16, v47
  v_and_b32 v15, 0xffff0000, v23
  v_and_b32 v39, 0xffff0000, v47
  v_pk_mul_f32 v[8:9], v[8:9], v[18:19] op_sel_hi:[1,0]
  v_pk_mul_f32 v[32:33], v[32:33], v[42:43] op_sel_hi:[1,0]
  v_pk_mul_f32 v[10:11], v[10:11], v[18:19] op_sel_hi:[1,0]
  v_pk_mul_f32 v[34:35], v[34:35], v[42:43] op_sel_hi:[1,0]
  v_pk_mul_f32 v[12:13], v[12:13], v[18:19] op_sel_hi:[1,0]
  v_pk_mul_f32 v[36:37], v[36:37], v[42:43] op_sel_hi:[1,0]
  v_pk_mul_f32 v[14:15], v[14:15], v[18:19] op_sel_hi:[1,0]
  v_pk_mul_f32 v[38:39], v[38:39], v[42:43] op_sel_hi:[1,0]
  v_cvt_pk_bf16_f32 v20, v8, v9
  v_cvt_pk_bf16_f32 v44, v32, v33
  v_cvt_pk_bf16_f32 v21, v10, v11
  v_cvt_pk_bf16_f32 v45, v34, v35
  v_cvt_pk_bf16_f32 v22, v12, v13
  v_cvt_pk_bf16_f32 v46, v36, v37
  v_cvt_pk_bf16_f32 v23, v14, v15
  v_cvt_pk_bf16_f32 v47, v38, v39
  s_waitcnt vmcnt(0)
  s_mov_b64 exec, 3
  buffer_store_dword v7, v4, s[4:7], s22 offen sc1
  s_mov_b64 exec, -1
  s_add_u32 s22, s22, 2048
  buffer_store_dwordx4 v[20:23], v1, s[4:7], s21 offen offset:0 sc1
  buffer_store_dwordx4 v[44:47], v1, s[4:7], s21 offen offset:1024 sc1
  s_add_u32 s21, s21, 65536
  v_lshlrev_b32 v8, 16, v216
  v_lshlrev_b32 v32, 16, v220
  v_and_b32 v9, 0xffff0000, v216
  v_and_b32 v33, 0xffff0000, v220
  v_lshlrev_b32 v10, 16, v217
  v_lshlrev_b32 v34, 16, v221
  v_and_b32 v11, 0xffff0000, v217
  v_and_b32 v35, 0xffff0000, v221
  v_lshlrev_b32 v12, 16, v218
  v_lshlrev_b32 v36, 16, v222
  v_and_b32 v13, 0xffff0000, v218
  v_and_b32 v37, 0xffff0000, v222
  v_lshlrev_b32 v14, 16, v219
  v_lshlrev_b32 v38, 16, v223
  v_and_b32 v15, 0xffff0000, v219
  v_and_b32 v39, 0xffff0000, v223
  v_pk_add_f32 v[18:19], v[8:9], v[10:11]
  v_pk_add_f32 v[42:43], v[32:33], v[34:35]
  v_pk_add_f32 v[20:21], v[12:13], v[14:15]
  v_pk_add_f32 v[44:45], v[36:37], v[38:39]
  v_pk_add_f32 v[18:19], v[18:19], v[20:21]
  v_pk_add_f32 v[42:43], v[42:43], v[44:45]
  v_add_f32 v16, v18, v19
  v_add_f32 v40, v42, v43
  s_nop 0
  v_add_f32_dpp v16, v16, v16 row_ror:1 row_mask:0xf bank_mask:0xf
  v_add_f32_dpp v40, v40, v40 row_ror:1 row_mask:0xf bank_mask:0xf
  s_nop 0
  v_add_f32_dpp v16, v16, v16 row_ror:2 row_mask:0xf bank_mask:0xf
  v_add_f32_dpp v40, v40, v40 row_ror:2 row_mask:0xf bank_mask:0xf
  s_nop 0
  v_add_f32_dpp v16, v16, v16 row_ror:4 row_mask:0xf bank_mask:0xf
  v_add_f32_dpp v40, v40, v40 row_ror:4 row_mask:0xf bank_mask:0xf
  s_nop 0
  v_add_f32_dpp v16, v16, v16 row_ror:8 row_mask:0xf bank_mask:0xf
  v_add_f32_dpp v40, v40, v40 row_ror:8 row_mask:0xf bank_mask:0xf
  v_mov_b32 v18, v16
  v_mov_b32 v42, v40
  s_nop 0
  v_permlane16_swap_b32 v16, v18
  v_permlane16_swap_b32 v40, v42
  v_add_f32 v16, v16, v18
  v_add_f32 v40, v40, v42
  v_mov_b32 v18, v16
  v_mov_b32 v42, v40
  s_nop 0
  v_permlane32_swap_b32 v16, v18
  v_permlane32_swap_b32 v40, v42
  v_add_f32 v16, v16, v18
  v_add_f32 v40, v40, v42
  v_mul_f32 v16, s26, v16
  v_mul_f32 v40, s26, v40
  v_pk_add_f32 v[64:65], v[8:9], v[16:17] op_sel_hi:[1,0] neg_lo:[0,1] neg_hi:[0,1]
  v_pk_add_f32 v[96:97], v[32:33], v[40:41] op_sel_hi:[1,0] neg_lo:[0,1] neg_hi:[0,1]
  v_pk_add_f32 v[66:67], v[10:11], v[16:17] op_sel_hi:[1,0] neg_lo:[0,1] neg_hi:[0,1]
  v_pk_add_f32 v[98:99], v[34:35], v[40:41] op_sel_hi:[1,0] neg_lo:[0,1] neg_hi:[0,1]
  v_pk_add_f32 v[68:69], v[12:13], v[16:17] op_sel_hi:[1,0] neg_lo:[0,1] neg_hi:[0,1]
  v_pk_add_f32 v[100:101], v[36:37], v[40:41] op_sel_hi:[1,0] neg_lo:[0,1] neg_hi:[0,1]
  v_pk_add_f32 v[70:71], v[14:15], v[16:17] op_sel_hi:[1,0] neg_lo:[0,1] neg_hi:[0,1]
  v_pk_add_f32 v[102:103], v[38:39], v[40:41] op_sel_hi:[1,0] neg_lo:[0,1] neg_hi:[0,1]
  v_pk_mul_f32 v[18:19], v[64:65], v[64:65]
  v_pk_mul_f32 v[42:43], v[96:97], v[96:97]
  v_pk_fma_f32 v[18:19], v[66:67], v[66:67], v[18:19]
  v_pk_fma_f32 v[42:43], v[98:99], v[98:99], v[42:43]
  v_pk_fma_f32 v[18:19], v[68:69], v[68:69], v[18:19]
  v_pk_fma_f32 v[42:43], v[100:101], v[100:101], v[42:43]
  v_pk_fma_f32 v[18:19], v[70:71], v[70:71], v[18:19]
  v_pk_fma_f32 v[42:43], v[102:103], v[102:103], v[42:43]
  v_add_f32 v17, v18, v19
  v_add_f32 v41, v42, v43
  v_cvt_pk_bf16_f32 v16, v16, v16
  v_cvt_pk_bf16_f32 v40, v40, v40
  v_lshlrev_b32 v16, 16, v16
  v_lshlrev_b32 v40, 16, v40
  v_add_f32_dpp v17, v17, v17 row_ror:1 row_mask:0xf bank_mask:0xf
  v_add_f32_dpp v41, v41, v41 row_ror:1 row_mask:0xf bank_mask:0xf
  s_nop 0
  v_add_f32_dpp v17, v17, v17 row_ror:2 row_mask:0xf bank_mask:0xf
  v_add_f32_dpp v41, v41, v41 row_ror:2 row_mask:0xf bank_mask:0xf
  s_nop 0
  v_add_f32_dpp v17, v17, v17 row_ror:4 row_mask:0xf bank_mask:0xf
  v_add_f32_dpp v41, v41, v41 row_ror:4 row_mask:0xf bank_mask:0xf
  s_nop 0
  v_add_f32_dpp v17, v17, v17 row_ror:8 row_mask:0xf bank_mask:0xf
  v_add_f32_dpp v41, v41, v41 row_ror:8 row_mask:0xf bank_mask:0xf
  v_mov_b32 v18, v17
  v_mov_b32 v42, v41
  s_nop 0
  v_permlane16_swap_b32 v17, v18
  v_permlane16_swap_b32 v41, v42
  v_add_f32 v17, v17, v18
  v_add_f32 v41, v41, v42
  v_mov_b32 v18, v17
  v_mov_b32 v42, v41
  s_nop 0
  v_permlane32_swap_b32 v17, v18
  v_permlane32_swap_b32 v41, v42
  v_add_f32 v17, v17, v18
  v_add_f32 v41, v41, v42
  v_mul_f32 v17, s26, v17
  v_mul_f32 v41, s26, v41
  v_cvt_pk_bf16_f32 v17, v17, v17
  v_cvt_pk_bf16_f32 v41, v41, v41
  v_lshlrev_b32 v17, 16, v17
  v_lshlrev_b32 v41, 16, v41
  v_add_f32 v17, s25, v17
  v_add_f32 v41, s25, v41
  v_cvt_pk_bf16_f32 v17, v17, v17
  v_cvt_pk_bf16_f32 v41, v41, v41
  v_lshlrev_b32 v17, 16, v17
  v_lshlrev_b32 v41, 16, v41
  v_sqrt_f32 v17, v17
  v_sqrt_f32 v41, v41
  v_pk_add_f32 v[8:9], v[8:9], v[16:17] op_sel_hi:[1,0] neg_lo:[0,1] neg_hi:[0,1]
  v_pk_add_f32 v[32:33], v[32:33], v[40:41] op_sel_hi:[1,0] neg_lo:[0,1] neg_hi:[0,1]
  v_pk_add_f32 v[10:11], v[10:11], v[16:17] op_sel_hi:[1,0] neg_lo:[0,1] neg_hi:[0,1]
  v_pk_add_f32 v[34:35], v[34:35], v[40:41] op_sel_hi:[1,0] neg_lo:[0,1] neg_hi:[0,1]
  v_pk_add_f32 v[12:13], v[12:13], v[16:17] op_sel_hi:[1,0] neg_lo:[0,1] neg_hi:[0,1]
  v_pk_add_f32 v[36:37], v[36:37], v[40:41] op_sel_hi:[1,0] neg_lo:[0,1] neg_hi:[0,1]
  v_pk_add_f32 v[14:15], v[14:15], v[16:17] op_sel_hi:[1,0] neg_lo:[0,1] neg_hi:[0,1]
  v_pk_add_f32 v[38:39], v[38:39], v[40:41] op_sel_hi:[1,0] neg_lo:[0,1] neg_hi:[0,1]
  v_cvt_pk_bf16_f32 v17, v17, v17
  v_cvt_pk_bf16_f32 v41, v41, v41
  v_lshlrev_b32 v17, 16, v17
  v_lshlrev_b32 v41, 16, v41
  v_rcp_f32 v18, v17
  v_rcp_f32 v42, v41
  v_cvt_pk_bf16_f32 v20, v8, v9
  v_cvt_pk_bf16_f32 v44, v32, v33
  v_cvt_pk_bf16_f32 v21, v10, v11
  v_cvt_pk_bf16_f32 v45, v34, v35
  v_cvt_pk_bf16_f32 v22, v12, v13
  v_cvt_pk_bf16_f32 v46, v36, v37
  v_cvt_pk_bf16_f32 v23, v14, v15
  v_cvt_pk_bf16_f32 v47, v38, v39
  v_lshlrev_b32 v8, 16, v20
  v_lshlrev_b32 v32, 16, v44
  v_and_b32 v9, 0xffff0000, v20
  v_and_b32 v33, 0xffff0000, v44
  v_lshlrev_b32 v10, 16, v21
  v_lshlrev_b32 v34, 16, v45
  v_and_b32 v11, 0xffff0000, v21
  v_and_b32 v35, 0xffff0000, v45
  v_lshlrev_b32 v12, 16, v22
  v_lshlrev_b32 v36, 16, v46
  v_and_b32 v13, 0xffff0000, v22
  v_and_b32 v37, 0xffff0000, v46
  v_lshlrev_b32 v14, 16, v23
  v_lshlrev_b32 v38, 16, v47
  v_and_b32 v15, 0xffff0000, v23
  v_and_b32 v39, 0xffff0000, v47
  v_pk_mul_f32 v[8:9], v[8:9], v[18:19] op_sel_hi:[1,0]
  v_pk_mul_f32 v[32:33], v[32:33], v[42:43] op_sel_hi:[1,0]
  v_pk_mul_f32 v[10:11], v[10:11], v[18:19] op_sel_hi:[1,0]
  v_pk_mul_f32 v[34:35], v[34:35], v[42:43] op_sel_hi:[1,0]
  v_pk_mul_f32 v[12:13], v[12:13], v[18:19] op_sel_hi:[1,0]
  v_pk_mul_f32 v[36:37], v[36:37], v[42:43] op_sel_hi:[1,0]
  v_pk_mul_f32 v[14:15], v[14:15], v[18:19] op_sel_hi:[1,0]
  v_pk_mul_f32 v[38:39], v[38:39], v[42:43] op_sel_hi:[1,0]
  v_cvt_pk_bf16_f32 v20, v8, v9
  v_cvt_pk_bf16_f32 v44, v32, v33
  v_cvt_pk_bf16_f32 v21, v10, v11
  v_cvt_pk_bf16_f32 v45, v34, v35
  v_cvt_pk_bf16_f32 v22, v12, v13
  v_cvt_pk_bf16_f32 v46, v36, v37
  v_cvt_pk_bf16_f32 v23, v14, v15
  v_cvt_pk_bf16_f32 v47, v38, v39
  s_waitcnt vmcnt(0)
  s_mov_b64 exec, 3
  buffer_store_dword v7, v4, s[4:7], s22 offen sc1
  s_mov_b64 exec, -1
  s_add_u32 s22, s22, 2048
  buffer_store_dwordx4 v[20:23], v1, s[4:7], s21 offen offset:0 sc1
  buffer_store_dwordx4 v[44:47], v1, s[4:7], s21 offen offset:1024 sc1
  s_add_u32 s21, s21, 65536
  v_lshlrev_b32 v8, 16, v224
  v_lshlrev_b32 v32, 16, v228
  v_and_b32 v9, 0xffff0000, v224
  v_and_b32 v33, 0xffff0000, v228
  v_lshlrev_b32 v10, 16, v225
  v_lshlrev_b32 v34, 16, v229
  v_and_b32 v11, 0xffff0000, v225
  v_and_b32 v35, 0xffff0000, v229
  v_lshlrev_b32 v12, 16, v226
  v_lshlrev_b32 v36, 16, v230
  v_and_b32 v13, 0xffff0000, v226
  v_and_b32 v37, 0xffff0000, v230
  v_lshlrev_b32 v14, 16, v227
  v_lshlrev_b32 v38, 16, v231
  v_and_b32 v15, 0xffff0000, v227
  v_and_b32 v39, 0xffff0000, v231
  v_pk_add_f32 v[18:19], v[8:9], v[10:11]
  v_pk_add_f32 v[42:43], v[32:33], v[34:35]
  v_pk_add_f32 v[20:21], v[12:13], v[14:15]
  v_pk_add_f32 v[44:45], v[36:37], v[38:39]
  v_pk_add_f32 v[18:19], v[18:19], v[20:21]
  v_pk_add_f32 v[42:43], v[42:43], v[44:45]
  v_add_f32 v16, v18, v19
  v_add_f32 v40, v42, v43
  s_nop 0
  v_add_f32_dpp v16, v16, v16 row_ror:1 row_mask:0xf bank_mask:0xf
  v_add_f32_dpp v40, v40, v40 row_ror:1 row_mask:0xf bank_mask:0xf
  s_nop 0
  v_add_f32_dpp v16, v16, v16 row_ror:2 row_mask:0xf bank_mask:0xf
  v_add_f32_dpp v40, v40, v40 row_ror:2 row_mask:0xf bank_mask:0xf
  s_nop 0
  v_add_f32_dpp v16, v16, v16 row_ror:4 row_mask:0xf bank_mask:0xf
  v_add_f32_dpp v40, v40, v40 row_ror:4 row_mask:0xf bank_mask:0xf
  s_nop 0
  v_add_f32_dpp v16, v16, v16 row_ror:8 row_mask:0xf bank_mask:0xf
  v_add_f32_dpp v40, v40, v40 row_ror:8 row_mask:0xf bank_mask:0xf
  v_mov_b32 v18, v16
  v_mov_b32 v42, v40
  s_nop 0
  v_permlane16_swap_b32 v16, v18
  v_permlane16_swap_b32 v40, v42
  v_add_f32 v16, v16, v18
  v_add_f32 v40, v40, v42
  v_mov_b32 v18, v16
  v_mov_b32 v42, v40
  s_nop 0
  v_permlane32_swap_b32 v16, v18
  v_permlane32_swap_b32 v40, v42
  v_add_f32 v16, v16, v18
  v_add_f32 v40, v40, v42
  v_mul_f32 v16, s26, v16
  v_mul_f32 v40, s26, v40
  v_pk_add_f32 v[64:65], v[8:9], v[16:17] op_sel_hi:[1,0] neg_lo:[0,1] neg_hi:[0,1]
  v_pk_add_f32 v[96:97], v[32:33], v[40:41] op_sel_hi:[1,0] neg_lo:[0,1] neg_hi:[0,1]
  v_pk_add_f32 v[66:67], v[10:11], v[16:17] op_sel_hi:[1,0] neg_lo:[0,1] neg_hi:[0,1]
  v_pk_add_f32 v[98:99], v[34:35], v[40:41] op_sel_hi:[1,0] neg_lo:[0,1] neg_hi:[0,1]
  v_pk_add_f32 v[68:69], v[12:13], v[16:17] op_sel_hi:[1,0] neg_lo:[0,1] neg_hi:[0,1]
  v_pk_add_f32 v[100:101], v[36:37], v[40:41] op_sel_hi:[1,0] neg_lo:[0,1] neg_hi:[0,1]
  v_pk_add_f32 v[70:71], v[14:15], v[16:17] op_sel_hi:[1,0] neg_lo:[0,1] neg_hi:[0,1]
  v_pk_add_f32 v[102:103], v[38:39], v[40:41] op_sel_hi:[1,0] neg_lo:[0,1] neg_hi:[0,1]
  v_pk_mul_f32 v[18:19], v[64:65], v[64:65]
  v_pk_mul_f32 v[42:43], v[96:97], v[96:97]
  v_pk_fma_f32 v[18:19], v[66:67], v[66:67], v[18:19]
  v_pk_fma_f32 v[42:43], v[98:99], v[98:99], v[42:43]
  v_pk_fma_f32 v[18:19], v[68:69], v[68:69], v[18:19]
  v_pk_fma_f32 v[42:43], v[100:101], v[100:101], v[42:43]
  v_pk_fma_f32 v[18:19], v[70:71], v[70:71], v[18:19]
  v_pk_fma_f32 v[42:43], v[102:103], v[102:103], v[42:43]
  v_add_f32 v17, v18, v19
  v_add_f32 v41, v42, v43
  v_cvt_pk_bf16_f32 v16, v16, v16
  v_cvt_pk_bf16_f32 v40, v40, v40
  v_lshlrev_b32 v16, 16, v16
  v_lshlrev_b32 v40, 16, v40
  v_add_f32_dpp v17, v17, v17 row_ror:1 row_mask:0xf bank_mask:0xf
  v_add_f32_dpp v41, v41, v41 row_ror:1 row_mask:0xf bank_mask:0xf
  s_nop 0
  v_add_f32_dpp v17, v17, v17 row_ror:2 row_mask:0xf bank_mask:0xf
  v_add_f32_dpp v41, v41, v41 row_ror:2 row_mask:0xf bank_mask:0xf
  s_nop 0
  v_add_f32_dpp v17, v17, v17 row_ror:4 row_mask:0xf bank_mask:0xf
  v_add_f32_dpp v41, v41, v41 row_ror:4 row_mask:0xf bank_mask:0xf
  s_nop 0
  v_add_f32_dpp v17, v17, v17 row_ror:8 row_mask:0xf bank_mask:0xf
  v_add_f32_dpp v41, v41, v41 row_ror:8 row_mask:0xf bank_mask:0xf
  v_mov_b32 v18, v17
  v_mov_b32 v42, v41
  s_nop 0
  v_permlane16_swap_b32 v17, v18
  v_permlane16_swap_b32 v41, v42
  v_add_f32 v17, v17, v18
  v_add_f32 v41, v41, v42
  v_mov_b32 v18, v17
  v_mov_b32 v42, v41
  s_nop 0
  v_permlane32_swap_b32 v17, v18
  v_permlane32_swap_b32 v41, v42
  v_add_f32 v17, v17, v18
  v_add_f32 v41, v41, v42
  v_mul_f32 v17, s26, v17
  v_mul_f32 v41, s26, v41
  v_cvt_pk_bf16_f32 v17, v17, v17
  v_cvt_pk_bf16_f32 v41, v41, v41
  v_lshlrev_b32 v17, 16, v17
  v_lshlrev_b32 v41, 16, v41
  v_add_f32 v17, s25, v17
  v_add_f32 v41, s25, v41
  v_cvt_pk_bf16_f32 v17, v17, v17
  v_cvt_pk_bf16_f32 v41, v41, v41
  v_lshlrev_b32 v17, 16, v17
  v_lshlrev_b32 v41, 16, v41
  v_sqrt_f32 v17, v17
  v_sqrt_f32 v41, v41
  v_pk_add_f32 v[8:9], v[8:9], v[16:17] op_sel_hi:[1,0] neg_lo:[0,1] neg_hi:[0,1]
  v_pk_add_f32 v[32:33], v[32:33], v[40:41] op_sel_hi:[1,0] neg_lo:[0,1] neg_hi:[0,1]
  v_pk_add_f32 v[10:11], v[10:11], v[16:17] op_sel_hi:[1,0] neg_lo:[0,1] neg_hi:[0,1]
  v_pk_add_f32 v[34:35], v[34:35], v[40:41] op_sel_hi:[1,0] neg_lo:[0,1] neg_hi:[0,1]
  v_pk_add_f32 v[12:13], v[12:13], v[16:17] op_sel_hi:[1,0] neg_lo:[0,1] neg_hi:[0,1]
  v_pk_add_f32 v[36:37], v[36:37], v[40:41] op_sel_hi:[1,0] neg_lo:[0,1] neg_hi:[0,1]
  v_pk_add_f32 v[14:15], v[14:15], v[16:17] op_sel_hi:[1,0] neg_lo:[0,1] neg_hi:[0,1]
  v_pk_add_f32 v[38:39], v[38:39], v[40:41] op_sel_hi:[1,0] neg_lo:[0,1] neg_hi:[0,1]
  v_cvt_pk_bf16_f32 v17, v17, v17
  v_cvt_pk_bf16_f32 v41, v41, v41
  v_lshlrev_b32 v17, 16, v17
  v_lshlrev_b32 v41, 16, v41
  v_rcp_f32 v18, v17
  v_rcp_f32 v42, v41
  v_cvt_pk_bf16_f32 v20, v8, v9
  v_cvt_pk_bf16_f32 v44, v32, v33
  v_cvt_pk_bf16_f32 v21, v10, v11
  v_cvt_pk_bf16_f32 v45, v34, v35
  v_cvt_pk_bf16_f32 v22, v12, v13
  v_cvt_pk_bf16_f32 v46, v36, v37
  v_cvt_pk_bf16_f32 v23, v14, v15
  v_cvt_pk_bf16_f32 v47, v38, v39
  v_lshlrev_b32 v8, 16, v20
  v_lshlrev_b32 v32, 16, v44
  v_and_b32 v9, 0xffff0000, v20
  v_and_b32 v33, 0xffff0000, v44
  v_lshlrev_b32 v10, 16, v21
  v_lshlrev_b32 v34, 16, v45
  v_and_b32 v11, 0xffff0000, v21
  v_and_b32 v35, 0xffff0000, v45
  v_lshlrev_b32 v12, 16, v22
  v_lshlrev_b32 v36, 16, v46
  v_and_b32 v13, 0xffff0000, v22
  v_and_b32 v37, 0xffff0000, v46
  v_lshlrev_b32 v14, 16, v23
  v_lshlrev_b32 v38, 16, v47
  v_and_b32 v15, 0xffff0000, v23
  v_and_b32 v39, 0xffff0000, v47
  v_pk_mul_f32 v[8:9], v[8:9], v[18:19] op_sel_hi:[1,0]
  v_pk_mul_f32 v[32:33], v[32:33], v[42:43] op_sel_hi:[1,0]
  v_pk_mul_f32 v[10:11], v[10:11], v[18:19] op_sel_hi:[1,0]
  v_pk_mul_f32 v[34:35], v[34:35], v[42:43] op_sel_hi:[1,0]
  v_pk_mul_f32 v[12:13], v[12:13], v[18:19] op_sel_hi:[1,0]
  v_pk_mul_f32 v[36:37], v[36:37], v[42:43] op_sel_hi:[1,0]
  v_pk_mul_f32 v[14:15], v[14:15], v[18:19] op_sel_hi:[1,0]
  v_pk_mul_f32 v[38:39], v[38:39], v[42:43] op_sel_hi:[1,0]
  v_cvt_pk_bf16_f32 v20, v8, v9
  v_cvt_pk_bf16_f32 v44, v32, v33
  v_cvt_pk_bf16_f32 v21, v10, v11
  v_cvt_pk_bf16_f32 v45, v34, v35
  v_cvt_pk_bf16_f32 v22, v12, v13
  v_cvt_pk_bf16_f32 v46, v36, v37
  v_cvt_pk_bf16_f32 v23, v14, v15
  v_cvt_pk_bf16_f32 v47, v38, v39
  s_waitcnt vmcnt(0)
  s_mov_b64 exec, 3
  buffer_store_dword v7, v4, s[4:7], s22 offen sc1
  s_mov_b64 exec, -1
  s_add_u32 s22, s22, 2048
  buffer_store_dwordx4 v[20:23], v1, s[4:7], s21 offen offset:0 sc1
  buffer_store_dwordx4 v[44:47], v1, s[4:7], s21 offen offset:1024 sc1
  s_add_u32 s21, s21, 65536
  v_lshlrev_b32 v8, 16, v232
  v_lshlrev_b32 v32, 16, v236
  v_and_b32 v9, 0xffff0000, v232
  v_and_b32 v33, 0xffff0000, v236
  v_lshlrev_b32 v10, 16, v233
  v_lshlrev_b32 v34, 16, v237
  v_and_b32 v11, 0xffff0000, v233
  v_and_b32 v35, 0xffff0000, v237
  v_lshlrev_b32 v12, 16, v234
  v_lshlrev_b32 v36, 16, v238
  v_and_b32 v13, 0xffff0000, v234
  v_and_b32 v37, 0xffff0000, v238
  v_lshlrev_b32 v14, 16, v235
  v_lshlrev_b32 v38, 16, v239
  v_and_b32 v15, 0xffff0000, v235
  v_and_b32 v39, 0xffff0000, v239
  v_pk_add_f32 v[18:19], v[8:9], v[10:11]
  v_pk_add_f32 v[42:43], v[32:33], v[34:35]
  v_pk_add_f32 v[20:21], v[12:13], v[14:15]
  v_pk_add_f32 v[44:45], v[36:37], v[38:39]
  v_pk_add_f32 v[18:19], v[18:19], v[20:21]
  v_pk_add_f32 v[42:43], v[42:43], v[44:45]
  v_add_f32 v16, v18, v19
  v_add_f32 v40, v42, v43
  s_nop 0
  v_add_f32_dpp v16, v16, v16 row_ror:1 row_mask:0xf bank_mask:0xf
  v_add_f32_dpp v40, v40, v40 row_ror:1 row_mask:0xf bank_mask:0xf
  s_nop 0
  v_add_f32_dpp v16, v16, v16 row_ror:2 row_mask:0xf bank_mask:0xf
  v_add_f32_dpp v40, v40, v40 row_ror:2 row_mask:0xf bank_mask:0xf
  s_nop 0
  v_add_f32_dpp v16, v16, v16 row_ror:4 row_mask:0xf bank_mask:0xf
  v_add_f32_dpp v40, v40, v40 row_ror:4 row_mask:0xf bank_mask:0xf
  s_nop 0
  v_add_f32_dpp v16, v16, v16 row_ror:8 row_mask:0xf bank_mask:0xf
  v_add_f32_dpp v40, v40, v40 row_ror:8 row_mask:0xf bank_mask:0xf
  v_mov_b32 v18, v16
  v_mov_b32 v42, v40
  s_nop 0
  v_permlane16_swap_b32 v16, v18
  v_permlane16_swap_b32 v40, v42
  v_add_f32 v16, v16, v18
  v_add_f32 v40, v40, v42
  v_mov_b32 v18, v16
  v_mov_b32 v42, v40
  s_nop 0
  v_permlane32_swap_b32 v16, v18
  v_permlane32_swap_b32 v40, v42
  v_add_f32 v16, v16, v18
  v_add_f32 v40, v40, v42
  v_mul_f32 v16, s26, v16
  v_mul_f32 v40, s26, v40
  v_pk_add_f32 v[64:65], v[8:9], v[16:17] op_sel_hi:[1,0] neg_lo:[0,1] neg_hi:[0,1]
  v_pk_add_f32 v[96:97], v[32:33], v[40:41] op_sel_hi:[1,0] neg_lo:[0,1] neg_hi:[0,1]
  v_pk_add_f32 v[66:67], v[10:11], v[16:17] op_sel_hi:[1,0] neg_lo:[0,1] neg_hi:[0,1]
  v_pk_add_f32 v[98:99], v[34:35], v[40:41] op_sel_hi:[1,0] neg_lo:[0,1] neg_hi:[0,1]
  v_pk_add_f32 v[68:69], v[12:13], v[16:17] op_sel_hi:[1,0] neg_lo:[0,1] neg_hi:[0,1]
  v_pk_add_f32 v[100:101], v[36:37], v[40:41] op_sel_hi:[1,0] neg_lo:[0,1] neg_hi:[0,1]
  v_pk_add_f32 v[70:71], v[14:15], v[16:17] op_sel_hi:[1,0] neg_lo:[0,1] neg_hi:[0,1]
  v_pk_add_f32 v[102:103], v[38:39], v[40:41] op_sel_hi:[1,0] neg_lo:[0,1] neg_hi:[0,1]
  v_pk_mul_f32 v[18:19], v[64:65], v[64:65]
  v_pk_mul_f32 v[42:43], v[96:97], v[96:97]
  v_pk_fma_f32 v[18:19], v[66:67], v[66:67], v[18:19]
  v_pk_fma_f32 v[42:43], v[98:99], v[98:99], v[42:43]
  v_pk_fma_f32 v[18:19], v[68:69], v[68:69], v[18:19]
  v_pk_fma_f32 v[42:43], v[100:101], v[100:101], v[42:43]
  v_pk_fma_f32 v[18:19], v[70:71], v[70:71], v[18:19]
  v_pk_fma_f32 v[42:43], v[102:103], v[102:103], v[42:43]
  v_add_f32 v17, v18, v19
  v_add_f32 v41, v42, v43
  v_cvt_pk_bf16_f32 v16, v16, v16
  v_cvt_pk_bf16_f32 v40, v40, v40
  v_lshlrev_b32 v16, 16, v16
  v_lshlrev_b32 v40, 16, v40
  v_add_f32_dpp v17, v17, v17 row_ror:1 row_mask:0xf bank_mask:0xf
  v_add_f32_dpp v41, v41, v41 row_ror:1 row_mask:0xf bank_mask:0xf
  s_nop 0
  v_add_f32_dpp v17, v17, v17 row_ror:2 row_mask:0xf bank_mask:0xf
  v_add_f32_dpp v41, v41, v41 row_ror:2 row_mask:0xf bank_mask:0xf
  s_nop 0
  v_add_f32_dpp v17, v17, v17 row_ror:4 row_mask:0xf bank_mask:0xf
  v_add_f32_dpp v41, v41, v41 row_ror:4 row_mask:0xf bank_mask:0xf
  s_nop 0
  v_add_f32_dpp v17, v17, v17 row_ror:8 row_mask:0xf bank_mask:0xf
  v_add_f32_dpp v41, v41, v41 row_ror:8 row_mask:0xf bank_mask:0xf
  v_mov_b32 v18, v17
  v_mov_b32 v42, v41
  s_nop 0
  v_permlane16_swap_b32 v17, v18
  v_permlane16_swap_b32 v41, v42
  v_add_f32 v17, v17, v18
  v_add_f32 v41, v41, v42
  v_mov_b32 v18, v17
  v_mov_b32 v42, v41
  s_nop 0
  v_permlane32_swap_b32 v17, v18
  v_permlane32_swap_b32 v41, v42
  v_add_f32 v17, v17, v18
  v_add_f32 v41, v41, v42
  v_mul_f32 v17, s26, v17
  v_mul_f32 v41, s26, v41
  v_cvt_pk_bf16_f32 v17, v17, v17
  v_cvt_pk_bf16_f32 v41, v41, v41
  v_lshlrev_b32 v17, 16, v17
  v_lshlrev_b32 v41, 16, v41
  v_add_f32 v17, s25, v17
  v_add_f32 v41, s25, v41
  v_cvt_pk_bf16_f32 v17, v17, v17
  v_cvt_pk_bf16_f32 v41, v41, v41
  v_lshlrev_b32 v17, 16, v17
  v_lshlrev_b32 v41, 16, v41
  v_sqrt_f32 v17, v17
  v_sqrt_f32 v41, v41
  v_pk_add_f32 v[8:9], v[8:9], v[16:17] op_sel_hi:[1,0] neg_lo:[0,1] neg_hi:[0,1]
  v_pk_add_f32 v[32:33], v[32:33], v[40:41] op_sel_hi:[1,0] neg_lo:[0,1] neg_hi:[0,1]
  v_pk_add_f32 v[10:11], v[10:11], v[16:17] op_sel_hi:[1,0] neg_lo:[0,1] neg_hi:[0,1]
  v_pk_add_f32 v[34:35], v[34:35], v[40:41] op_sel_hi:[1,0] neg_lo:[0,1] neg_hi:[0,1]
  v_pk_add_f32 v[12:13], v[12:13], v[16:17] op_sel_hi:[1,0] neg_lo:[0,1] neg_hi:[0,1]
  v_pk_add_f32 v[36:37], v[36:37], v[40:41] op_sel_hi:[1,0] neg_lo:[0,1] neg_hi:[0,1]
  v_pk_add_f32 v[14:15], v[14:15], v[16:17] op_sel_hi:[1,0] neg_lo:[0,1] neg_hi:[0,1]
  v_pk_add_f32 v[38:39], v[38:39], v[40:41] op_sel_hi:[1,0] neg_lo:[0,1] neg_hi:[0,1]
  v_cvt_pk_bf16_f32 v17, v17, v17
  v_cvt_pk_bf16_f32 v41, v41, v41
  v_lshlrev_b32 v17, 16, v17
  v_lshlrev_b32 v41, 16, v41
  v_rcp_f32 v18, v17
  v_rcp_f32 v42, v41
  v_cvt_pk_bf16_f32 v20, v8, v9
  v_cvt_pk_bf16_f32 v44, v32, v33
  v_cvt_pk_bf16_f32 v21, v10, v11
  v_cvt_pk_bf16_f32 v45, v34, v35
  v_cvt_pk_bf16_f32 v22, v12, v13
  v_cvt_pk_bf16_f32 v46, v36, v37
  v_cvt_pk_bf16_f32 v23, v14, v15
  v_cvt_pk_bf16_f32 v47, v38, v39
  v_lshlrev_b32 v8, 16, v20
  v_lshlrev_b32 v32, 16, v44
  v_and_b32 v9, 0xffff0000, v20
  v_and_b32 v33, 0xffff0000, v44
  v_lshlrev_b32 v10, 16, v21
  v_lshlrev_b32 v34, 16, v45
  v_and_b32 v11, 0xffff0000, v21
  v_and_b32 v35, 0xffff0000, v45
  v_lshlrev_b32 v12, 16, v22
  v_lshlrev_b32 v36, 16, v46
  v_and_b32 v13, 0xffff0000, v22
  v_and_b32 v37, 0xffff0000, v46
  v_lshlrev_b32 v14, 16, v23
  v_lshlrev_b32 v38, 16, v47
  v_and_b32 v15, 0xffff0000, v23
  v_and_b32 v39, 0xffff0000, v47
  v_pk_mul_f32 v[8:9], v[8:9], v[18:19] op_sel_hi:[1,0]
  v_pk_mul_f32 v[32:33], v[32:33], v[42:43] op_sel_hi:[1,0]
  v_pk_mul_f32 v[10:11], v[10:11], v[18:19] op_sel_hi:[1,0]
  v_pk_mul_f32 v[34:35], v[34:35], v[42:43] op_sel_hi:[1,0]
  v_pk_mul_f32 v[12:13], v[12:13], v[18:19] op_sel_hi:[1,0]
  v_pk_mul_f32 v[36:37], v[36:37], v[42:43] op_sel_hi:[1,0]
  v_pk_mul_f32 v[14:15], v[14:15], v[18:19] op_sel_hi:[1,0]
  v_pk_mul_f32 v[38:39], v[38:39], v[42:43] op_sel_hi:[1,0]
  v_cvt_pk_bf16_f32 v20, v8, v9
  v_cvt_pk_bf16_f32 v44, v32, v33
  v_cvt_pk_bf16_f32 v21, v10, v11
  v_cvt_pk_bf16_f32 v45, v34, v35
  v_cvt_pk_bf16_f32 v22, v12, v13
  v_cvt_pk_bf16_f32 v46, v36, v37
  v_cvt_pk_bf16_f32 v23, v14, v15
  v_cvt_pk_bf16_f32 v47, v38, v39
  s_waitcnt vmcnt(0)
  s_mov_b64 exec, 3
  buffer_store_dword v7, v4, s[4:7], s22 offen sc1
  s_mov_b64 exec, -1
  s_add_u32 s22, s22, 2048
  buffer_store_dwordx4 v[20:23], v1, s[4:7], s21 offen offset:0 sc1
  buffer_store_dwordx4 v[44:47], v1, s[4:7], s21 offen offset:1024 sc1
  s_add_u32 s21, s21, 65536
  v_lshlrev_b32 v8, 16, v240
  v_lshlrev_b32 v32, 16, v244
  v_and_b32 v9, 0xffff0000, v240
  v_and_b32 v33, 0xffff0000, v244
  v_lshlrev_b32 v10, 16, v241
  v_lshlrev_b32 v34, 16, v245
  v_and_b32 v11, 0xffff0000, v241
  v_and_b32 v35, 0xffff0000, v245
  v_lshlrev_b32 v12, 16, v242
  v_lshlrev_b32 v36, 16, v246
  v_and_b32 v13, 0xffff0000, v242
  v_and_b32 v37, 0xffff0000, v246
  v_lshlrev_b32 v14, 16, v243
  v_lshlrev_b32 v38, 16, v247
  v_and_b32 v15, 0xffff0000, v243
  v_and_b32 v39, 0xffff0000, v247
  v_pk_add_f32 v[18:19], v[8:9], v[10:11]
  v_pk_add_f32 v[42:43], v[32:33], v[34:35]
  v_pk_add_f32 v[20:21], v[12:13], v[14:15]
  v_pk_add_f32 v[44:45], v[36:37], v[38:39]
  v_pk_add_f32 v[18:19], v[18:19], v[20:21]
  v_pk_add_f32 v[42:43], v[42:43], v[44:45]
  v_add_f32 v16, v18, v19
  v_add_f32 v40, v42, v43
  s_nop 0
  v_add_f32_dpp v16, v16, v16 row_ror:1 row_mask:0xf bank_mask:0xf
  v_add_f32_dpp v40, v40, v40 row_ror:1 row_mask:0xf bank_mask:0xf
  s_nop 0
  v_add_f32_dpp v16, v16, v16 row_ror:2 row_mask:0xf bank_mask:0xf
  v_add_f32_dpp v40, v40, v40 row_ror:2 row_mask:0xf bank_mask:0xf
  s_nop 0
  v_add_f32_dpp v16, v16, v16 row_ror:4 row_mask:0xf bank_mask:0xf
  v_add_f32_dpp v40, v40, v40 row_ror:4 row_mask:0xf bank_mask:0xf
  s_nop 0
  v_add_f32_dpp v16, v16, v16 row_ror:8 row_mask:0xf bank_mask:0xf
  v_add_f32_dpp v40, v40, v40 row_ror:8 row_mask:0xf bank_mask:0xf
  v_mov_b32 v18, v16
  v_mov_b32 v42, v40
  s_nop 0
  v_permlane16_swap_b32 v16, v18
  v_permlane16_swap_b32 v40, v42
  v_add_f32 v16, v16, v18
  v_add_f32 v40, v40, v42
  v_mov_b32 v18, v16
  v_mov_b32 v42, v40
  s_nop 0
  v_permlane32_swap_b32 v16, v18
  v_permlane32_swap_b32 v40, v42
  v_add_f32 v16, v16, v18
  v_add_f32 v40, v40, v42
  v_mul_f32 v16, s26, v16
  v_mul_f32 v40, s26, v40
  v_pk_add_f32 v[64:65], v[8:9], v[16:17] op_sel_hi:[1,0] neg_lo:[0,1] neg_hi:[0,1]
  v_pk_add_f32 v[96:97], v[32:33], v[40:41] op_sel_hi:[1,0] neg_lo:[0,1] neg_hi:[0,1]
  v_pk_add_f32 v[66:67], v[10:11], v[16:17] op_sel_hi:[1,0] neg_lo:[0,1] neg_hi:[0,1]
  v_pk_add_f32 v[98:99], v[34:35], v[40:41] op_sel_hi:[1,0] neg_lo:[0,1] neg_hi:[0,1]
  v_pk_add_f32 v[68:69], v[12:13], v[16:17] op_sel_hi:[1,0] neg_lo:[0,1] neg_hi:[0,1]
  v_pk_add_f32 v[100:101], v[36:37], v[40:41] op_sel_hi:[1,0] neg_lo:[0,1] neg_hi:[0,1]
  v_pk_add_f32 v[70:71], v[14:15], v[16:17] op_sel_hi:[1,0] neg_lo:[0,1] neg_hi:[0,1]
  v_pk_add_f32 v[102:103], v[38:39], v[40:41] op_sel_hi:[1,0] neg_lo:[0,1] neg_hi:[0,1]
  v_pk_mul_f32 v[18:19], v[64:65], v[64:65]
  v_pk_mul_f32 v[42:43], v[96:97], v[96:97]
  v_pk_fma_f32 v[18:19], v[66:67], v[66:67], v[18:19]
  v_pk_fma_f32 v[42:43], v[98:99], v[98:99], v[42:43]
  v_pk_fma_f32 v[18:19], v[68:69], v[68:69], v[18:19]
  v_pk_fma_f32 v[42:43], v[100:101], v[100:101], v[42:43]
  v_pk_fma_f32 v[18:19], v[70:71], v[70:71], v[18:19]
  v_pk_fma_f32 v[42:43], v[102:103], v[102:103], v[42:43]
  v_add_f32 v17, v18, v19
  v_add_f32 v41, v42, v43
  v_cvt_pk_bf16_f32 v16, v16, v16
  v_cvt_pk_bf16_f32 v40, v40, v40
  v_lshlrev_b32 v16, 16, v16
  v_lshlrev_b32 v40, 16, v40
  v_add_f32_dpp v17, v17, v17 row_ror:1 row_mask:0xf bank_mask:0xf
  v_add_f32_dpp v41, v41, v41 row_ror:1 row_mask:0xf bank_mask:0xf
  s_nop 0
  v_add_f32_dpp v17, v17, v17 row_ror:2 row_mask:0xf bank_mask:0xf
  v_add_f32_dpp v41, v41, v41 row_ror:2 row_mask:0xf bank_mask:0xf
  s_nop 0
  v_add_f32_dpp v17, v17, v17 row_ror:4 row_mask:0xf bank_mask:0xf
  v_add_f32_dpp v41, v41, v41 row_ror:4 row_mask:0xf bank_mask:0xf
  s_nop 0
  v_add_f32_dpp v17, v17, v17 row_ror:8 row_mask:0xf bank_mask:0xf
  v_add_f32_dpp v41, v41, v41 row_ror:8 row_mask:0xf bank_mask:0xf
  v_mov_b32 v18, v17
  v_mov_b32 v42, v41
  s_nop 0
  v_permlane16_swap_b32 v17, v18
  v_permlane16_swap_b32 v41, v42
  v_add_f32 v17, v17, v18
  v_add_f32 v41, v41, v42
  v_mov_b32 v18, v17
  v_mov_b32 v42, v41
  s_nop 0
  v_permlane32_swap_b32 v17, v18
  v_permlane32_swap_b32 v41, v42
  v_add_f32 v17, v17, v18
  v_add_f32 v41, v41, v42
  v_mul_f32 v17, s26, v17
  v_mul_f32 v41, s26, v41
  v_cvt_pk_bf16_f32 v17, v17, v17
  v_cvt_pk_bf16_f32 v41, v41, v41
  v_lshlrev_b32 v17, 16, v17
  v_lshlrev_b32 v41, 16, v41
  v_add_f32 v17, s25, v17
  v_add_f32 v41, s25, v41
  v_cvt_pk_bf16_f32 v17, v17, v17
  v_cvt_pk_bf16_f32 v41, v41, v41
  v_lshlrev_b32 v17, 16, v17
  v_lshlrev_b32 v41, 16, v41
  v_sqrt_f32 v17, v17
  v_sqrt_f32 v41, v41
  v_pk_add_f32 v[8:9], v[8:9], v[16:17] op_sel_hi:[1,0] neg_lo:[0,1] neg_hi:[0,1]
  v_pk_add_f32 v[32:33], v[32:33], v[40:41] op_sel_hi:[1,0] neg_lo:[0,1] neg_hi:[0,1]
  v_pk_add_f32 v[10:11], v[10:11], v[16:17] op_sel_hi:[1,0] neg_lo:[0,1] neg_hi:[0,1]
  v_pk_add_f32 v[34:35], v[34:35], v[40:41] op_sel_hi:[1,0] neg_lo:[0,1] neg_hi:[0,1]
  v_pk_add_f32 v[12:13], v[12:13], v[16:17] op_sel_hi:[1,0] neg_lo:[0,1] neg_hi:[0,1]
  v_pk_add_f32 v[36:37], v[36:37], v[40:41] op_sel_hi:[1,0] neg_lo:[0,1] neg_hi:[0,1]
  v_pk_add_f32 v[14:15], v[14:15], v[16:17] op_sel_hi:[1,0] neg_lo:[0,1] neg_hi:[0,1]
  v_pk_add_f32 v[38:39], v[38:39], v[40:41] op_sel_hi:[1,0] neg_lo:[0,1] neg_hi:[0,1]
  v_cvt_pk_bf16_f32 v17, v17, v17
  v_cvt_pk_bf16_f32 v41, v41, v41
  v_lshlrev_b32 v17, 16, v17
  v_lshlrev_b32 v41, 16, v41
  v_rcp_f32 v18, v17
  v_rcp_f32 v42, v41
  v_cvt_pk_bf16_f32 v20, v8, v9
  v_cvt_pk_bf16_f32 v44, v32, v33
  v_cvt_pk_bf16_f32 v21, v10, v11
  v_cvt_pk_bf16_f32 v45, v34, v35
  v_cvt_pk_bf16_f32 v22, v12, v13
  v_cvt_pk_bf16_f32 v46, v36, v37
  v_cvt_pk_bf16_f32 v23, v14, v15
  v_cvt_pk_bf16_f32 v47, v38, v39
  v_lshlrev_b32 v8, 16, v20
  v_lshlrev_b32 v32, 16, v44
  v_and_b32 v9, 0xffff0000, v20
  v_and_b32 v33, 0xffff0000, v44
  v_lshlrev_b32 v10, 16, v21
  v_lshlrev_b32 v34, 16, v45
  v_and_b32 v11, 0xffff0000, v21
  v_and_b32 v35, 0xffff0000, v45
  v_lshlrev_b32 v12, 16, v22
  v_lshlrev_b32 v36, 16, v46
  v_and_b32 v13, 0xffff0000, v22
  v_and_b32 v37, 0xffff0000, v46
  v_lshlrev_b32 v14, 16, v23
  v_lshlrev_b32 v38, 16, v47
  v_and_b32 v15, 0xffff0000, v23
  v_and_b32 v39, 0xffff0000, v47
  v_pk_mul_f32 v[8:9], v[8:9], v[18:19] op_sel_hi:[1,0]
  v_pk_mul_f32 v[32:33], v[32:33], v[42:43] op_sel_hi:[1,0]
  v_pk_mul_f32 v[10:11], v[10:11], v[18:19] op_sel_hi:[1,0]
  v_pk_mul_f32 v[34:35], v[34:35], v[42:43] op_sel_hi:[1,0]
  v_pk_mul_f32 v[12:13], v[12:13], v[18:19] op_sel_hi:[1,0]
  v_pk_mul_f32 v[36:37], v[36:37], v[42:43] op_sel_hi:[1,0]
  v_pk_mul_f32 v[14:15], v[14:15], v[18:19] op_sel_hi:[1,0]
  v_pk_mul_f32 v[38:39], v[38:39], v[42:43] op_sel_hi:[1,0]
  v_cvt_pk_bf16_f32 v20, v8, v9
  v_cvt_pk_bf16_f32 v44, v32, v33
  v_cvt_pk_bf16_f32 v21, v10, v11
  v_cvt_pk_bf16_f32 v45, v34, v35
  v_cvt_pk_bf16_f32 v22, v12, v13
  v_cvt_pk_bf16_f32 v46, v36, v37
  v_cvt_pk_bf16_f32 v23, v14, v15
  v_cvt_pk_bf16_f32 v47, v38, v39
  s_waitcnt vmcnt(0)
  s_mov_b64 exec, 3
  buffer_store_dword v7, v4, s[4:7], s22 offen sc1
  s_mov_b64 exec, -1
  s_add_u32 s22, s22, 2048
  buffer_store_dwordx4 v[20:23], v1, s[4:7], s21 offen offset:0 sc1
  buffer_store_dwordx4 v[44:47], v1, s[4:7], s21 offen offset:1024 sc1
  s_add_u32 s21, s21, 65536
  v_lshlrev_b32 v8, 16, v248
  v_lshlrev_b32 v32, 16, v252
  v_and_b32 v9, 0xffff0000, v248
  v_and_b32 v33, 0xffff0000, v252
  v_lshlrev_b32 v10, 16, v249
  v_lshlrev_b32 v34, 16, v253
  v_and_b32 v11, 0xffff0000, v249
  v_and_b32 v35, 0xffff0000, v253
  v_lshlrev_b32 v12, 16, v250
  v_lshlrev_b32 v36, 16, v254
  v_and_b32 v13, 0xffff0000, v250
  v_and_b32 v37, 0xffff0000, v254
  v_lshlrev_b32 v14, 16, v251
  v_lshlrev_b32 v38, 16, v255
  v_and_b32 v15, 0xffff0000, v251
  v_and_b32 v39, 0xffff0000, v255
  v_pk_add_f32 v[18:19], v[8:9], v[10:11]
  v_pk_add_f32 v[42:43], v[32:33], v[34:35]
  v_pk_add_f32 v[20:21], v[12:13], v[14:15]
  v_pk_add_f32 v[44:45], v[36:37], v[38:39]
  v_pk_add_f32 v[18:19], v[18:19], v[20:21]
  v_pk_add_f32 v[42:43], v[42:43], v[44:45]
  v_add_f32 v16, v18, v19
  v_add_f32 v40, v42, v43
  s_nop 0
  v_add_f32_dpp v16, v16, v16 row_ror:1 row_mask:0xf bank_mask:0xf
  v_add_f32_dpp v40, v40, v40 row_ror:1 row_mask:0xf bank_mask:0xf
  s_nop 0
  v_add_f32_dpp v16, v16, v16 row_ror:2 row_mask:0xf bank_mask:0xf
  v_add_f32_dpp v40, v40, v40 row_ror:2 row_mask:0xf bank_mask:0xf
  s_nop 0
  v_add_f32_dpp v16, v16, v16 row_ror:4 row_mask:0xf bank_mask:0xf
  v_add_f32_dpp v40, v40, v40 row_ror:4 row_mask:0xf bank_mask:0xf
  s_nop 0
  v_add_f32_dpp v16, v16, v16 row_ror:8 row_mask:0xf bank_mask:0xf
  v_add_f32_dpp v40, v40, v40 row_ror:8 row_mask:0xf bank_mask:0xf
  v_mov_b32 v18, v16
  v_mov_b32 v42, v40
  s_nop 0
  v_permlane16_swap_b32 v16, v18
  v_permlane16_swap_b32 v40, v42
  v_add_f32 v16, v16, v18
  v_add_f32 v40, v40, v42
  v_mov_b32 v18, v16
  v_mov_b32 v42, v40
  s_nop 0
  v_permlane32_swap_b32 v16, v18
  v_permlane32_swap_b32 v40, v42
  v_add_f32 v16, v16, v18
  v_add_f32 v40, v40, v42
  v_mul_f32 v16, s26, v16
  v_mul_f32 v40, s26, v40
  v_pk_add_f32 v[64:65], v[8:9], v[16:17] op_sel_hi:[1,0] neg_lo:[0,1] neg_hi:[0,1]
  v_pk_add_f32 v[96:97], v[32:33], v[40:41] op_sel_hi:[1,0] neg_lo:[0,1] neg_hi:[0,1]
  v_pk_add_f32 v[66:67], v[10:11], v[16:17] op_sel_hi:[1,0] neg_lo:[0,1] neg_hi:[0,1]
  v_pk_add_f32 v[98:99], v[34:35], v[40:41] op_sel_hi:[1,0] neg_lo:[0,1] neg_hi:[0,1]
  v_pk_add_f32 v[68:69], v[12:13], v[16:17] op_sel_hi:[1,0] neg_lo:[0,1] neg_hi:[0,1]
  v_pk_add_f32 v[100:101], v[36:37], v[40:41] op_sel_hi:[1,0] neg_lo:[0,1] neg_hi:[0,1]
  v_pk_add_f32 v[70:71], v[14:15], v[16:17] op_sel_hi:[1,0] neg_lo:[0,1] neg_hi:[0,1]
  v_pk_add_f32 v[102:103], v[38:39], v[40:41] op_sel_hi:[1,0] neg_lo:[0,1] neg_hi:[0,1]
  v_pk_mul_f32 v[18:19], v[64:65], v[64:65]
  v_pk_mul_f32 v[42:43], v[96:97], v[96:97]
  v_pk_fma_f32 v[18:19], v[66:67], v[66:67], v[18:19]
  v_pk_fma_f32 v[42:43], v[98:99], v[98:99], v[42:43]
  v_pk_fma_f32 v[18:19], v[68:69], v[68:69], v[18:19]
  v_pk_fma_f32 v[42:43], v[100:101], v[100:101], v[42:43]
  v_pk_fma_f32 v[18:19], v[70:71], v[70:71], v[18:19]
  v_pk_fma_f32 v[42:43], v[102:103], v[102:103], v[42:43]
  v_add_f32 v17, v18, v19
  v_add_f32 v41, v42, v43
  v_cvt_pk_bf16_f32 v16, v16, v16
  v_cvt_pk_bf16_f32 v40, v40, v40
  v_lshlrev_b32 v16, 16, v16
  v_lshlrev_b32 v40, 16, v40
  v_add_f32_dpp v17, v17, v17 row_ror:1 row_mask:0xf bank_mask:0xf
  v_add_f32_dpp v41, v41, v41 row_ror:1 row_mask:0xf bank_mask:0xf
  s_nop 0
  v_add_f32_dpp v17, v17, v17 row_ror:2 row_mask:0xf bank_mask:0xf
  v_add_f32_dpp v41, v41, v41 row_ror:2 row_mask:0xf bank_mask:0xf
  s_nop 0
  v_add_f32_dpp v17, v17, v17 row_ror:4 row_mask:0xf bank_mask:0xf
  v_add_f32_dpp v41, v41, v41 row_ror:4 row_mask:0xf bank_mask:0xf
  s_nop 0
  v_add_f32_dpp v17, v17, v17 row_ror:8 row_mask:0xf bank_mask:0xf
  v_add_f32_dpp v41, v41, v41 row_ror:8 row_mask:0xf bank_mask:0xf
  v_mov_b32 v18, v17
  v_mov_b32 v42, v41
  s_nop 0
  v_permlane16_swap_b32 v17, v18
  v_permlane16_swap_b32 v41, v42
  v_add_f32 v17, v17, v18
  v_add_f32 v41, v41, v42
  v_mov_b32 v18, v17
  v_mov_b32 v42, v41
  s_nop 0
  v_permlane32_swap_b32 v17, v18
  v_permlane32_swap_b32 v41, v42
  v_add_f32 v17, v17, v18
  v_add_f32 v41, v41, v42
  v_mul_f32 v17, s26, v17
  v_mul_f32 v41, s26, v41
  v_cvt_pk_bf16_f32 v17, v17, v17
  v_cvt_pk_bf16_f32 v41, v41, v41
  v_lshlrev_b32 v17, 16, v17
  v_lshlrev_b32 v41, 16, v41
  v_add_f32 v17, s25, v17
  v_add_f32 v41, s25, v41
  v_cvt_pk_bf16_f32 v17, v17, v17
  v_cvt_pk_bf16_f32 v41, v41, v41
  v_lshlrev_b32 v17, 16, v17
  v_lshlrev_b32 v41, 16, v41
  v_sqrt_f32 v17, v17
  v_sqrt_f32 v41, v41
  v_pk_add_f32 v[8:9], v[8:9], v[16:17] op_sel_hi:[1,0] neg_lo:[0,1] neg_hi:[0,1]
  v_pk_add_f32 v[32:33], v[32:33], v[40:41] op_sel_hi:[1,0] neg_lo:[0,1] neg_hi:[0,1]
  v_pk_add_f32 v[10:11], v[10:11], v[16:17] op_sel_hi:[1,0] neg_lo:[0,1] neg_hi:[0,1]
  v_pk_add_f32 v[34:35], v[34:35], v[40:41] op_sel_hi:[1,0] neg_lo:[0,1] neg_hi:[0,1]
  v_pk_add_f32 v[12:13], v[12:13], v[16:17] op_sel_hi:[1,0] neg_lo:[0,1] neg_hi:[0,1]
  v_pk_add_f32 v[36:37], v[36:37], v[40:41] op_sel_hi:[1,0] neg_lo:[0,1] neg_hi:[0,1]
  v_pk_add_f32 v[14:15], v[14:15], v[16:17] op_sel_hi:[1,0] neg_lo:[0,1] neg_hi:[0,1]
  v_pk_add_f32 v[38:39], v[38:39], v[40:41] op_sel_hi:[1,0] neg_lo:[0,1] neg_hi:[0,1]
  v_cvt_pk_bf16_f32 v17, v17, v17
  v_cvt_pk_bf16_f32 v41, v41, v41
  v_lshlrev_b32 v17, 16, v17
  v_lshlrev_b32 v41, 16, v41
  v_rcp_f32 v18, v17
  v_rcp_f32 v42, v41
  v_cvt_pk_bf16_f32 v20, v8, v9
  v_cvt_pk_bf16_f32 v44, v32, v33
  v_cvt_pk_bf16_f32 v21, v10, v11
  v_cvt_pk_bf16_f32 v45, v34, v35
  v_cvt_pk_bf16_f32 v22, v12, v13
  v_cvt_pk_bf16_f32 v46, v36, v37
  v_cvt_pk_bf16_f32 v23, v14, v15
  v_cvt_pk_bf16_f32 v47, v38, v39
  v_lshlrev_b32 v8, 16, v20
  v_lshlrev_b32 v32, 16, v44
  v_and_b32 v9, 0xffff0000, v20
  v_and_b32 v33, 0xffff0000, v44
  v_lshlrev_b32 v10, 16, v21
  v_lshlrev_b32 v34, 16, v45
  v_and_b32 v11, 0xffff0000, v21
  v_and_b32 v35, 0xffff0000, v45
  v_lshlrev_b32 v12, 16, v22
  v_lshlrev_b32 v36, 16, v46
  v_and_b32 v13, 0xffff0000, v22
  v_and_b32 v37, 0xffff0000, v46
  v_lshlrev_b32 v14, 16, v23
  v_lshlrev_b32 v38, 16, v47
  v_and_b32 v15, 0xffff0000, v23
  v_and_b32 v39, 0xffff0000, v47
  v_pk_mul_f32 v[8:9], v[8:9], v[18:19] op_sel_hi:[1,0]
  v_pk_mul_f32 v[32:33], v[32:33], v[42:43] op_sel_hi:[1,0]
  v_pk_mul_f32 v[10:11], v[10:11], v[18:19] op_sel_hi:[1,0]
  v_pk_mul_f32 v[34:35], v[34:35], v[42:43] op_sel_hi:[1,0]
  v_pk_mul_f32 v[12:13], v[12:13], v[18:19] op_sel_hi:[1,0]
  v_pk_mul_f32 v[36:37], v[36:37], v[42:43] op_sel_hi:[1,0]
  v_pk_mul_f32 v[14:15], v[14:15], v[18:19] op_sel_hi:[1,0]
  v_pk_mul_f32 v[38:39], v[38:39], v[42:43] op_sel_hi:[1,0]
  v_cvt_pk_bf16_f32 v20, v8, v9
  v_cvt_pk_bf16_f32 v44, v32, v33
  v_cvt_pk_bf16_f32 v21, v10, v11
  v_cvt_pk_bf16_f32 v45, v34, v35
  v_cvt_pk_bf16_f32 v22, v12, v13
  v_cvt_pk_bf16_f32 v46, v36, v37
  v_cvt_pk_bf16_f32 v23, v14, v15
  v_cvt_pk_bf16_f32 v47, v38, v39
  s_waitcnt vmcnt(0)
  s_mov_b64 exec, 3
  buffer_store_dword v7, v4, s[4:7], s22 offen sc1
  s_mov_b64 exec, -1
  s_add_u32 s22, s22, 2048
  buffer_store_dwordx4 v[20:23], v1, s[4:7], s21 offen offset:0 sc1
  buffer_store_dwordx4 v[44:47], v1, s[4:7], s21 offen offset:1024 sc1
  s_add_u32 s21, s21, 65536
  buffer_load_dwordx4 v[128:131], v1, s[28:31], s19 offen offset:0
  buffer_load_dwordx4 v[132:135], v1, s[28:31], s19 offen offset:1024
  s_add_u32 s19, s19, 65536
  buffer_load_dwordx4 v[136:139], v1, s[28:31], s19 offen offset:0
  buffer_load_dwordx4 v[140:143], v1, s[28:31], s19 offen offset:1024
  s_add_u32 s19, s19, 65536
  buffer_load_dwordx4 v[144:147], v1, s[28:31], s19 offen offset:0
  buffer_load_dwordx4 v[148:151], v1, s[28:31], s19 offen offset:1024
  s_add_u32 s19, s19, 65536
  buffer_load_dwordx4 v[152:155], v1, s[28:31], s19 offen offset:0
  buffer_load_dwordx4 v[156:159], v1, s[28:31], s19 offen offset:1024
  s_add_u32 s19, s19, 65536
  buffer_load_dwordx4 v[160:163], v1, s[28:31], s19 offen offset:0
  buffer_load_dwordx4 v[164:167], v1, s[28:31], s19 offen offset:1024
  s_add_u32 s19, s19, 65536
  buffer_load_dwordx4 v[168:171], v1, s[28:31], s19 offen offset:0
  buffer_load_dwordx4 v[172:175], v1, s[28:31], s19 offen offset:1024
  s_add_u32 s19, s19, 65536
  buffer_load_dwordx4 v[176:179], v1, s[28:31], s19 offen offset:0
  buffer_load_dwordx4 v[180:183], v1, s[28:31], s19 offen offset:1024
  s_add_u32 s19, s19, 65536
  buffer_load_dwordx4 v[184:187], v1, s[28:31], s19 offen offset:0
  buffer_load_dwordx4 v[188:191], v1, s[28:31], s19 offen offset:1024
  s_add_u32 s19, s19, 65536
  buffer_load_dwordx4 v[192:195], v1, s[28:31], s19 offen offset:0
  buffer_load_dwordx4 v[196:199], v1, s[28:31], s19 offen offset:1024
  s_add_u32 s19, s19, 65536
  buffer_load_dwordx4 v[200:203], v1, s[28:31], s19 offen offset:0
  buffer_load_dwordx4 v[204:207], v1, s[28:31], s19 offen offset:1024
  s_add_u32 s19, s19, 65536
  buffer_load_dwordx4 v[208:211], v1, s[28:31], s19 offen offset:0
  buffer_load_dwordx4 v[212:215], v1, s[28:31], s19 offen offset:1024
  s_add_u32 s19, s19, 65536
  buffer_load_dwordx4 v[216:219], v1, s[28:31], s19 offen offset:0
  buffer_load_dwordx4 v[220:223], v1, s[28:31], s19 offen offset:1024
  s_add_u32 s19, s19, 65536
  buffer_load_dwordx4 v[224:227], v1, s[28:31], s19 offen offset:0
  buffer_load_dwordx4 v[228:231], v1, s[28:31], s19 offen offset:1024
  s_add_u32 s19, s19, 65536
  buffer_load_dwordx4 v[232:235], v1, s[28:31], s19 offen offset:0
  buffer_load_dwordx4 v[236:239], v1, s[28:31], s19 offen offset:1024
  s_add_u32 s19, s19, 65536
  buffer_load_dwordx4 v[240:243], v1, s[28:31], s19 offen offset:0
  buffer_load_dwordx4 v[244:247], v1, s[28:31], s19 offen offset:1024
  s_add_u32 s19, s19, 65536
  buffer_load_dwordx4 v[248:251], v1, s[28:31], s19 offen offset:0
  buffer_load_dwordx4 v[252:255], v1, s[28:31], s19 offen offset:1024
  s_add_u32 s19, s19, 65536
  s_waitcnt vmcnt(32)
  s_mov_b64 exec, 3
  buffer_store_dword v7, v4, s[4:7], s22 offen sc1
  s_mov_b64 exec, -1
  s_add_u32 s22, s22, 2048
  s_waitcnt vmcnt(0)
  s_xor_b32 s15, s15, 1
  s_cbranch_scc1 L_red_ln0
L_red_main:
  s_lshr_b32 s67, s13, 2
  s_lshl_b32 s68, s12, 1
  s_add_u32 s67, s67, s68
  s_cmp_eq_u32 s67, 1
  s_cbranch_scc1 L_red1_ini
  s_cmp_eq_u32 s67, 2
  s_cbranch_scc1 L_red2_ini
  s_cmp_eq_u32 s67, 3
  s_cbranch_scc1 L_red3_ini
L_red0_ini:
  v_lshrrev_b32 v61, 2, v0
  v_and_b32 v3, 12, v3
  v_lshl_add_u32 v3, v61, 6, v3
  s_mov_b32 s23, 458752
  v_and_b32 v61, 7, v0
  v_bfe_u32 v62, v0, 4, 1
  v_lshl_add_u32 v61, v62, 3, v61
  v_bfe_u32 v62, v0, 3, 1
  v_lshl_add_u32 v61, v62, 4, v61
  v_and_b32 v62, 32, v0
  v_add_u32 v61, v61, v62
  v_lshlrev_b32 v1, 4, v61
  v_and_b32 v61, 15, v0
  v_lshrrev_b32 v62, 4, v0
  v_and_b32 v63, 1, v0
  v_lshlrev_b32 v63, 4, v63
  v_mov_b32 v64, 0x3f80
  v_lshlrev_b32 v63, v63, v64
  v_lshrrev_b32 v64, 1, v61
  v_lshlrev_b32 v60, 15, v62
  v_cmp_eq_u32 vcc, 0, v64
  s_nop 1
  v_cndmask_b32 v176, 0, v63, vcc
  v_cmp_eq_u32 vcc, 1, v64
  s_nop 1
  v_cndmask_b32 v177, 0, v63, vcc
  v_cmp_eq_u32 vcc, 2, v64
  s_nop 1
  v_cndmask_b32 v178, 0, v63, vcc
  v_cmp_eq_u32 vcc, 3, v64
  s_nop 1
  v_cndmask_b32 v179, 0, v63, vcc
  v_cmp_eq_u32 vcc, 4, v64
  s_nop 1
  v_cndmask_b32 v180, 0, v63, vcc
  v_cmp_eq_u32 vcc, 5, v64
  s_nop 1
  v_cndmask_b32 v181, 0, v63, vcc
  v_cmp_eq_u32 vcc, 6, v64
  s_nop 1
  v_cndmask_b32 v182, 0, v63, vcc
  v_cmp_eq_u32 vcc, 7, v64
  s_nop 1
  v_cndmask_b32 v183, 0, v63, vcc
  v_lshl_add_u32 v60, v61, 4, v60
  s_mov_b32 s36, s26
  s_mov_b32 s37, s26
  s_mov_b32 s38, s25
  s_mov_b32 s39, s25
  s_lshl_b32 s67, s17, 10
  s_add_u32 s18, s67, 167772160
  s_lshl_b32 s67, s17, 10
  s_add_u32 s19, s67, 0
  s_add_u32 s20, s67, 10485760
  s_add_u32 s21, s67, 4194304
  s_lshl_b32 s67, s17, 5
  s_add_u32 s22, s67, 196608
  s_mov_b32 s46, 0
  s_sub_u32 s68, s22, 65536
  v_and_b32 v6, 32, v4
  v_add_u32 v6, s68, v6
  v_lshlrev_b32 v61, 2, v0
  v_add_u32 v61, 716768, v61
  v_cmp_gt_u32 vcc, 8, v0
  s_nop 1
  v_cndmask_b32 v6, v61, v6, vcc
  v_lshrrev_b32 v61, 4, v0
  v_lshlrev_b32 v61, 15, v61
  v_and_b32 v62, 15, v0
  v_lshl_add_u32 v61, v62, 7, v61
  buffer_load_dword v56, v61, s[4:7], s21 offen sc1
  s_mov_b32 s49, s21
  s_mov_b32 s47, 536870912
  s_mov_b32 s48, 0
  .p2align 3
L_red0_top:
L_red0_poll:
  s_sub_u32 s66, s66, 1
  s_cbranch_scc1 L_abort
  buffer_load_dword v5, v3, s[4:7], s23 offen sc1
  buffer_load_dword v56, v6, s[4:7], s46 offen sc1
  s_waitcnt vmcnt(0)
  v_cmp_ne_u32 vcc, 0, v5
  v_cmp_ne_u32 s[50:51], 0, v56
  s_mov_b64 exec, 3
  buffer_store_dword v7, v4, s[4:7], s47 offen
  s_mov_b64 exec, -1
  s_mov_b32 s47, 536870912
  s_cmp_lt_u32 s15, 4
  s_cselect_b32 s68, -1, 0
  s_or_b32 s51, s51, s68
  s_andn2_b32 s68, s68, 0xff
  s_or_b32 s50, s50, s68
  s_cmp_eq_u64 s[50:51], exec
  s_cbranch_scc0 L_red0_poll
  s_cmp_lg_u32 s48, 0
  s_cbranch_scc1 L_red0_have
  buffer_load_dwordx4 v[40:43], v1, s[28:31], s19 offen offset:0
  buffer_load_dwordx4 v[44:47], v1, s[28:31], s19 offen offset:1024
  s_mov_b32 s48, 1
L_red0_have:
  s_and_b32 s68, s15, 3
  s_lshl_b32 s68, s68, 15
  s_add_u32 s21, s49, s68
  s_and_b32 s68, s15, 7
  s_mul_i32 s68, s68, 131072
  s_add_u32 s68, s68, s18
  s_cmp_eq_u64 vcc, exec
  s_cbranch_scc0 L_red0_nap
  buffer_load_dwordx4 v[64:67], v60, s[4:7], s68 offen offset:0 sc1
  buffer_load_dwordx4 v[68:71], v60, s[4:7], s68 offen offset:256 sc1
  buffer_load_dwordx4 v[72:75], v60, s[4:7], s68 offen offset:512 sc1
  buffer_load_dwordx4 v[76:79], v60, s[4:7], s68 offen offset:768 sc1
  buffer_load_dwordx4 v[80:83], v60, s[4:7], s68 offen offset:1024 sc1
  buffer_load_dwordx4 v[84:87], v60, s[4:7], s68 offen offset:1280 sc1
  buffer_load_dwordx4 v[88:91], v60, s[4:7], s68 offen offset:1536 sc1
  buffer_load_dwordx4 v[92:95], v60, s[4:7], s68 offen offset:1792 sc1
  s_waitcnt vmcnt(9)
  v_lshlrev_b32 v128, 16, v40
  v_and_b32 v130, 0xffff0000, v40
  s_waitcnt vmcnt(8)
  v_lshlrev_b32 v129, 16, v44
  v_and_b32 v131, 0xffff0000, v44
  v_lshlrev_b32_e64 v132, 16, v41
  v_and_b32 v134, 0xffff0000, v41
  v_lshlrev_b32_e64 v133, 16, v45
  v_and_b32 v135, 0xffff0000, v45
  v_lshlrev_b32_e64 v136, 16, v42
  v_and_b32 v138, 0xffff0000, v42
  v_lshlrev_b32_e64 v137, 16, v46
  v_and_b32 v139, 0xffff0000, v46
  v_lshlrev_b32_e64 v140, 16, v43
  v_and_b32 v142, 0xffff0000, v43
  v_lshlrev_b32_e64 v141, 16, v47
  v_and_b32 v143, 0xffff0000, v47
  s_waitcnt vmcnt(7)
  v_mfma_f32_16x16x32_bf16 v[160:163], v[176:179], v[64:67], 0
  s_waitcnt vmcnt(6)
  v_mfma_f32_16x16x32_bf16 v[160:163], v[180:183], v[68:71], v[160:163]
  s_waitcnt vmcnt(5)
  v_mfma_f32_16x16x32_bf16 v[164:167], v[176:179], v[72:75], 0
  s_waitcnt vmcnt(4)
  v_mfma_f32_16x16x32_bf16 v[164:167], v[180:183], v[76:79], v[164:167]
  s_waitcnt vmcnt(3)
  v_mfma_f32_16x16x32_bf16 v[168:171], v[176:179], v[80:83], 0
  s_waitcnt vmcnt(2)
  v_mfma_f32_16x16x32_bf16 v[168:171], v[180:183], v[84:87], v[168:171]
  s_waitcnt vmcnt(1)
  v_mfma_f32_16x16x32_bf16 v[172:175], v[176:179], v[88:91], 0
  s_waitcnt vmcnt(0)
  v_mfma_f32_16x16x32_bf16 v[172:175], v[180:183], v[92:95], v[172:175]
  v_pk_add_f32 v[128:129], v[128:129], v[160:161]
  v_pk_add_f32 v[130:131], v[130:131], v[162:163]
  v_pk_add_f32 v[132:133], v[132:133], v[164:165]
  v_pk_add_f32 v[134:135], v[134:135], v[166:167]
  v_pk_add_f32 v[136:137], v[136:137], v[168:169]
  v_pk_add_f32 v[138:139], v[138:139], v[170:171]
  s_nop 1
  s_nop 0
  v_pk_add_f32 v[140:141], v[140:141], v[172:173]
  v_pk_add_f32 v[142:143], v[142:143], v[174:175]
  v_cvt_pk_bf16_f32 v48, v128, v130
  v_cvt_pk_bf16_f32 v52, v129, v131
  v_cvt_pk_bf16_f32 v49, v132, v134
  v_cvt_pk_bf16_f32 v53, v133, v135
  v_cvt_pk_bf16_f32 v50, v136, v138
  v_cvt_pk_bf16_f32 v54, v137, v139
  v_cvt_pk_bf16_f32 v51, v140, v142
  v_cvt_pk_bf16_f32 v55, v141, v143
  v_lshlrev_b32_e64 v128, 16, v48
  v_and_b32 v130, 0xffff0000, v48
  v_lshlrev_b32_e64 v129, 16, v52
  v_and_b32 v131, 0xffff0000, v52
  v_lshlrev_b32_e64 v132, 16, v49
  v_and_b32 v134, 0xffff0000, v49
  v_lshlrev_b32_e64 v133, 16, v53
  v_and_b32 v135, 0xffff0000, v53
  v_lshlrev_b32_e64 v136, 16, v50
  v_and_b32 v138, 0xffff0000, v50
  v_lshlrev_b32_e64 v137, 16, v54
  v_and_b32 v139, 0xffff0000, v54
  v_lshlrev_b32_e64 v140, 16, v51
  v_and_b32 v142, 0xffff0000, v51
  v_lshlrev_b32_e64 v141, 16, v55
  v_and_b32 v143, 0xffff0000, v55
  v_pk_add_f32 v[16:17], v[128:129], v[130:131]
  v_pk_add_f32 v[20:21], v[132:133], v[134:135]
  v_pk_add_f32 v[18:19], v[136:137], v[138:139]
  v_pk_add_f32 v[22:23], v[140:141], v[142:143]
  v_pk_add_f32 v[16:17], v[16:17], v[20:21]
  v_pk_add_f32 v[18:19], v[18:19], v[22:23]
  v_pk_add_f32 v[16:17], v[16:17], v[18:19]
  s_nop 1
  s_nop 0
  v_add_f32_dpp v16, v16, v16 row_ror:1 row_mask:0xf bank_mask:0xf
  v_add_f32_dpp v17, v17, v17 row_ror:1 row_mask:0xf bank_mask:0xf
  buffer_store_dwordx4 v[48:51], v1, s[4:7], s20 offen offset:0 sc1
  v_add_f32_dpp v16, v16, v16 row_ror:2 row_mask:0xf bank_mask:0xf
  v_add_f32_dpp v17, v17, v17 row_ror:2 row_mask:0xf bank_mask:0xf
  buffer_store_dwordx4 v[52:55], v1, s[4:7], s20 offen offset:1024 sc1
  v_add_f32_dpp v16, v16, v16 row_ror:4 row_mask:0xf bank_mask:0xf
  v_add_f32_dpp v17, v17, v17 row_ror:4 row_mask:0xf bank_mask:0xf
  s_nop 0
  v_add_f32_dpp v16, v16, v16 row_ror:8 row_mask:0xf bank_mask:0xf
  v_add_f32_dpp v17, v17, v17 row_ror:8 row_mask:0xf bank_mask:0xf
  v_mov_b32_e64 v20, v16
  v_mov_b32 v21, v17
  s_nop 0
  v_permlane16_swap_b32 v16, v20
  v_permlane16_swap_b32 v17, v21
  v_add_f32 v16, v16, v20
  v_add_f32 v17, v17, v21
  v_mov_b32 v20, v16
  v_mov_b32 v21, v17
  s_nop 0
  v_permlane32_swap_b32 v16, v20
  v_permlane32_swap_b32 v17, v21
  v_add_f32 v16, v16, v20
  v_add_f32 v17, v17, v21
  v_pk_mul_f32 v[16:17], v[16:17], s[36:37]
  v_pk_add_f32 v[160:161], v[128:129], v[16:17] neg_lo:[0,1] neg_hi:[0,1]
  v_pk_add_f32 v[162:163], v[130:131], v[16:17] neg_lo:[0,1] neg_hi:[0,1]
  v_pk_add_f32 v[164:165], v[132:133], v[16:17] neg_lo:[0,1] neg_hi:[0,1]
  v_pk_add_f32 v[166:167], v[134:135], v[16:17] neg_lo:[0,1] neg_hi:[0,1]
  v_pk_add_f32 v[168:169], v[136:137], v[16:17] neg_lo:[0,1] neg_hi:[0,1]
  v_pk_add_f32 v[170:171], v[138:139], v[16:17] neg_lo:[0,1] neg_hi:[0,1]
  v_pk_add_f32 v[172:173], v[140:141], v[16:17] neg_lo:[0,1] neg_hi:[0,1]
  v_pk_add_f32 v[174:175], v[142:143], v[16:17] neg_lo:[0,1] neg_hi:[0,1]
  v_pk_mul_f32 v[18:19], v[160:161], v[160:161]
  v_pk_mul_f32 v[20:21], v[162:163], v[162:163]
  v_pk_fma_f32 v[18:19], v[164:165], v[164:165], v[18:19]
  v_pk_fma_f32 v[20:21], v[166:167], v[166:167], v[20:21]
  v_pk_fma_f32 v[18:19], v[168:169], v[168:169], v[18:19]
  v_pk_fma_f32 v[20:21], v[170:171], v[170:171], v[20:21]
  v_pk_fma_f32 v[18:19], v[172:173], v[172:173], v[18:19]
  v_pk_fma_f32 v[20:21], v[174:175], v[174:175], v[20:21]
  v_pk_add_f32 v[18:19], v[18:19], v[20:21]
  s_nop 1
  s_nop 0
  v_add_f32_dpp v18, v18, v18 row_ror:1 row_mask:0xf bank_mask:0xf
  v_add_f32_dpp v19, v19, v19 row_ror:1 row_mask:0xf bank_mask:0xf
  v_cvt_pk_bf16_f32 v22, v16, v17
  v_add_f32_dpp v18, v18, v18 row_ror:2 row_mask:0xf bank_mask:0xf
  v_add_f32_dpp v19, v19, v19 row_ror:2 row_mask:0xf bank_mask:0xf
  v_and_b32 v23, 0xffff0000, v22
  v_add_f32_dpp v18, v18, v18 row_ror:4 row_mask:0xf bank_mask:0xf
  v_add_f32_dpp v19, v19, v19 row_ror:4 row_mask:0xf bank_mask:0xf
  v_lshlrev_b32_e64 v22, 16, v22
  v_add_f32_dpp v18, v18, v18 row_ror:8 row_mask:0xf bank_mask:0xf
  v_add_f32_dpp v19, v19, v19 row_ror:8 row_mask:0xf bank_mask:0xf
  v_pk_add_f32 v[144:145], v[128:129], v[22:23] neg_lo:[0,1] neg_hi:[0,1]
  v_mov_b32 v20, v18
  v_mov_b32 v21, v19
  v_pk_add_f32 v[146:147], v[130:131], v[22:23] neg_lo:[0,1] neg_hi:[0,1]
  v_permlane16_swap_b32 v18, v20
  v_permlane16_swap_b32 v19, v21
  v_pk_add_f32 v[148:149], v[132:133], v[22:23] neg_lo:[0,1] neg_hi:[0,1]
  v_add_f32 v18, v18, v20
  v_add_f32 v19, v19, v21
  v_pk_add_f32 v[150:151], v[134:135], v[22:23] neg_lo:[0,1] neg_hi:[0,1]
  v_mov_b32 v20, v18
  v_mov_b32 v21, v19
  v_pk_add_f32 v[152:153], v[136:137], v[22:23] neg_lo:[0,1] neg_hi:[0,1]
  v_permlane32_swap_b32 v18, v20
  v_permlane32_swap_b32 v19, v21
  v_pk_add_f32 v[154:155], v[138:139], v[22:23] neg_lo:[0,1] neg_hi:[0,1]
  v_add_f32 v18, v18, v20
  v_add_f32 v19, v19, v21
  v_pk_add_f32 v[156:157], v[140:141], v[22:23] neg_lo:[0,1] neg_hi:[0,1]
  v_pk_add_f32 v[158:159], v[142:143], v[22:23] neg_lo:[0,1] neg_hi:[0,1]
  v_pk_mul_f32 v[18:19], v[18:19], s[36:37]
  v_cvt_pk_bf16_f32 v18, v18, v19
  v_and_b32 v19, 0xffff0000, v18
  v_lshlrev_b32_e64 v18, 16, v18
  v_pk_add_f32 v[18:19], v[18:19], s[38:39]
  v_cvt_pk_bf16_f32 v18, v18, v19
  v_and_b32 v19, 0xffff0000, v18
  v_lshlrev_b32_e64 v18, 16, v18
  v_sqrt_f32 v18, v18
  v_sqrt_f32 v19, v19
  v_cvt_pk_bf16_f32 v24, v144, v146
  v_cvt_pk_bf16_f32 v28, v145, v147
  v_cvt_pk_bf16_f32 v25, v148, v150
  v_cvt_pk_bf16_f32 v29, v149, v151
  v_cvt_pk_bf16_f32 v18, v18, v19
  v_and_b32 v19, 0xffff0000, v18
  v_lshlrev_b32_e64 v18, 16, v18
  v_rcp_f32 v18, v18
  v_rcp_f32 v19, v19
  v_cvt_pk_bf16_f32 v26, v152, v154
  v_cvt_pk_bf16_f32 v30, v153, v155
  v_cvt_pk_bf16_f32 v27, v156, v158
  v_cvt_pk_bf16_f32 v31, v157, v159
  v_lshlrev_b32_e64 v144, 16, v24
  v_and_b32 v146, 0xffff0000, v24
  v_lshlrev_b32_e64 v145, 16, v28
  v_and_b32 v147, 0xffff0000, v28
  v_lshlrev_b32_e64 v148, 16, v25
  v_and_b32 v150, 0xffff0000, v25
  v_lshlrev_b32_e64 v149, 16, v29
  v_and_b32 v151, 0xffff0000, v29
  v_lshlrev_b32_e64 v152, 16, v26
  v_and_b32 v154, 0xffff0000, v26
  v_lshlrev_b32_e64 v153, 16, v30
  v_and_b32 v155, 0xffff0000, v30
  v_lshlrev_b32_e64 v156, 16, v27
  v_and_b32 v158, 0xffff0000, v27
  v_lshlrev_b32_e64 v157, 16, v31
  v_and_b32 v159, 0xffff0000, v31
  v_pk_mul_f32 v[144:145], v[144:145], v[18:19]
  v_pk_mul_f32 v[146:147], v[146:147], v[18:19]
  v_pk_mul_f32 v[148:149], v[148:149], v[18:19]
  v_pk_mul_f32 v[150:151], v[150:151], v[18:19]
  v_pk_mul_f32 v[152:153], v[152:153], v[18:19]
  v_pk_mul_f32 v[154:155], v[154:155], v[18:19]
  v_pk_mul_f32 v[156:157], v[156:157], v[18:19]
  v_pk_mul_f32 v[158:159], v[158:159], v[18:19]
  v_cvt_pk_bf16_f32 v24, v144, v146
  v_cvt_pk_bf16_f32 v28, v145, v147
  v_cvt_pk_bf16_f32 v25, v148, v150
  v_cvt_pk_bf16_f32 v29, v149, v151
  v_cvt_pk_bf16_f32 v26, v152, v154
  v_cvt_pk_bf16_f32 v30, v153, v155
  v_cvt_pk_bf16_f32 v27, v156, v158
  v_cvt_pk_bf16_f32 v31, v157, v159
  buffer_store_dwordx4 v[24:27], v1, s[4:7], s21 offen offset:0
  buffer_store_dwordx4 v[28:31], v1, s[4:7], s21 offen offset:1024
  s_add_u32 s23, s23, 1024
  s_add_u32 s19, s19, 32768
  s_add_u32 s20, s20, 32768
  s_add_u32 s21, s21, 32768
  s_mov_b32 s47, s22
  s_add_u32 s22, s22, 1024
  s_add_u32 s46, s46, 1024
  s_mov_b32 s48, 0
  s_add_u32 s15, s15, 1
  s_cmp_lt_u32 s15, 64
  s_cbranch_scc1 L_red0_top
  s_waitcnt vmcnt(0)
  s_mov_b64 exec, 3
  buffer_store_dword v7, v4, s[4:7], s47 offen
  s_mov_b64 exec, -1
  s_branch L_end
L_red0_nap:
  s_branch L_red0_poll
L_red1_ini:
  v_and_b32 v3, 127, v3
  s_mov_b32 s23, 589824
  v_and_b32 v61, 7, v0
  v_bfe_u32 v62, v0, 4, 1
  v_lshl_add_u32 v61, v62, 3, v61
  v_bfe_u32 v62, v0, 3, 1
  v_lshl_add_u32 v61, v62, 4, v61
  v_and_b32 v62, 32, v0
  v_add_u32 v61, v61, v62
  v_lshlrev_b32 v1, 4, v61
  v_and_b32 v61, 15, v0
  v_lshrrev_b32 v62, 4, v0
  v_and_b32 v63, 1, v0
  v_lshlrev_b32 v63, 4, v63
  v_mov_b32 v64, 0x3f80
  v_lshlrev_b32 v63, v63, v64
  v_lshrrev_b32 v64, 1, v61
  v_lshrrev_b32 v65, 1, v62
  v_and_b32 v62, 1, v62
  v_lshlrev_b32 v60, 15, v62
  v_lshl_add_u32 v60, v65, 8, v60
  v_lshlrev_b32 v65, 2, v65
  v_sub_u32 v64, v64, v65
  v_cmp_eq_u32 vcc, 0, v64
  s_nop 1
  v_cndmask_b32 v176, 0, v63, vcc
  v_cmp_eq_u32 vcc, 1, v64
  s_nop 1
  v_cndmask_b32 v177, 0, v63, vcc
  v_cmp_eq_u32 vcc, 2, v64
  s_nop 1
  v_cndmask_b32 v178, 0, v63, vcc
  v_cmp_eq_u32 vcc, 3, v64
  s_nop 1
  v_cndmask_b32 v179, 0, v63, vcc
  v_lshl_add_u32 v60, v61, 4, v60
  s_mov_b32 s36, s26
  s_mov_b32 s37, s26
  s_mov_b32 s38, s25
  s_mov_b32 s39, s25
  s_lshl_b32 s67, s17, 10
  s_add_u32 s18, s67, 234881024
  s_lshl_b32 s67, s17, 10
  s_add_u32 s19, s67, 10485760
  s_add_u32 s20, s67, 12582912
  s_add_u32 s21, s67, 6291456
  s_lshl_b32 s67, s17, 5
  s_add_u32 s22, s67, 262144
  s_mov_b32 s46, 0
  s_sub_u32 s68, s22, 65536
  v_and_b32 v6, 32, v4
  v_add_u32 v6, s68, v6
  s_mov_b32 s47, 536870912
  s_mov_b32 s48, 0
  .p2align 3
L_red1_top:
L_red1_poll:
  s_sub_u32 s66, s66, 1
  s_cbranch_scc1 L_abort
  buffer_load_dword v5, v3, s[4:7], s23 offen sc1
  buffer_load_dword v56, v6, s[4:7], s46 offen sc1
  s_waitcnt vmcnt(0)
  v_cmp_ne_u32 vcc, 0, v5
  v_cmp_ne_u32 s[50:51], 0, v56
  s_mov_b64 exec, 3
  buffer_store_dword v7, v4, s[4:7], s47 offen sc1
  s_mov_b64 exec, -1
  s_mov_b32 s47, 536870912
  s_cmp_eq_u64 s[50:51], exec
  s_cbranch_scc0 L_red1_poll
  s_cmp_lg_u32 s48, 0
  s_cbranch_scc1 L_red1_have
  buffer_load_dwordx4 v[40:43], v1, s[4:7], s19 offen offset:0 sc1
  buffer_load_dwordx4 v[44:47], v1, s[4:7], s19 offen offset:1024 sc1
  s_mov_b32 s48, 1
L_red1_have:
  s_and_b32 s68, s15, 3
  s_mul_i32 s68, s68, 65536
  s_add_u32 s68, s68, s18
  s_cmp_eq_u64 vcc, exec
  s_cbranch_scc0 L_red1_nap
  buffer_load_dwordx4 v[64:67], v60, s[4:7], s68 offen offset:0 sc1
  buffer_load_dwordx4 v[68:71], v60, s[4:7], s68 offen offset:512 sc1
  buffer_load_dwordx4 v[72:75], v60, s[4:7], s68 offen offset:1024 sc1
  buffer_load_dwordx4 v[76:79], v60, s[4:7], s68 offen offset:1536 sc1
  s_waitcnt vmcnt(5)
  v_lshlrev_b32_e64 v128, 16, v40
  v_and_b32 v130, 0xffff0000, v40
  s_waitcnt vmcnt(4)
  v_lshlrev_b32 v129, 16, v44
  v_and_b32 v131, 0xffff0000, v44
  v_lshlrev_b32_e64 v132, 16, v41
  v_and_b32 v134, 0xffff0000, v41
  v_lshlrev_b32_e64 v133, 16, v45
  v_and_b32 v135, 0xffff0000, v45
  v_lshlrev_b32_e64 v136, 16, v42
  v_and_b32 v138, 0xffff0000, v42
  v_lshlrev_b32_e64 v137, 16, v46
  v_and_b32 v139, 0xffff0000, v46
  v_lshlrev_b32_e64 v140, 16, v43
  v_and_b32 v142, 0xffff0000, v43
  v_lshlrev_b32_e64 v141, 16, v47
  v_and_b32 v143, 0xffff0000, v47
  s_waitcnt vmcnt(3)
  v_mfma_f32_16x16x32_bf16 v[160:163], v[176:179], v[64:67], 0
  s_waitcnt vmcnt(2)
  v_mfma_f32_16x16x32_bf16 v[164:167], v[176:179], v[68:71], 0
  s_waitcnt vmcnt(1)
  v_mfma_f32_16x16x32_bf16 v[168:171], v[176:179], v[72:75], 0
  s_waitcnt vmcnt(0)
  v_mfma_f32_16x16x32_bf16 v[172:175], v[176:179], v[76:79], 0
  s_nop 1
  s_nop 0
  v_pk_add_f32 v[128:129], v[128:129], v[160:161]
  v_pk_add_f32 v[130:131], v[130:131], v[162:163]
  v_pk_add_f32 v[132:133], v[132:133], v[164:165]
  v_pk_add_f32 v[134:135], v[134:135], v[166:167]
  v_pk_add_f32 v[136:137], v[136:137], v[168:169]
  v_pk_add_f32 v[138:139], v[138:139], v[170:171]
  v_pk_add_f32 v[140:141], v[140:141], v[172:173]
  v_pk_add_f32 v[142:143], v[142:143], v[174:175]
  v_cvt_pk_bf16_f32 v48, v128, v130
  v_cvt_pk_bf16_f32 v52, v129, v131
  v_cvt_pk_bf16_f32 v49, v132, v134
  v_cvt_pk_bf16_f32 v53, v133, v135
  v_cvt_pk_bf16_f32 v50, v136, v138
  v_cvt_pk_bf16_f32 v54, v137, v139
  v_cvt_pk_bf16_f32 v51, v140, v142
  v_cvt_pk_bf16_f32 v55, v141, v143
  v_lshlrev_b32_e64 v128, 16, v48
  v_and_b32 v130, 0xffff0000, v48
  v_lshlrev_b32_e64 v129, 16, v52
  v_and_b32 v131, 0xffff0000, v52
  v_lshlrev_b32_e64 v132, 16, v49
  v_and_b32 v134, 0xffff0000, v49
  v_lshlrev_b32_e64 v133, 16, v53
  v_and_b32 v135, 0xffff0000, v53
  v_lshlrev_b32_e64 v136, 16, v50
  v_and_b32 v138, 0xffff0000, v50
  v_lshlrev_b32_e64 v137, 16, v54
  v_and_b32 v139, 0xffff0000, v54
  v_lshlrev_b32_e64 v140, 16, v51
  v_and_b32 v142, 0xffff0000, v51
  v_lshlrev_b32_e64 v141, 16, v55
  v_and_b32 v143, 0xffff0000, v55
  v_pk_add_f32 v[16:17], v[128:129], v[130:131]
  v_pk_add_f32 v[20:21], v[132:133], v[134:135]
  v_pk_add_f32 v[18:19], v[136:137], v[138:139]
  v_pk_add_f32 v[22:23], v[140:141], v[142:143]
  v_pk_add_f32 v[16:17], v[16:17], v[20:21]
  v_pk_add_f32 v[18:19], v[18:19], v[22:23]
  v_pk_add_f32 v[16:17], v[16:17], v[18:19]
  s_nop 1
  s_nop 0
  v_add_f32_dpp v16, v16, v16 row_ror:1 row_mask:0xf bank_mask:0xf
  v_add_f32_dpp v17, v17, v17 row_ror:1 row_mask:0xf bank_mask:0xf
  buffer_store_dwordx4 v[48:51], v1, s[4:7], s20 offen offset:0 sc1
  v_add_f32_dpp v16, v16, v16 row_ror:2 row_mask:0xf bank_mask:0xf
  v_add_f32_dpp v17, v17, v17 row_ror:2 row_mask:0xf bank_mask:0xf
  buffer_store_dwordx4 v[52:55], v1, s[4:7], s20 offen offset:1024 sc1
  v_add_f32_dpp v16, v16, v16 row_ror:4 row_mask:0xf bank_mask:0xf
  v_add_f32_dpp v17, v17, v17 row_ror:4 row_mask:0xf bank_mask:0xf
  s_nop 0
  v_add_f32_dpp v16, v16, v16 row_ror:8 row_mask:0xf bank_mask:0xf
  v_add_f32_dpp v17, v17, v17 row_ror:8 row_mask:0xf bank_mask:0xf
  v_mov_b32_e64 v20, v16
  v_mov_b32 v21, v17
  s_nop 0
  v_permlane16_swap_b32 v16, v20
  v_permlane16_swap_b32 v17, v21
  v_add_f32 v16, v16, v20
  v_add_f32 v17, v17, v21
  v_mov_b32 v20, v16
  v_mov_b32 v21, v17
  s_nop 0
  v_permlane32_swap_b32 v16, v20
  v_permlane32_swap_b32 v17, v21
  v_add_f32 v16, v16, v20
  v_add_f32 v17, v17, v21
  v_pk_mul_f32 v[16:17], v[16:17], s[36:37]
  v_pk_add_f32 v[160:161], v[128:129], v[16:17] neg_lo:[0,1] neg_hi:[0,1]
  v_pk_add_f32 v[162:163], v[130:131], v[16:17] neg_lo:[0,1] neg_hi:[0,1]
  v_pk_add_f32 v[164:165], v[132:133], v[16:17] neg_lo:[0,1] neg_hi:[0,1]
  v_pk_add_f32 v[166:167], v[134:135], v[16:17] neg_lo:[0,1] neg_hi:[0,1]
  v_pk_add_f32 v[168:169], v[136:137], v[16:17] neg_lo:[0,1] neg_hi:[0,1]
  v_pk_add_f32 v[170:171], v[138:139], v[16:17] neg_lo:[0,1] neg_hi:[0,1]
  v_pk_add_f32 v[172:173], v[140:141], v[16:17] neg_lo:[0,1] neg_hi:[0,1]
  v_pk_add_f32 v[174:175], v[142:143], v[16:17] neg_lo:[0,1] neg_hi:[0,1]
  v_pk_mul_f32 v[18:19], v[160:161], v[160:161]
  v_pk_mul_f32 v[20:21], v[162:163], v[162:163]
  v_pk_fma_f32 v[18:19], v[164:165], v[164:165], v[18:19]
  v_pk_fma_f32 v[20:21], v[166:167], v[166:167], v[20:21]
  v_pk_fma_f32 v[18:19], v[168:169], v[168:169], v[18:19]
  v_pk_fma_f32 v[20:21], v[170:171], v[170:171], v[20:21]
  v_pk_fma_f32 v[18:19], v[172:173], v[172:173], v[18:19]
  v_pk_fma_f32 v[20:21], v[174:175], v[174:175], v[20:21]
  v_pk_add_f32 v[18:19], v[18:19], v[20:21]
  s_nop 1
  s_nop 0
  v_add_f32_dpp v18, v18, v18 row_ror:1 row_mask:0xf bank_mask:0xf
  v_add_f32_dpp v19, v19, v19 row_ror:1 row_mask:0xf bank_mask:0xf
  v_cvt_pk_bf16_f32 v22, v16, v17
  v_add_f32_dpp v18, v18, v18 row_ror:2 row_mask:0xf bank_mask:0xf
  v_add_f32_dpp v19, v19, v19 row_ror:2 row_mask:0xf bank_mask:0xf
  v_and_b32 v23, 0xffff0000, v22
  v_add_f32_dpp v18, v18, v18 row_ror:4 row_mask:0xf bank_mask:0xf
  v_add_f32_dpp v19, v19, v19 row_ror:4 row_mask:0xf bank_mask:0xf
  v_lshlrev_b32_e64 v22, 16, v22
  v_add_f32_dpp v18, v18, v18 row_ror:8 row_mask:0xf bank_mask:0xf
  v_add_f32_dpp v19, v19, v19 row_ror:8 row_mask:0xf bank_mask:0xf
  v_pk_add_f32 v[144:145], v[128:129], v[22:23] neg_lo:[0,1] neg_hi:[0,1]
  v_mov_b32 v20, v18
  v_mov_b32 v21, v19
  v_pk_add_f32 v[146:147], v[130:131], v[22:23] neg_lo:[0,1] neg_hi:[0,1]
  v_permlane16_swap_b32 v18, v20
  v_permlane16_swap_b32 v19, v21
  v_pk_add_f32 v[148:149], v[132:133], v[22:23] neg_lo:[0,1] neg_hi:[0,1]
  v_add_f32 v18, v18, v20
  v_add_f32 v19, v19, v21
  v_pk_add_f32 v[150:151], v[134:135], v[22:23] neg_lo:[0,1] neg_hi:[0,1]
  v_mov_b32 v20, v18
  v_mov_b32 v21, v19
  v_pk_add_f32 v[152:153], v[136:137], v[22:23] neg_lo:[0,1] neg_hi:[0,1]
  v_permlane32_swap_b32 v18, v20
  v_permlane32_swap_b32 v19, v21
  v_pk_add_f32 v[154:155], v[138:139], v[22:23] neg_lo:[0,1] neg_hi:[0,1]
  v_add_f32 v18, v18, v20
  v_add_f32 v19, v19, v21
  v_pk_add_f32 v[156:157], v[140:141], v[22:23] neg_lo:[0,1] neg_hi:[0,1]
  v_pk_add_f32 v[158:159], v[142:143], v[22:23] neg_lo:[0,1] neg_hi:[0,1]
  v_pk_mul_f32 v[18:19], v[18:19], s[36:37]
  v_cvt_pk_bf16_f32 v18, v18, v19
  v_and_b32 v19, 0xffff0000, v18
  v_lshlrev_b32_e64 v18, 16, v18
  v_pk_add_f32 v[18:19], v[18:19], s[38:39]
  v_cvt_pk_bf16_f32 v18, v18, v19
  v_and_b32 v19, 0xffff0000, v18
  v_lshlrev_b32_e64 v18, 16, v18
  v_sqrt_f32 v18, v18
  v_sqrt_f32 v19, v19
  v_cvt_pk_bf16_f32 v24, v144, v146
  v_cvt_pk_bf16_f32 v28, v145, v147
  v_cvt_pk_bf16_f32 v25, v148, v150
  v_cvt_pk_bf16_f32 v29, v149, v151
  v_cvt_pk_bf16_f32 v18, v18, v19
  v_and_b32 v19, 0xffff0000, v18
  v_lshlrev_b32_e64 v18, 16, v18
  v_rcp_f32 v18, v18
  v_rcp_f32 v19, v19
  v_cvt_pk_bf16_f32 v26, v152, v154
  v_cvt_pk_bf16_f32 v30, v153, v155
  v_cvt_pk_bf16_f32 v27, v156, v158
  v_cvt_pk_bf16_f32 v31, v157, v159
  v_lshlrev_b32_e64 v144, 16, v24
  v_and_b32 v146, 0xffff0000, v24
  v_lshlrev_b32_e64 v145, 16, v28
  v_and_b32 v147, 0xffff0000, v28
  v_lshlrev_b32_e64 v148, 16, v25
  v_and_b32 v150, 0xffff0000, v25
  v_lshlrev_b32_e64 v149, 16, v29
  v_and_b32 v151, 0xffff0000, v29
  v_lshlrev_b32_e64 v152, 16, v26
  v_and_b32 v154, 0xffff0000, v26
  v_lshlrev_b32_e64 v153, 16, v30
  v_and_b32 v155, 0xffff0000, v30
  v_lshlrev_b32_e64 v156, 16, v27
  v_and_b32 v158, 0xffff0000, v27
  v_lshlrev_b32_e64 v157, 16, v31
  v_and_b32 v159, 0xffff0000, v31
  v_pk_mul_f32 v[144:145], v[144:145], v[18:19]
  v_pk_mul_f32 v[146:147], v[146:147], v[18:19]
  v_pk_mul_f32 v[148:149], v[148:149], v[18:19]
  v_pk_mul_f32 v[150:151], v[150:151], v[18:19]
  v_pk_mul_f32 v[152:153], v[152:153], v[18:19]
  v_pk_mul_f32 v[154:155], v[154:155], v[18:19]
  v_pk_mul_f32 v[156:157], v[156:157], v[18:19]
  v_pk_mul_f32 v[158:159], v[158:159], v[18:19]
  v_cvt_pk_bf16_f32 v24, v144, v146
  v_cvt_pk_bf16_f32 v28, v145, v147
  v_cvt_pk_bf16_f32 v25, v148, v150
  v_cvt_pk_bf16_f32 v29, v149, v151
  v_cvt_pk_bf16_f32 v26, v152, v154
  v_cvt_pk_bf16_f32 v30, v153, v155
  v_cvt_pk_bf16_f32 v27, v156, v158
  v_cvt_pk_bf16_f32 v31, v157, v159
  buffer_store_dwordx4 v[24:27], v1, s[4:7], s21 offen offset:0 sc1
  buffer_store_dwordx4 v[28:31], v1, s[4:7], s21 offen offset:1024 sc1
  s_add_u32 s23, s23, 1024
  s_add_u32 s19, s19, 32768
  s_add_u32 s20, s20, 32768
  s_add_u32 s21, s21, 32768
  s_mov_b32 s47, s22
  s_add_u32 s22, s22, 1024
  s_add_u32 s46, s46, 1024
  s_mov_b32 s48, 0
  s_add_u32 s15, s15, 1
  s_cmp_lt_u32 s15, 64
  s_cbranch_scc1 L_red1_top
  s_waitcnt vmcnt(0)
  s_mov_b64 exec, 3
  buffer_store_dword v7, v4, s[4:7], s47 offen sc1
  s_mov_b64 exec, -1
  s_branch L_end
L_red1_nap:
  s_branch L_red1_poll
L_red2_ini:
  v_lshrrev_b32 v61, 2, v0
  v_and_b32 v3, 12, v3
  v_lshl_add_u32 v3, v61, 6, v3
  s_mov_b32 s23, 524288
  v_and_b32 v61, 7, v0
  v_bfe_u32 v62, v0, 4, 1
  v_lshl_add_u32 v61, v62, 3, v61
  v_bfe_u32 v62, v0, 3, 1
  v_lshl_add_u32 v61, v62, 4, v61
  v_and_b32 v62, 32, v0
  v_add_u32 v61, v61, v62
  v_lshlrev_b32 v1, 4, v61
  v_and_b32 v61, 15, v0
  v_lshrrev_b32 v62, 4, v0
  v_and_b32 v63, 1, v0
  v_lshlrev_b32 v63, 4, v63
  v_mov_b32 v64, 0x3f80
  v_lshlrev_b32 v63, v63, v64
  v_lshrrev_b32 v64, 1, v61
  v_lshlrev_b32 v60, 15, v62
  v_cmp_eq_u32 vcc, 0, v64
  s_nop 1
  v_cndmask_b32 v176, 0, v63, vcc
  v_cmp_eq_u32 vcc, 1, v64
  s_nop 1
  v_cndmask_b32 v177, 0, v63, vcc
  v_cmp_eq_u32 vcc, 2, v64
  s_nop 1
  v_cndmask_b32 v178, 0, v63, vcc
  v_cmp_eq_u32 vcc, 3, v64
  s_nop 1
  v_cndmask_b32 v179, 0, v63, vcc
  v_cmp_eq_u32 vcc, 4, v64
  s_nop 1
  v_cndmask_b32 v180, 0, v63, vcc
  v_cmp_eq_u32 vcc, 5, v64
  s_nop 1
  v_cndmask_b32 v181, 0, v63, vcc
  v_cmp_eq_u32 vcc, 6, v64
  s_nop 1
  v_cndmask_b32 v182, 0, v63, vcc
  v_cmp_eq_u32 vcc, 7, v64
  s_nop 1
  v_cndmask_b32 v183, 0, v63, vcc
  v_lshl_add_u32 v60, v61, 4, v60
  s_mov_b32 s36, s26
  s_mov_b32 s37, s26
  s_mov_b32 s38, s25
  s_mov_b32 s39, s25
  s_lshl_b32 s67, s17, 10
  s_add_u32 s18, s67, 169869312
  s_lshl_b32 s67, s17, 10
  s_add_u32 s19, s67, 12582912
  s_add_u32 s20, s67, 14680064
  s_add_u32 s21, s67, 8388608
  s_lshl_b32 s67, s17, 5
  s_add_u32 s22, s67, 327680
  s_mov_b32 s46, 0
  s_sub_u32 s68, s22, 65536
  v_and_b32 v6, 32, v4
  v_add_u32 v6, s68, v6
  v_lshlrev_b32 v61, 2, v0
  v_add_u32 v61, 782304, v61
  v_cmp_gt_u32 vcc, 8, v0
  s_nop 1
  v_cndmask_b32 v6, v61, v6, vcc
  v_lshrrev_b32 v61, 4, v0
  v_lshlrev_b32 v61, 15, v61
  v_and_b32 v62, 15, v0
  v_lshl_add_u32 v61, v62, 7, v61
  buffer_load_dword v56, v61, s[4:7], s21 offen sc1
  s_mov_b32 s49, s21
  s_mov_b32 s47, 536870912
  s_mov_b32 s48, 0
  .p2align 3
L_red2_top:
L_red2_poll:
  s_sub_u32 s66, s66, 1
  s_cbranch_scc1 L_abort
  buffer_load_dword v5, v3, s[4:7], s23 offen sc1
  buffer_load_dword v56, v6, s[4:7], s46 offen sc1
  s_waitcnt vmcnt(0)
  v_cmp_ne_u32 vcc, 0, v5
  v_cmp_ne_u32 s[50:51], 0, v56
  s_mov_b64 exec, 3
  buffer_store_dword v7, v4, s[4:7], s47 offen
  s_mov_b64 exec, -1
  s_mov_b32 s47, 536870912
  s_cmp_lt_u32 s15, 4
  s_cselect_b32 s68, -1, 0
  s_or_b32 s51, s51, s68
  s_andn2_b32 s68, s68, 0xff
  s_or_b32 s50, s50, s68
  s_cmp_eq_u64 s[50:51], exec
  s_cbranch_scc0 L_red2_poll
  s_cmp_lg_u32 s48, 0
  s_cbranch_scc1 L_red2_have
  buffer_load_dwordx4 v[40:43], v1, s[4:7], s19 offen offset:0 sc1
  buffer_load_dwordx4 v[44:47], v1, s[4:7], s19 offen offset:1024 sc1
  s_mov_b32 s48, 1
L_red2_have:
  s_and_b32 s68, s15, 3
  s_lshl_b32 s68, s68, 15
  s_add_u32 s21, s49, s68
  s_and_b32 s68, s15, 7
  s_mul_i32 s68, s68, 131072
  s_add_u32 s68, s68, s18
  s_cmp_eq_u64 vcc, exec
  s_cbranch_scc0 L_red2_nap
  buffer_load_dwordx4 v[64:67], v60, s[4:7], s68 offen offset:0 sc1
  buffer_load_dwordx4 v[68:71], v60, s[4:7], s68 offen offset:256 sc1
  buffer_load_dwordx4 v[72:75], v60, s[4:7], s68 offen offset:512 sc1
  buffer_load_dwordx4 v[76:79], v60, s[4:7], s68 offen offset:768 sc1
  buffer_load_dwordx4 v[80:83], v60, s[4:7], s68 offen offset:1024 sc1
  buffer_load_dwordx4 v[84:87], v60, s[4:7], s68 offen offset:1280 sc1
  buffer_load_dwordx4 v[88:91], v60, s[4:7], s68 offen offset:1536 sc1
  buffer_load_dwordx4 v[92:95], v60, s[4:7], s68 offen offset:1792 sc1
  s_waitcnt vmcnt(9)
  v_lshlrev_b32 v128, 16, v40
  v_and_b32 v130, 0xffff0000, v40
  s_waitcnt vmcnt(8)
  v_lshlrev_b32 v129, 16, v44
  v_and_b32 v131, 0xffff0000, v44
  v_lshlrev_b32_e64 v132, 16, v41
  v_and_b32 v134, 0xffff0000, v41
  v_lshlrev_b32_e64 v133, 16, v45
  v_and_b32 v135, 0xffff0000, v45
  v_lshlrev_b32_e64 v136, 16, v42
  v_and_b32 v138, 0xffff0000, v42
  v_lshlrev_b32_e64 v137, 16, v46
  v_and_b32 v139, 0xffff0000, v46
  v_lshlrev_b32_e64 v140, 16, v43
  v_and_b32 v142, 0xffff0000, v43
  v_lshlrev_b32_e64 v141, 16, v47
  v_and_b32 v143, 0xffff0000, v47
  s_waitcnt vmcnt(7)
  v_mfma_f32_16x16x32_bf16 v[160:163], v[176:179], v[64:67], 0
  s_waitcnt vmcnt(6)
  v_mfma_f32_16x16x32_bf16 v[160:163], v[180:183], v[68:71], v[160:163]
  s_waitcnt vmcnt(5)
  v_mfma_f32_16x16x32_bf16 v[164:167], v[176:179], v[72:75], 0
  s_waitcnt vmcnt(4)
  v_mfma_f32_16x16x32_bf16 v[164:167], v[180:183], v[76:79], v[164:167]
  s_waitcnt vmcnt(3)
  v_mfma_f32_16x16x32_bf16 v[168:171], v[176:179], v[80:83], 0
  s_waitcnt vmcnt(2)
  v_mfma_f32_16x16x32_bf16 v[168:171], v[180:183], v[84:87], v[168:171]
  s_waitcnt vmcnt(1)
  v_mfma_f32_16x16x32_bf16 v[172:175], v[176:179], v[88:91], 0
  s_waitcnt vmcnt(0)
  v_mfma_f32_16x16x32_bf16 v[172:175], v[180:183], v[92:95], v[172:175]
  v_pk_add_f32 v[128:129], v[128:129], v[160:161]
  v_pk_add_f32 v[130:131], v[130:131], v[162:163]
  v_pk_add_f32 v[132:133], v[132:133], v[164:165]
  v_pk_add_f32 v[134:135], v[134:135], v[166:167]
  v_pk_add_f32 v[136:137], v[136:137], v[168:169]
  v_pk_add_f32 v[138:139], v[138:139], v[170:171]
  s_nop 1
  s_nop 0
  v_pk_add_f32 v[140:141], v[140:141], v[172:173]
  v_pk_add_f32 v[142:143], v[142:143], v[174:175]
  v_cvt_pk_bf16_f32 v48, v128, v130
  v_cvt_pk_bf16_f32 v52, v129, v131
  v_cvt_pk_bf16_f32 v49, v132, v134
  v_cvt_pk_bf16_f32 v53, v133, v135
  v_cvt_pk_bf16_f32 v50, v136, v138
  v_cvt_pk_bf16_f32 v54, v137, v139
  v_cvt_pk_bf16_f32 v51, v140, v142
  v_cvt_pk_bf16_f32 v55, v141, v143
  v_lshlrev_b32_e64 v128, 16, v48
  v_and_b32 v130, 0xffff0000, v48
  v_lshlrev_b32_e64 v129, 16, v52
  v_and_b32 v131, 0xffff0000, v52
  v_lshlrev_b32_e64 v132, 16, v49
  v_and_b32 v134, 0xffff0000, v49
  v_lshlrev_b32_e64 v133, 16, v53
  v_and_b32 v135, 0xffff0000, v53
  v_lshlrev_b32_e64 v136, 16, v50
  v_and_b32 v138, 0xffff0000, v50
  v_lshlrev_b32_e64 v137, 16, v54
  v_and_b32 v139, 0xffff0000, v54
  v_lshlrev_b32_e64 v140, 16, v51
  v_and_b32 v142, 0xffff0000, v51
  v_lshlrev_b32_e64 v141, 16, v55
  v_and_b32 v143, 0xffff0000, v55
  v_pk_add_f32 v[16:17], v[128:129], v[130:131]
  v_pk_add_f32 v[20:21], v[132:133], v[134:135]
  v_pk_add_f32 v[18:19], v[136:137], v[138:139]
  v_pk_add_f32 v[22:23], v[140:141], v[142:143]
  v_pk_add_f32 v[16:17], v[16:17], v[20:21]
  v_pk_add_f32 v[18:19], v[18:19], v[22:23]
  v_pk_add_f32 v[16:17], v[16:17], v[18:19]
  s_nop 1
  s_nop 0
  v_add_f32_dpp v16, v16, v16 row_ror:1 row_mask:0xf bank_mask:0xf
  v_add_f32_dpp v17, v17, v17 row_ror:1 row_mask:0xf bank_mask:0xf
  buffer_store_dwordx4 v[48:51], v1, s[4:7], s20 offen offset:0 sc1
  v_add_f32_dpp v16, v16, v16 row_ror:2 row_mask:0xf bank_mask:0xf
  v_add_f32_dpp v17, v17, v17 row_ror:2 row_mask:0xf bank_mask:0xf
  buffer_store_dwordx4 v[52:55], v1, s[4:7], s20 offen offset:1024 sc1
  v_add_f32_dpp v16, v16, v16 row_ror:4 row_mask:0xf bank_mask:0xf
  v_add_f32_dpp v17, v17, v17 row_ror:4 row_mask:0xf bank_mask:0xf
  s_nop 0
  v_add_f32_dpp v16, v16, v16 row_ror:8 row_mask:0xf bank_mask:0xf
  v_add_f32_dpp v17, v17, v17 row_ror:8 row_mask:0xf bank_mask:0xf
  v_mov_b32_e64 v20, v16
  v_mov_b32 v21, v17
  s_nop 0
  v_permlane16_swap_b32 v16, v20
  v_permlane16_swap_b32 v17, v21
  v_add_f32 v16, v16, v20
  v_add_f32 v17, v17, v21
  v_mov_b32 v20, v16
  v_mov_b32 v21, v17
  s_nop 0
  v_permlane32_swap_b32 v16, v20
  v_permlane32_swap_b32 v17, v21
  v_add_f32 v16, v16, v20
  v_add_f32 v17, v17, v21
  v_pk_mul_f32 v[16:17], v[16:17], s[36:37]
  v_pk_add_f32 v[160:161], v[128:129], v[16:17] neg_lo:[0,1] neg_hi:[0,1]
  v_pk_add_f32 v[162:163], v[130:131], v[16:17] neg_lo:[0,1] neg_hi:[0,1]
  v_pk_add_f32 v[164:165], v[132:133], v[16:17] neg_lo:[0,1] neg_hi:[0,1]
  v_pk_add_f32 v[166:167], v[134:135], v[16:17] neg_lo:[0,1] neg_hi:[0,1]
  v_pk_add_f32 v[168:169], v[136:137], v[16:17] neg_lo:[0,1] neg_hi:[0,1]
  v_pk_add_f32 v[170:171], v[138:139], v[16:17] neg_lo:[0,1] neg_hi:[0,1]
  v_pk_add_f32 v[172:173], v[140:141], v[16:17] neg_lo:[0,1] neg_hi:[0,1]
  v_pk_add_f32 v[174:175], v[142:143], v[16:17] neg_lo:[0,1] neg_hi:[0,1]
  v_pk_mul_f32 v[18:19], v[160:161], v[160:161]
  v_pk_mul_f32 v[20:21], v[162:163], v[162:163]
  v_pk_fma_f32 v[18:19], v[164:165], v[164:165], v[18:19]
  v_pk_fma_f32 v[20:21], v[166:167], v[166:167], v[20:21]
  v_pk_fma_f32 v[18:19], v[168:169], v[168:169], v[18:19]
  v_pk_fma_f32 v[20:21], v[170:171], v[170:171], v[20:21]
  v_pk_fma_f32 v[18:19], v[172:173], v[172:173], v[18:19]
  v_pk_fma_f32 v[20:21], v[174:175], v[174:175], v[20:21]
  v_pk_add_f32 v[18:19], v[18:19], v[20:21]
  s_nop 1
  s_nop 0
  v_add_f32_dpp v18, v18, v18 row_ror:1 row_mask:0xf bank_mask:0xf
  v_add_f32_dpp v19, v19, v19 row_ror:1 row_mask:0xf bank_mask:0xf
  v_cvt_pk_bf16_f32 v22, v16, v17
  v_add_f32_dpp v18, v18, v18 row_ror:2 row_mask:0xf bank_mask:0xf
  v_add_f32_dpp v19, v19, v19 row_ror:2 row_mask:0xf bank_mask:0xf
  v_and_b32 v23, 0xffff0000, v22
  v_add_f32_dpp v18, v18, v18 row_ror:4 row_mask:0xf bank_mask:0xf
  v_add_f32_dpp v19, v19, v19 row_ror:4 row_mask:0xf bank_mask:0xf
  v_lshlrev_b32_e64 v22, 16, v22
  v_add_f32_dpp v18, v18, v18 row_ror:8 row_mask:0xf bank_mask:0xf
  v_add_f32_dpp v19, v19, v19 row_ror:8 row_mask:0xf bank_mask:0xf
  v_pk_add_f32 v[144:145], v[128:129], v[22:23] neg_lo:[0,1] neg_hi:[0,1]
  v_mov_b32 v20, v18
  v_mov_b32 v21, v19
  v_pk_add_f32 v[146:147], v[130:131], v[22:23] neg_lo:[0,1] neg_hi:[0,1]
  v_permlane16_swap_b32 v18, v20
  v_permlane16_swap_b32 v19, v21
  v_pk_add_f32 v[148:149], v[132:133], v[22:23] neg_lo:[0,1] neg_hi:[0,1]
  v_add_f32 v18, v18, v20
  v_add_f32 v19, v19, v21
  v_pk_add_f32 v[150:151], v[134:135], v[22:23] neg_lo:[0,1] neg_hi:[0,1]
  v_mov_b32 v20, v18
  v_mov_b32 v21, v19
  v_pk_add_f32 v[152:153], v[136:137], v[22:23] neg_lo:[0,1] neg_hi:[0,1]
  v_permlane32_swap_b32 v18, v20
  v_permlane32_swap_b32 v19, v21
  v_pk_add_f32 v[154:155], v[138:139], v[22:23] neg_lo:[0,1] neg_hi:[0,1]
  v_add_f32 v18, v18, v20
  v_add_f32 v19, v19, v21
  v_pk_add_f32 v[156:157], v[140:141], v[22:23] neg_lo:[0,1] neg_hi:[0,1]
  v_pk_add_f32 v[158:159], v[142:143], v[22:23] neg_lo:[0,1] neg_hi:[0,1]
  v_pk_mul_f32 v[18:19], v[18:19], s[36:37]
  v_cvt_pk_bf16_f32 v18, v18, v19
  v_and_b32 v19, 0xffff0000, v18
  v_lshlrev_b32_e64 v18, 16, v18
  v_pk_add_f32 v[18:19], v[18:19], s[38:39]
  v_cvt_pk_bf16_f32 v18, v18, v19
  v_and_b32 v19, 0xffff0000, v18
  v_lshlrev_b32_e64 v18, 16, v18
  v_sqrt_f32 v18, v18
  v_sqrt_f32 v19, v19
  v_cvt_pk_bf16_f32 v24, v144, v146
  v_cvt_pk_bf16_f32 v28, v145, v147
  v_cvt_pk_bf16_f32 v25, v148, v150
  v_cvt_pk_bf16_f32 v29, v149, v151
  v_cvt_pk_bf16_f32 v18, v18, v19
  v_and_b32 v19, 0xffff0000, v18
  v_lshlrev_b32_e64 v18, 16, v18
  v_rcp_f32 v18, v18
  v_rcp_f32 v19, v19
  v_cvt_pk_bf16_f32 v26, v152, v154
  v_cvt_pk_bf16_f32 v30, v153, v155
  v_cvt_pk_bf16_f32 v27, v156, v158
  v_cvt_pk_bf16_f32 v31, v157, v159
  v_lshlrev_b32_e64 v144, 16, v24
  v_and_b32 v146, 0xffff0000, v24
  v_lshlrev_b32_e64 v145, 16, v28
  v_and_b32 v147, 0xffff0000, v28
  v_lshlrev_b32_e64 v148, 16, v25
  v_and_b32 v150, 0xffff0000, v25
  v_lshlrev_b32_e64 v149, 16, v29
  v_and_b32 v151, 0xffff0000, v29
  v_lshlrev_b32_e64 v152, 16, v26
  v_and_b32 v154, 0xffff0000, v26
  v_lshlrev_b32_e64 v153, 16, v30
  v_and_b32 v155, 0xffff0000, v30
  v_lshlrev_b32_e64 v156, 16, v27
  v_and_b32 v158, 0xffff0000, v27
  v_lshlrev_b32_e64 v157, 16, v31
  v_and_b32 v159, 0xffff0000, v31
  v_pk_mul_f32 v[144:145], v[144:145], v[18:19]
  v_pk_mul_f32 v[146:147], v[146:147], v[18:19]
  v_pk_mul_f32 v[148:149], v[148:149], v[18:19]
  v_pk_mul_f32 v[150:151], v[150:151], v[18:19]
  v_pk_mul_f32 v[152:153], v[152:153], v[18:19]
  v_pk_mul_f32 v[154:155], v[154:155], v[18:19]
  v_pk_mul_f32 v[156:157], v[156:157], v[18:19]
  v_pk_mul_f32 v[158:159], v[158:159], v[18:19]
  v_cvt_pk_bf16_f32 v24, v144, v146
  v_cvt_pk_bf16_f32 v28, v145, v147
  v_cvt_pk_bf16_f32 v25, v148, v150
  v_cvt_pk_bf16_f32 v29, v149, v151
  v_cvt_pk_bf16_f32 v26, v152, v154
  v_cvt_pk_bf16_f32 v30, v153, v155
  v_cvt_pk_bf16_f32 v27, v156, v158
  v_cvt_pk_bf16_f32 v31, v157, v159
  buffer_store_dwordx4 v[24:27], v1, s[4:7], s21 offen offset:0
  buffer_store_dwordx4 v[28:31], v1, s[4:7], s21 offen offset:1024
  s_add_u32 s23, s23, 1024
  s_add_u32 s19, s19, 32768
  s_add_u32 s20, s20, 32768
  s_add_u32 s21, s21, 32768
  s_mov_b32 s47, s22
  s_add_u32 s22, s22, 1024
  s_add_u32 s46, s46, 1024
  s_mov_b32 s48, 0
  s_add_u32 s15, s15, 1
  s_cmp_lt_u32 s15, 64
  s_cbranch_scc1 L_red2_top
  s_waitcnt vmcnt(0)
  s_mov_b64 exec, 3
  buffer_store_dword v7, v4, s[4:7], s47 offen
  s_mov_b64 exec, -1
  s_branch L_end
L_red2_nap:
  s_branch L_red2_poll
L_red3_ini:
  v_and_b32 v3, 127, v3
  s_mov_b32 s23, 655360
  v_and_b32 v61, 7, v0
  v_bfe_u32 v62, v0, 4, 1
  v_lshl_add_u32 v61, v62, 3, v61
  v_bfe_u32 v62, v0, 3, 1
  v_lshl_add_u32 v61, v62, 4, v61
  v_and_b32 v62, 32, v0
  v_add_u32 v61, v61, v62
  v_lshlrev_b32 v1, 4, v61
  v_and_b32 v61, 15, v0
  v_lshrrev_b32 v62, 4, v0
  v_and_b32 v63, 1, v0
  v_lshlrev_b32 v63, 4, v63
  v_mov_b32 v64, 0x3f80
  v_lshlrev_b32 v63, v63, v64
  v_lshrrev_b32 v64, 1, v61
  v_lshrrev_b32 v65, 1, v62
  v_and_b32 v62, 1, v62
  v_lshlrev_b32 v60, 15, v62
  v_lshl_add_u32 v60, v65, 8, v60
  v_lshlrev_b32 v65, 2, v65
  v_sub_u32 v64, v64, v65
  v_cmp_eq_u32 vcc, 0, v64
  s_nop 1
  v_cndmask_b32 v176, 0, v63, vcc
  v_cmp_eq_u32 vcc, 1, v64
  s_nop 1
  v_cndmask_b32 v177, 0, v63, vcc
  v_cmp_eq_u32 vcc, 2, v64
  s_nop 1
  v_cndmask_b32 v178, 0, v63, vcc
  v_cmp_eq_u32 vcc, 3, v64
  s_nop 1
  v_cndmask_b32 v179, 0, v63, vcc
  v_lshl_add_u32 v60, v61, 4, v60
  s_mov_b32 s36, s26
  s_mov_b32 s37, s26
  s_mov_b32 s38, s25
  s_mov_b32 s39, s25
  s_lshl_b32 s67, s17, 10
  s_add_u32 s18, s67, 236978176
  s_lshl_b32 s67, s17, 10
  s_add_u32 s19, s67, 14680064
  s_add_u32 s20, s67, 0
  s_add_u32 s21, s67, 10485760
  s_lshl_b32 s67, s17, 5
  s_add_u32 s22, s67, 393216
  s_mov_b32 s46, 0
  s_sub_u32 s68, s22, 65536
  v_and_b32 v6, 32, v4
  v_add_u32 v6, s68, v6
  s_mov_b32 s47, 536870912
  s_mov_b32 s48, 0
  .p2align 3
L_red3_top:
L_red3_poll:
  s_sub_u32 s66, s66, 1
  s_cbranch_scc1 L_abort
  buffer_load_dword v5, v3, s[4:7], s23 offen sc1
  buffer_load_dword v56, v6, s[4:7], s46 offen sc1
  s_waitcnt vmcnt(0)
  v_cmp_ne_u32 vcc, 0, v5
  v_cmp_ne_u32 s[50:51], 0, v56
  s_mov_b64 exec, 3
  buffer_store_dword v7, v4, s[4:7], s47 offen sc1
  s_mov_b64 exec, -1
  s_mov_b32 s47, 536870912
  s_cmp_eq_u64 s[50:51], exec
  s_cbranch_scc0 L_red3_poll
  s_cmp_lg_u32 s48, 0
  s_cbranch_scc1 L_red3_have
  buffer_load_dwordx4 v[40:43], v1, s[4:7], s19 offen offset:0 sc1
  buffer_load_dwordx4 v[44:47], v1, s[4:7], s19 offen offset:1024 sc1
  s_mov_b32 s48, 1
L_red3_have:
  s_and_b32 s68, s15, 3
  s_mul_i32 s68, s68, 65536
  s_add_u32 s68, s68, s18
  s_cmp_eq_u64 vcc, exec
  s_cbranch_scc0 L_red3_nap
  buffer_load_dwordx4 v[64:67], v60, s[4:7], s68 offen offset:0 sc1
  buffer_load_dwordx4 v[68:71], v60, s[4:7], s68 offen offset:512 sc1
  buffer_load_dwordx4 v[72:75], v60, s[4:7], s68 offen offset:1024 sc1
  buffer_load_dwordx4 v[76:79], v60, s[4:7], s68 offen offset:1536 sc1
  s_waitcnt vmcnt(5)
  v_lshlrev_b32_e64 v128, 16, v40
  v_and_b32 v130, 0xffff0000, v40
  s_waitcnt vmcnt(4)
  v_lshlrev_b32 v129, 16, v44
  v_and_b32 v131, 0xffff0000, v44
  v_lshlrev_b32_e64 v132, 16, v41
  v_and_b32 v134, 0xffff0000, v41
  v_lshlrev_b32_e64 v133, 16, v45
  v_and_b32 v135, 0xffff0000, v45
  v_lshlrev_b32_e64 v136, 16, v42
  v_and_b32 v138, 0xffff0000, v42
  v_lshlrev_b32_e64 v137, 16, v46
  v_and_b32 v139, 0xffff0000, v46
  v_lshlrev_b32_e64 v140, 16, v43
  v_and_b32 v142, 0xffff0000, v43
  v_lshlrev_b32_e64 v141, 16, v47
  v_and_b32 v143, 0xffff0000, v47
  s_waitcnt vmcnt(3)
  v_mfma_f32_16x16x32_bf16 v[160:163], v[176:179], v[64:67], 0
  s_waitcnt vmcnt(2)
  v_mfma_f32_16x16x32_bf16 v[164:167], v[176:179], v[68:71], 0
  s_waitcnt vmcnt(1)
  v_mfma_f32_16x16x32_bf16 v[168:171], v[176:179], v[72:75], 0
  s_waitcnt vmcnt(0)
  v_mfma_f32_16x16x32_bf16 v[172:175], v[176:179], v[76:79], 0
  s_nop 1
  s_nop 0
  v_pk_add_f32 v[128:129], v[128:129], v[160:161]
  v_pk_add_f32 v[130:131], v[130:131], v[162:163]
  v_pk_add_f32 v[132:133], v[132:133], v[164:165]
  v_pk_add_f32 v[134:135], v[134:135], v[166:167]
  v_pk_add_f32 v[136:137], v[136:137], v[168:169]
  v_pk_add_f32 v[138:139], v[138:139], v[170:171]
  v_pk_add_f32 v[140:141], v[140:141], v[172:173]
  v_pk_add_f32 v[142:143], v[142:143], v[174:175]
  v_cvt_pk_bf16_f32 v48, v128, v130
  v_cvt_pk_bf16_f32 v52, v129, v131
  v_cvt_pk_bf16_f32 v49, v132, v134
  v_cvt_pk_bf16_f32 v53, v133, v135
  v_cvt_pk_bf16_f32 v50, v136, v138
  v_cvt_pk_bf16_f32 v54, v137, v139
  v_cvt_pk_bf16_f32 v51, v140, v142
  v_cvt_pk_bf16_f32 v55, v141, v143
  buffer_store_dwordx4 v[48:51], v1, s[32:35], s20 offen offset:0
  buffer_store_dwordx4 v[52:55], v1, s[32:35], s20 offen offset:1024
  s_add_u32 s23, s23, 1024
  s_add_u32 s19, s19, 32768
  s_add_u32 s20, s20, 32768
  s_add_u32 s21, s21, 32768
  s_mov_b64 exec, 3
  buffer_store_dword v7, v4, s[4:7], s22 offen sc1
  s_mov_b64 exec, -1
  s_add_u32 s22, s22, 1024
  s_add_u32 s46, s46, 1024
  s_mov_b32 s48, 0
  s_add_u32 s15, s15, 1
  s_cmp_lt_u32 s15, 64
  s_cbranch_scc1 L_red3_top
  s_waitcnt vmcnt(0)
  s_mov_b64 exec, 3
  buffer_store_dword v7, v4, s[4:7], s47 offen sc1
  s_mov_b64 exec, -1
  s_branch L_end
L_red3_nap:
  s_branch L_red3_poll
L_last:
  s_endpgm
.section .rodata,"a"
.p2align 6
.amdhsa_kernel interleave_layers__memory_aug_recurrent_mem_tr__glu_gated_glu__prompt_kernel
  .amdhsa_next_free_vgpr 512
  .amdhsa_next_free_sgpr 102
  .amdhsa_accum_offset 256
  .amdhsa_group_segment_fixed_size 0
  .amdhsa_kernarg_size 112
  .amdhsa_user_sgpr_count 2
  .amdhsa_user_sgpr_kernarg_segment_ptr 1
  .amdhsa_system_sgpr_workgroup_id_x 1
  .amdhsa_float_denorm_mode_32 3
.end_amdhsa_kernel
```
